```python
import torch

def _softmax(x, axis=-1):
    return torch.softmax(x, dim=axis)
def _gelu(x):
    return torch.nn.functional.gelu(x, approximate="tanh")
def _silu(x):
    return torch.nn.functional.silu(x)
def _sigmoid(x):
    return torch.sigmoid(x)
def _layernorm(x, axis=-1, eps=1e-5):
    m = x.mean(dim=axis, keepdim=True)
    v = x.var(dim=axis, keepdim=True, unbiased=False)
    return (x - m) / torch.sqrt(v + eps)
def _scatter_add(tgt, idx, src, axis=0):
    return tgt.clone().index_add_(axis, idx, src)
def _segment_sum(src, seg, n):
    out = torch.zeros((n,) + src.shape[1:], dtype=src.dtype)
    return out.index_add_(0, seg, src)
def _pad(x, pw):
    flat = tuple(v for pair in reversed(pw) for v in pair)
    return torch.nn.functional.pad(x, flat)

kernel_name = 'parallel_sum__sliding_local_dilated__geglu_ffn__prompt'

def setup_inputs():

    _w = (lambda a: (lambda t: t.to(torch.bfloat16) if t.is_floating_point() else t)(torch.as_tensor(a)))
    def _A_setup():
        B, S, D = 1, 2048, 448
        return {
            "x": _w((lambda *s: torch.randn(*s, dtype=torch.bfloat16) * 0.05)(B, S, D)),
            "wqkv": _w((lambda *s: torch.randn(*s, dtype=torch.bfloat16) * 0.05)(D, 3 * D)),
            "wo": _w((lambda *s: torch.randn(*s, dtype=torch.bfloat16) * 0.05)(D, D)),
        }
    _A_in = _A_setup()

    def _B_setup():
        B, S, D, F = 1, 2048, 448, 1792
        return {
            "x": _w((lambda *s: torch.randn(*s, dtype=torch.bfloat16) * 0.05)(B, S, D)),
            "w_gate": _w((lambda *s: torch.randn(*s, dtype=torch.bfloat16) * 0.05)(D, F)),
            "w_up": _w((lambda *s: torch.randn(*s, dtype=torch.bfloat16) * 0.05)(D, F)),
            "w_down": _w((lambda *s: torch.randn(*s, dtype=torch.bfloat16) * 0.05)(F, D)),
        }
    _B_in = _B_setup()

    return {
        "A_x": _A_in["x"],
        "A_wqkv": _A_in["wqkv"],
        "A_wo": _A_in["wo"],
        "B_x": _B_in["x"],
        "B_w_gate": _B_in["w_gate"],
        "B_w_up": _B_in["w_up"],
        "B_w_down": _B_in["w_down"],
    }

def reference(A_x, A_wqkv, A_wo, B_x, B_w_gate, B_w_up, B_w_down):
    def _A_ref(x, wqkv, wo):
        B, S, D = x.shape
        H = 16; Dh = D // H
        W, dil = 8, 2
        qkv = (lambda x, *d: x.permute(*d))((x @ wqkv).reshape(B, S, 3, H, Dh), 2, 0, 3, 1, 4)
        q, k, v = qkv[0], qkv[1], qkv[2]
        scale = Dh ** -0.5
        pos = torch.arange(S)
        off = torch.arange(W) * dil
        idx = pos[:, None] - off[None, :]
        mask = idx >= 0
        idx_c = torch.where(mask, idx, 0).reshape(-1)
        kg = k[:, :, idx_c, :].reshape(B, H, S, W, Dh)
        vg = v[:, :, idx_c, :].reshape(B, H, S, W, Dh)
        logits = torch.einsum("bhsd,bhswd->bhsw", q, kg) * scale
        logits = torch.where(mask[None, None, :, :], logits, -1e9)
        attn = _softmax(logits, axis=-1)
        o = torch.einsum("bhsw,bhswd->bhsd", attn, vg)
        return (lambda x, *d: x.permute(*d))(o, 0, 2, 1, 3).reshape(B, S, D) @ wo

    def _B_ref(x, w_gate, w_up, w_down):
        return (_gelu(x @ w_gate) * (x @ w_up)) @ w_down

    x = A_x
    xn = _layernorm(x, axis=-1)
    return x + _A_ref(xn, A_wqkv, A_wo) + _B_ref(xn, B_w_gate, B_w_up, B_w_down)
```

```asm
; @launch grid=(256,1,1) block=(256,1,1) lds=163840
.amdgcn_target "amdgcn-amd-amdhsa--gfx950"
.text
.globl parallel_sum__sliding_local_dilated__geglu_ffn__prompt_kernel
.p2align 8
.type parallel_sum__sliding_local_dilated__geglu_ffn__prompt_kernel,@function
parallel_sum__sliding_local_dilated__geglu_ffn__prompt_kernel:
    s_load_dwordx16 s[64:79], s[0:1], 0
    s_load_dwordx4 s[80:83], s[0:1], 64
    s_cmp_ge_u32 s2, 256
    s_cbranch_scc1 L_end
    s_getpc_b64 s[96:97]
    s_lshr_b32 s44, s2, 3
    v_lshrrev_b32 v1, 4, v0
    v_lshl_add_u32 v1, s44, 4, v1
    v_min_u32 v1, 403, v1
    v_lshlrev_b32 v1, 7, v1
    global_load_dword a255, v1, s[96:97]
    v_lshrrev_b32 v1, 6, v0
    v_and_b32 v0, 63, v0
    v_readfirstlane_b32 s3, v1
    s_and_b32 s43, s2, 7
    s_lshr_b32 s41, s44, 3
    s_and_b32 s57, s43, 1
    s_and_b32 s58, s44, 7
    s_lshl_b32 s40, s57, 3
    s_add_u32 s40, s40, s58
    s_lshl_b32 s60, s3, 14
    s_add_u32 s60, s60, 82432
    s_and_b32 s100, s58, 1
    s_lshr_b32 s57, s58, 1
    s_add_u32 s57, s57, s41
    s_lshl_b32 s57, s57, 1
    s_cmp_ge_u32 s57, 7
    s_cselect_b32 s58, 7, 0
    s_sub_u32 s46, s57, s58
    s_lshl_b32 s45, s46, 7
    s_mov_b32 s47, s45
    s_mul_i32 s48, s40, 114688
    s_add_u32 s49, s48, s45
    s_lshr_b32 s57, s3, 1
    s_lshl_b32 s57, s57, 6
    s_and_b32 s58, s3, 1
    s_add_u32 s57, s57, s58
    v_lshrrev_b32 v1, 3, v0
    v_lshl_add_u32 v1, v1, 1, s57
    v_mul_u32_u24 v1, 896, v1
    v_and_b32 v2, 7, v0
    v_lshrrev_b32 v3, 4, v0
    v_xor_b32 v2, v2, v3
    v_lshl_add_u32 v234, v2, 4, v1
    v_xor_b32 v235, 64, v234
    s_mov_b32 s6, 1835008
    s_mov_b32 s7, 0x20000
    s_waitcnt lgkmcnt(0)
    s_mov_b32 s4, s64
    s_mov_b32 s5, s65
    s_add_u32 m0, s60, 0
    s_nop 0
    buffer_load_dwordx4 v234, s[4:7], s49 offen  lds
    s_add_u32 m0, s60, 1024
    s_add_u32 s58, s49, 14336
    buffer_load_dwordx4 v235, s[4:7], s58 offen  lds
    s_add_u32 m0, s60, 2048
    s_add_u32 s58, s49, 28672
    buffer_load_dwordx4 v234, s[4:7], s58 offen  lds
    s_add_u32 m0, s60, 3072
    s_add_u32 s58, s49, 43008
    buffer_load_dwordx4 v235, s[4:7], s58 offen  lds
    s_add_u32 s45, s45, 128
    s_cmp_eq_u32 s45, 896
    s_cselect_b32 s45, 0, s45
    s_add_u32 s49, s48, s45
    s_add_u32 m0, s60, 4096
    s_nop 0
    buffer_load_dwordx4 v234, s[4:7], s49 offen  lds
    s_add_u32 m0, s60, 5120
    s_add_u32 s58, s49, 14336
    buffer_load_dwordx4 v235, s[4:7], s58 offen  lds
    s_add_u32 m0, s60, 6144
    s_add_u32 s58, s49, 28672
    buffer_load_dwordx4 v234, s[4:7], s58 offen  lds
    s_add_u32 m0, s60, 7168
    s_add_u32 s58, s49, 43008
    buffer_load_dwordx4 v235, s[4:7], s58 offen  lds
    s_add_u32 s45, s45, 128
    s_cmp_eq_u32 s45, 896
    s_cselect_b32 s45, 0, s45
    s_add_u32 s49, s48, s45
    s_lshr_b32 s42, s43, 1
    s_mov_b32 s53, 0xffff0000
    s_mov_b32 s54, 0x3f803f80
    s_cmp_ge_u32 s41, 2
    s_cbranch_scc1 L_typeB
    v_and_b32 v1, 31, v0
    v_lshrrev_b32 v2, 5, v0
    v_bfe_u32 v3, v0, 1, 3
    v_xor_b32 v2, v2, v3
    v_lshlrev_b32 v1, 7, v1
    v_lshl_add_u32 v1, v2, 4, v1
    s_lshl_b32 s57, s100, 6
    v_xor_b32 v1, s57, v1
    v_add_u32 v236, s60, v1
    v_xor_b32 v237, 32, v236
    v_xor_b32 v238, 64, v236
    v_xor_b32 v239, 96, v236
    v_mov_b32 v200, 0
    v_mov_b32 v201, 0
    v_mov_b32 v202, 0
    v_mov_b32 v203, 0
    s_cmp_ge_u32 s3, 2
    s_cselect_b32 s8, s74, s72
    s_cselect_b32 s9, s75, s73
    s_sub_u32 s8, s8, 4096
    s_subb_u32 s9, s9, 0
    s_mov_b32 s10, 1609728
    s_mov_b32 s11, 0x20000
    s_mul_i32 s96, s100, 114688
    s_mul_i32 s50, s46, 229376
    s_add_u32 s50, s50, s96
    s_lshl_b32 s99, s96, 1
    s_sub_u32 s98, 114688, s99
    s_add_u32 s99, s99, 114688
    s_and_b32 s58, s3, 1
    s_mul_i32 s59, s58, 320
    s_mul_i32 s57, s42, 896
    s_mul_i32 s51, s41, 320
    s_add_u32 s57, s57, s51
    s_add_u32 s57, s57, 4352
    v_add_u32 v1, s59, v0
    v_mul_u32_u24 v2, 3277, v1
    v_lshrrev_b32 v2, 16, v2
    v_mul_u32_u24 v3, 20, v2
    v_sub_u32 v3, v1, v3
    v_mul_u32_u24 v2, 3584, v2
    v_lshl_add_u32 v2, v3, 4, v2
    v_add_u32 v8, s57, v2
    v_add_u32 v1, s59, v0
    v_add_u32 v1, 64, v1
    v_mul_u32_u24 v2, 3277, v1
    v_lshrrev_b32 v2, 16, v2
    v_mul_u32_u24 v3, 20, v2
    v_sub_u32 v3, v1, v3
    v_mul_u32_u24 v2, 3584, v2
    v_lshl_add_u32 v2, v3, 4, v2
    v_add_u32 v9, s57, v2
    v_subrev_u32 v9, 1024, v9
    v_add_u32 v1, s59, v0
    v_add_u32 v1, 128, v1
    v_mul_u32_u24 v2, 3277, v1
    v_lshrrev_b32 v2, 16, v2
    v_mul_u32_u24 v3, 20, v2
    v_sub_u32 v3, v1, v3
    v_mul_u32_u24 v2, 3584, v2
    v_lshl_add_u32 v2, v3, 4, v2
    v_add_u32 v10, s57, v2
    v_subrev_u32 v10, 2048, v10
    v_add_u32 v1, s59, v0
    v_add_u32 v1, 192, v1
    v_mul_u32_u24 v2, 3277, v1
    v_lshrrev_b32 v2, 16, v2
    v_mul_u32_u24 v3, 20, v2
    v_sub_u32 v3, v1, v3
    v_mul_u32_u24 v2, 3584, v2
    v_lshl_add_u32 v2, v3, 4, v2
    v_add_u32 v11, s57, v2
    v_subrev_u32 v11, 3072, v11
    v_add_u32 v1, s59, v0
    v_add_u32 v1, 256, v1
    v_mul_u32_u24 v2, 3277, v1
    v_lshrrev_b32 v2, 16, v2
    v_mul_u32_u24 v3, 20, v2
    v_sub_u32 v3, v1, v3
    v_mul_u32_u24 v2, 3584, v2
    v_lshl_add_u32 v2, v3, 4, v2
    v_add_u32 v12, s57, v2
    s_mul_i32 s55, s58, 5120
    s_lshr_b32 s58, s3, 1
    s_mul_i32 s58, s58, 10272
    s_add_u32 s55, s55, s58
    s_mul_i32 s61, s3, 20608
    s_and_b32 s88, s44, 3
    s_lshl_b32 s57, s43, 2
    s_add_u32 s88, s88, s57
    s_lshr_b32 s89, s44, 2
    s_mul_i32 s62, s3, 401408
    s_mul_i32 s63, s3, 100352
    s_mov_b32 s20, s82
    s_mov_b32 s21, s83
    s_mov_b32 s22, 9445376
    s_mov_b32 s23, 0x20000
    s_mov_b32 s24, s76
    s_mov_b32 s25, s77
    s_mov_b32 s26, 1605632
    s_mov_b32 s27, 0x20000
    s_mov_b32 s28, s68
    s_mov_b32 s29, s69
    s_mov_b32 s30, 401408
    s_mov_b32 s31, 0x20000
    s_mov_b32 s32, s78
    s_mov_b32 s33, s79
    s_mov_b32 s34, 1835008
    s_mov_b32 s35, 0x20000
    s_mov_b32 s36, s80
    s_mov_b32 s37, s81
    s_mov_b32 s38, 256
    s_mov_b32 s39, 0x20000
    s_mul_i32 s97, s88, 144
    s_mul_i32 s57, s3, 36
    s_add_u32 s97, s97, s57
    s_lshl_b32 s97, s97, 11
    s_add_u32 s57, s88, s89
    s_mov_b32 s57, 0
    s_and_b32 s58, s57, 3
    s_mul_i32 s59, s58, 71680
    s_add_u32 s59, s59, s62
    s_add_u32 s74, s59, 114688
    s_mul_i32 s59, s58, 10240
    s_add_u32 s78, s59, s97
    s_add_u32 s57, s57, 1
    s_and_b32 s58, s57, 3
    s_mul_i32 s59, s58, 71680
    s_add_u32 s59, s59, s62
    s_add_u32 s75, s59, 114688
    s_mul_i32 s59, s58, 10240
    s_add_u32 s79, s59, s97
    s_add_u32 s57, s57, 1
    s_and_b32 s58, s57, 3
    s_mul_i32 s59, s58, 71680
    s_add_u32 s59, s59, s62
    s_add_u32 s76, s59, 114688
    s_mul_i32 s59, s58, 10240
    s_add_u32 s80, s59, s97
    s_add_u32 s57, s57, 1
    s_and_b32 s58, s57, 3
    s_mul_i32 s59, s58, 71680
    s_add_u32 s59, s59, s62
    s_add_u32 s77, s59, 114688
    s_mul_i32 s59, s58, 10240
    s_add_u32 s81, s59, s97
    s_add_u32 s57, s57, 1
    s_lshr_b32 s57, s89, 1
    s_add_u32 s57, s57, s88
    s_mov_b32 s57, 0
    s_and_b32 s58, s57, 1
    s_mul_i32 s59, s58, 57344
    s_add_u32 s64, s59, s62
    s_mul_i32 s59, s58, 50176
    s_add_u32 s66, s59, s63
    s_lshl_b32 s59, s58, 14
    s_add_u32 s59, s59, s97
    s_add_u32 s82, s59, 40960
    s_add_u32 s57, s57, 1
    s_and_b32 s58, s57, 1
    s_mul_i32 s59, s58, 57344
    s_add_u32 s65, s59, s62
    s_mul_i32 s59, s58, 50176
    s_add_u32 s67, s59, s63
    s_lshl_b32 s59, s58, 14
    s_add_u32 s59, s59, s97
    s_add_u32 s83, s59, 40960
    s_add_u32 s57, s57, 1
    v_lshrrev_b32 v240, 3, v0
    v_mul_u32_u24 v240, 896, v240
    v_and_b32 v241, 7, v0
    v_lshrrev_b32 v242, 2, v0
    v_and_b32 v242, 4, v242
    v_xor_b32 v241, v241, v242
    v_lshl_add_u32 v15, v241, 4, v240
    s_lshl_b32 s57, s89, 7
    s_cmp_ge_u32 s44, 28
    s_cselect_b32 s57, 0x80000000, s57
    v_add_u32 v15, s57, v15
    v_add_u32 v233, 6144, v15
    v_lshrrev_b32 v240, 5, v0
    v_bfe_u32 v241, v0, 2, 2
    v_bfe_u32 v242, v0, 4, 1
    v_and_b32 v243, 3, v0
    v_lshlrev_b32 v243, 3, v243
    v_lshl_add_u32 v240, v240, 3, v241
    v_mul_u32_u24 v240, 320, v240
    v_mul_u32_u24 v242, 10272, v242
    v_add3_u32 v1, v240, v242, v243
    v_add_u32 v228, 41216, v1
    s_add_u32 m0, s60, 8192
    s_nop 0
    buffer_load_dwordx4 v234, s[4:7], s49 offen  lds
    s_add_u32 m0, s60, 9216
    s_add_u32 s58, s49, 14336
    buffer_load_dwordx4 v235, s[4:7], s58 offen  lds
    s_add_u32 m0, s60, 10240
    s_add_u32 s58, s49, 28672
    buffer_load_dwordx4 v234, s[4:7], s58 offen  lds
    s_add_u32 m0, s60, 11264
    s_add_u32 s58, s49, 43008
    buffer_load_dwordx4 v235, s[4:7], s58 offen  lds
    s_add_u32 s45, s45, 128
    s_cmp_eq_u32 s45, 896
    s_cselect_b32 s45, 0, s45
    s_add_u32 s49, s48, s45
    s_add_u32 m0, s60, 12288
    s_nop 0
    buffer_load_dwordx4 v234, s[4:7], s49 offen  lds
    s_add_u32 m0, s60, 13312
    s_add_u32 s58, s49, 14336
    buffer_load_dwordx4 v235, s[4:7], s58 offen  lds
    s_add_u32 m0, s60, 14336
    s_add_u32 s58, s49, 28672
    buffer_load_dwordx4 v234, s[4:7], s58 offen  lds
    s_add_u32 m0, s60, 15360
    s_add_u32 s58, s49, 43008
    buffer_load_dwordx4 v235, s[4:7], s58 offen  lds
    s_add_u32 s45, s45, 128
    s_cmp_eq_u32 s45, 896
    s_cselect_b32 s45, 0, s45
    s_add_u32 s49, s48, s45
    s_waitcnt vmcnt(12)
    ds_read_b128 v[16:19], v236 offset:0
    ds_read_b128 v[20:23], v237 offset:0
    ds_read_b128 v[24:27], v238 offset:0
    ds_read_b128 v[28:31], v239 offset:0
    ds_read_b128 a[0:3], v236 offset:0
    ds_read_b128 a[4:7], v237 offset:0
    ds_read_b128 a[8:11], v238 offset:0
    ds_read_b128 a[12:15], v239 offset:0
    s_waitcnt vmcnt(8)
    ds_read_b128 v[32:35], v236 offset:4096
    ds_read_b128 v[36:39], v237 offset:4096
    ds_read_b128 v[40:43], v238 offset:4096
    ds_read_b128 v[44:47], v239 offset:4096
    ds_read_b128 a[16:19], v236 offset:4096
    ds_read_b128 a[20:23], v237 offset:4096
    ds_read_b128 a[24:27], v238 offset:4096
    ds_read_b128 a[28:31], v239 offset:4096
    s_waitcnt lgkmcnt(8)
    s_add_u32 m0, s60, 0
    s_nop 0
    buffer_load_dwordx4 v234, s[4:7], s49 offen  lds
    s_add_u32 m0, s60, 1024
    s_add_u32 s58, s49, 14336
    buffer_load_dwordx4 v235, s[4:7], s58 offen  lds
    s_add_u32 m0, s60, 2048
    s_add_u32 s58, s49, 28672
    buffer_load_dwordx4 v234, s[4:7], s58 offen  lds
    s_add_u32 m0, s60, 3072
    s_add_u32 s58, s49, 43008
    buffer_load_dwordx4 v235, s[4:7], s58 offen  lds
    s_add_u32 s45, s45, 128
    s_cmp_eq_u32 s45, 896
    s_cselect_b32 s45, 0, s45
    s_add_u32 s49, s48, s45
    v_dot2c_f32_bf16 v200, v16, v16
    v_dot2c_f32_bf16 v202, s54, v16
    v_dot2c_f32_bf16 v201, v17, v17
    v_dot2c_f32_bf16 v203, s54, v17
    v_dot2c_f32_bf16 v200, v18, v18
    v_dot2c_f32_bf16 v202, s54, v18
    v_dot2c_f32_bf16 v201, v19, v19
    v_dot2c_f32_bf16 v203, s54, v19
    v_dot2c_f32_bf16 v200, v20, v20
    v_dot2c_f32_bf16 v202, s54, v20
    v_dot2c_f32_bf16 v201, v21, v21
    v_dot2c_f32_bf16 v203, s54, v21
    v_dot2c_f32_bf16 v200, v22, v22
    v_dot2c_f32_bf16 v202, s54, v22
    v_dot2c_f32_bf16 v201, v23, v23
    v_dot2c_f32_bf16 v203, s54, v23
    v_dot2c_f32_bf16 v200, v24, v24
    v_dot2c_f32_bf16 v202, s54, v24
    v_dot2c_f32_bf16 v201, v25, v25
    v_dot2c_f32_bf16 v203, s54, v25
    v_dot2c_f32_bf16 v200, v26, v26
    v_dot2c_f32_bf16 v202, s54, v26
    v_dot2c_f32_bf16 v201, v27, v27
    v_dot2c_f32_bf16 v203, s54, v27
    v_dot2c_f32_bf16 v200, v28, v28
    v_dot2c_f32_bf16 v202, s54, v28
    v_dot2c_f32_bf16 v201, v29, v29
    v_dot2c_f32_bf16 v203, s54, v29
    v_dot2c_f32_bf16 v200, v30, v30
    v_dot2c_f32_bf16 v202, s54, v30
    v_dot2c_f32_bf16 v201, v31, v31
    v_dot2c_f32_bf16 v203, s54, v31
    s_waitcnt vmcnt(8)
    ds_read_b128 v[16:19], v236 offset:8192
    ds_read_b128 v[20:23], v237 offset:8192
    ds_read_b128 v[24:27], v238 offset:8192
    ds_read_b128 v[28:31], v239 offset:8192
    ds_read_b128 a[32:35], v236 offset:8192
    ds_read_b128 a[36:39], v237 offset:8192
    ds_read_b128 a[40:43], v238 offset:8192
    ds_read_b128 a[44:47], v239 offset:8192
    s_waitcnt lgkmcnt(8)
    s_add_u32 m0, s60, 4096
    s_nop 0
    buffer_load_dwordx4 v234, s[4:7], s49 offen  lds
    s_add_u32 m0, s60, 5120
    s_add_u32 s58, s49, 14336
    buffer_load_dwordx4 v235, s[4:7], s58 offen  lds
    s_add_u32 m0, s60, 6144
    s_add_u32 s58, s49, 28672
    buffer_load_dwordx4 v234, s[4:7], s58 offen  lds
    s_add_u32 m0, s60, 7168
    s_add_u32 s58, s49, 43008
    buffer_load_dwordx4 v235, s[4:7], s58 offen  lds
    s_add_u32 s45, s45, 128
    s_cmp_eq_u32 s45, 896
    s_cselect_b32 s45, 0, s45
    s_add_u32 s49, s48, s45
    v_dot2c_f32_bf16 v200, v32, v32
    v_dot2c_f32_bf16 v202, s54, v32
    v_dot2c_f32_bf16 v201, v33, v33
    v_dot2c_f32_bf16 v203, s54, v33
    v_dot2c_f32_bf16 v200, v34, v34
    v_dot2c_f32_bf16 v202, s54, v34
    v_dot2c_f32_bf16 v201, v35, v35
    v_dot2c_f32_bf16 v203, s54, v35
    v_dot2c_f32_bf16 v200, v36, v36
    v_dot2c_f32_bf16 v202, s54, v36
    v_dot2c_f32_bf16 v201, v37, v37
    v_dot2c_f32_bf16 v203, s54, v37
    v_dot2c_f32_bf16 v200, v38, v38
    v_dot2c_f32_bf16 v202, s54, v38
    v_dot2c_f32_bf16 v201, v39, v39
    v_dot2c_f32_bf16 v203, s54, v39
    v_dot2c_f32_bf16 v200, v40, v40
    v_dot2c_f32_bf16 v202, s54, v40
    v_dot2c_f32_bf16 v201, v41, v41
    v_dot2c_f32_bf16 v203, s54, v41
    v_dot2c_f32_bf16 v200, v42, v42
    v_dot2c_f32_bf16 v202, s54, v42
    v_dot2c_f32_bf16 v201, v43, v43
    v_dot2c_f32_bf16 v203, s54, v43
    v_dot2c_f32_bf16 v200, v44, v44
    v_dot2c_f32_bf16 v202, s54, v44
    v_dot2c_f32_bf16 v201, v45, v45
    v_dot2c_f32_bf16 v203, s54, v45
    v_dot2c_f32_bf16 v200, v46, v46
    v_dot2c_f32_bf16 v202, s54, v46
    v_dot2c_f32_bf16 v201, v47, v47
    v_dot2c_f32_bf16 v203, s54, v47
    s_waitcnt vmcnt(8)
    ds_read_b128 v[32:35], v236 offset:12288
    ds_read_b128 v[36:39], v237 offset:12288
    ds_read_b128 v[40:43], v238 offset:12288
    ds_read_b128 v[44:47], v239 offset:12288
    ds_read_b128 a[48:51], v236 offset:12288
    ds_read_b128 a[52:55], v237 offset:12288
    ds_read_b128 a[56:59], v238 offset:12288
    ds_read_b128 a[60:63], v239 offset:12288
    s_waitcnt lgkmcnt(8)
    s_add_u32 m0, s60, 8192
    s_nop 0
    buffer_load_dwordx4 v234, s[4:7], s49 offen  lds
    s_add_u32 m0, s60, 9216
    s_add_u32 s58, s49, 14336
    buffer_load_dwordx4 v235, s[4:7], s58 offen  lds
    s_add_u32 m0, s60, 10240
    s_add_u32 s58, s49, 28672
    buffer_load_dwordx4 v234, s[4:7], s58 offen  lds
    s_add_u32 m0, s60, 11264
    s_add_u32 s58, s49, 43008
    buffer_load_dwordx4 v235, s[4:7], s58 offen  lds
    s_add_u32 s45, s45, 128
    s_cmp_eq_u32 s45, 896
    s_cselect_b32 s45, 0, s45
    s_add_u32 s49, s48, s45
    v_dot2c_f32_bf16 v200, v16, v16
    v_dot2c_f32_bf16 v202, s54, v16
    v_dot2c_f32_bf16 v201, v17, v17
    v_dot2c_f32_bf16 v203, s54, v17
    v_dot2c_f32_bf16 v200, v18, v18
    v_dot2c_f32_bf16 v202, s54, v18
    v_dot2c_f32_bf16 v201, v19, v19
    v_dot2c_f32_bf16 v203, s54, v19
    v_dot2c_f32_bf16 v200, v20, v20
    v_dot2c_f32_bf16 v202, s54, v20
    v_dot2c_f32_bf16 v201, v21, v21
    v_dot2c_f32_bf16 v203, s54, v21
    v_dot2c_f32_bf16 v200, v22, v22
    v_dot2c_f32_bf16 v202, s54, v22
    v_dot2c_f32_bf16 v201, v23, v23
    v_dot2c_f32_bf16 v203, s54, v23
    v_dot2c_f32_bf16 v200, v24, v24
    v_dot2c_f32_bf16 v202, s54, v24
    v_dot2c_f32_bf16 v201, v25, v25
    v_dot2c_f32_bf16 v203, s54, v25
    v_dot2c_f32_bf16 v200, v26, v26
    v_dot2c_f32_bf16 v202, s54, v26
    v_dot2c_f32_bf16 v201, v27, v27
    v_dot2c_f32_bf16 v203, s54, v27
    v_dot2c_f32_bf16 v200, v28, v28
    v_dot2c_f32_bf16 v202, s54, v28
    v_dot2c_f32_bf16 v201, v29, v29
    v_dot2c_f32_bf16 v203, s54, v29
    v_dot2c_f32_bf16 v200, v30, v30
    v_dot2c_f32_bf16 v202, s54, v30
    v_dot2c_f32_bf16 v201, v31, v31
    v_dot2c_f32_bf16 v203, s54, v31
    s_waitcnt vmcnt(8)
    ds_read_b128 v[16:19], v236 offset:0
    ds_read_b128 v[20:23], v237 offset:0
    ds_read_b128 v[24:27], v238 offset:0
    ds_read_b128 v[28:31], v239 offset:0
    ds_read_b128 a[64:67], v236 offset:0
    ds_read_b128 a[68:71], v237 offset:0
    ds_read_b128 a[72:75], v238 offset:0
    ds_read_b128 a[76:79], v239 offset:0
    s_waitcnt lgkmcnt(12)
    v_dot2c_f32_bf16 v200, v32, v32
    v_dot2c_f32_bf16 v202, s54, v32
    v_dot2c_f32_bf16 v201, v33, v33
    v_dot2c_f32_bf16 v203, s54, v33
    v_dot2c_f32_bf16 v200, v34, v34
    v_dot2c_f32_bf16 v202, s54, v34
    v_dot2c_f32_bf16 v201, v35, v35
    v_dot2c_f32_bf16 v203, s54, v35
    v_dot2c_f32_bf16 v200, v36, v36
    v_dot2c_f32_bf16 v202, s54, v36
    v_dot2c_f32_bf16 v201, v37, v37
    v_dot2c_f32_bf16 v203, s54, v37
    v_dot2c_f32_bf16 v200, v38, v38
    v_dot2c_f32_bf16 v202, s54, v38
    v_dot2c_f32_bf16 v201, v39, v39
    v_dot2c_f32_bf16 v203, s54, v39
    v_dot2c_f32_bf16 v200, v40, v40
    v_dot2c_f32_bf16 v202, s54, v40
    v_dot2c_f32_bf16 v201, v41, v41
    v_dot2c_f32_bf16 v203, s54, v41
    v_dot2c_f32_bf16 v200, v42, v42
    v_dot2c_f32_bf16 v202, s54, v42
    v_dot2c_f32_bf16 v201, v43, v43
    v_dot2c_f32_bf16 v203, s54, v43
    v_dot2c_f32_bf16 v200, v44, v44
    v_dot2c_f32_bf16 v202, s54, v44
    v_dot2c_f32_bf16 v201, v45, v45
    v_dot2c_f32_bf16 v203, s54, v45
    v_dot2c_f32_bf16 v200, v46, v46
    v_dot2c_f32_bf16 v202, s54, v46
    v_dot2c_f32_bf16 v201, v47, v47
    v_dot2c_f32_bf16 v203, s54, v47
    s_waitcnt vmcnt(4)
    ds_read_b128 v[32:35], v236 offset:4096
    ds_read_b128 v[36:39], v237 offset:4096
    ds_read_b128 v[40:43], v238 offset:4096
    ds_read_b128 v[44:47], v239 offset:4096
    ds_read_b128 a[80:83], v236 offset:4096
    ds_read_b128 a[84:87], v237 offset:4096
    ds_read_b128 a[88:91], v238 offset:4096
    ds_read_b128 a[92:95], v239 offset:4096
    s_add_u32 m0, s55, 0
    s_nop 0
    buffer_load_dwordx4 v8, s[8:11], s50 offen offset:0  lds
    buffer_load_dwordx4 v9, s[8:11], s50 offen offset:1024  lds
    s_waitcnt lgkmcnt(12)
    v_dot2c_f32_bf16 v200, v16, v16
    v_dot2c_f32_bf16 v202, s54, v16
    v_dot2c_f32_bf16 v201, v17, v17
    v_dot2c_f32_bf16 v203, s54, v17
    v_dot2c_f32_bf16 v200, v18, v18
    v_dot2c_f32_bf16 v202, s54, v18
    v_dot2c_f32_bf16 v201, v19, v19
    v_dot2c_f32_bf16 v203, s54, v19
    v_dot2c_f32_bf16 v200, v20, v20
    v_dot2c_f32_bf16 v202, s54, v20
    v_dot2c_f32_bf16 v201, v21, v21
    v_dot2c_f32_bf16 v203, s54, v21
    v_dot2c_f32_bf16 v200, v22, v22
    v_dot2c_f32_bf16 v202, s54, v22
    v_dot2c_f32_bf16 v201, v23, v23
    v_dot2c_f32_bf16 v203, s54, v23
    v_dot2c_f32_bf16 v200, v24, v24
    v_dot2c_f32_bf16 v202, s54, v24
    v_dot2c_f32_bf16 v201, v25, v25
    v_dot2c_f32_bf16 v203, s54, v25
    v_dot2c_f32_bf16 v200, v26, v26
    v_dot2c_f32_bf16 v202, s54, v26
    v_dot2c_f32_bf16 v201, v27, v27
    v_dot2c_f32_bf16 v203, s54, v27
    v_dot2c_f32_bf16 v200, v28, v28
    v_dot2c_f32_bf16 v202, s54, v28
    v_dot2c_f32_bf16 v201, v29, v29
    v_dot2c_f32_bf16 v203, s54, v29
    v_dot2c_f32_bf16 v200, v30, v30
    v_dot2c_f32_bf16 v202, s54, v30
    v_dot2c_f32_bf16 v201, v31, v31
    v_dot2c_f32_bf16 v203, s54, v31
    s_waitcnt vmcnt(2)
    ds_read_b128 v[16:19], v236 offset:8192
    ds_read_b128 v[20:23], v237 offset:8192
    ds_read_b128 v[24:27], v238 offset:8192
    ds_read_b128 v[28:31], v239 offset:8192
    ds_read_b128 a[96:99], v236 offset:8192
    ds_read_b128 a[100:103], v237 offset:8192
    ds_read_b128 a[104:107], v238 offset:8192
    ds_read_b128 a[108:111], v239 offset:8192
    buffer_load_dwordx4 v10, s[8:11], s50 offen offset:2048  lds
    buffer_load_dwordx4 v11, s[8:11], s50 offen offset:3072  lds
    s_add_u32 m0, s55, 4096
    s_nop 0
    buffer_load_dwordx4 v12, s[8:11], s50 offen  lds
    s_waitcnt lgkmcnt(12)
    v_dot2c_f32_bf16 v200, v32, v32
    v_dot2c_f32_bf16 v202, s54, v32
    v_dot2c_f32_bf16 v201, v33, v33
    v_dot2c_f32_bf16 v203, s54, v33
    v_dot2c_f32_bf16 v200, v34, v34
    v_dot2c_f32_bf16 v202, s54, v34
    v_dot2c_f32_bf16 v201, v35, v35
    v_dot2c_f32_bf16 v203, s54, v35
    v_dot2c_f32_bf16 v200, v36, v36
    v_dot2c_f32_bf16 v202, s54, v36
    v_dot2c_f32_bf16 v201, v37, v37
    v_dot2c_f32_bf16 v203, s54, v37
    v_dot2c_f32_bf16 v200, v38, v38
    v_dot2c_f32_bf16 v202, s54, v38
    v_dot2c_f32_bf16 v201, v39, v39
    v_dot2c_f32_bf16 v203, s54, v39
    v_dot2c_f32_bf16 v200, v40, v40
    v_dot2c_f32_bf16 v202, s54, v40
    v_dot2c_f32_bf16 v201, v41, v41
    v_dot2c_f32_bf16 v203, s54, v41
    v_dot2c_f32_bf16 v200, v42, v42
    v_dot2c_f32_bf16 v202, s54, v42
    v_dot2c_f32_bf16 v201, v43, v43
    v_dot2c_f32_bf16 v203, s54, v43
    v_dot2c_f32_bf16 v200, v44, v44
    v_dot2c_f32_bf16 v202, s54, v44
    v_dot2c_f32_bf16 v201, v45, v45
    v_dot2c_f32_bf16 v203, s54, v45
    v_dot2c_f32_bf16 v200, v46, v46
    v_dot2c_f32_bf16 v202, s54, v46
    v_dot2c_f32_bf16 v201, v47, v47
    v_dot2c_f32_bf16 v203, s54, v47
    s_waitcnt lgkmcnt(4)
    v_dot2c_f32_bf16 v200, v16, v16
    v_dot2c_f32_bf16 v202, s54, v16
    v_dot2c_f32_bf16 v201, v17, v17
    v_dot2c_f32_bf16 v203, s54, v17
    v_dot2c_f32_bf16 v200, v18, v18
    v_dot2c_f32_bf16 v202, s54, v18
    v_dot2c_f32_bf16 v201, v19, v19
    v_dot2c_f32_bf16 v203, s54, v19
    v_dot2c_f32_bf16 v200, v20, v20
    v_dot2c_f32_bf16 v202, s54, v20
    v_dot2c_f32_bf16 v201, v21, v21
    v_dot2c_f32_bf16 v203, s54, v21
    v_dot2c_f32_bf16 v200, v22, v22
    v_dot2c_f32_bf16 v202, s54, v22
    v_dot2c_f32_bf16 v201, v23, v23
    v_dot2c_f32_bf16 v203, s54, v23
    v_dot2c_f32_bf16 v200, v24, v24
    v_dot2c_f32_bf16 v202, s54, v24
    v_dot2c_f32_bf16 v201, v25, v25
    v_dot2c_f32_bf16 v203, s54, v25
    v_dot2c_f32_bf16 v200, v26, v26
    v_dot2c_f32_bf16 v202, s54, v26
    v_dot2c_f32_bf16 v201, v27, v27
    v_dot2c_f32_bf16 v203, s54, v27
    v_dot2c_f32_bf16 v200, v28, v28
    v_dot2c_f32_bf16 v202, s54, v28
    v_dot2c_f32_bf16 v201, v29, v29
    v_dot2c_f32_bf16 v203, s54, v29
    v_dot2c_f32_bf16 v200, v30, v30
    v_dot2c_f32_bf16 v202, s54, v30
    v_dot2c_f32_bf16 v201, v31, v31
    v_dot2c_f32_bf16 v203, s54, v31
    s_add_u32 s50, s50, s98
    s_nop 0
    v_add_f32 v200, v200, v201
    v_add_f32 v202, v202, v203
    v_mov_b32 v201, v200
    v_mov_b32 v203, v202
    s_nop 0
    v_permlane32_swap_b32 v200, v201
    v_permlane32_swap_b32 v202, v203
    v_add_f32 v200, v200, v201
    v_add_f32 v202, v202, v203
    v_mul_f32 v202, 0x3b124925, v202
    v_mul_f32 v200, 0x3b124925, v200
    v_fma_f32 v200, -v202, v202, v200
    v_max_f32 v200, 0, v200
    v_add_f32 v200, 0x3727c5ac, v200
    v_rsq_f32 v13, v200
    s_nop 0
    v_mul_f32 v201, v202, v13
    v_sub_f32 v14, 0, v201
    s_lshr_b32 s57, s3, 1
    v_lshrrev_b32 v240, 5, v0
    v_bfe_u32 v241, v0, 2, 2
    v_lshl_add_u32 v240, v240, 2, v241
    v_lshlrev_b32 v240, 7, v240
    v_bfe_u32 v241, v0, 4, 1
    v_and_b32 v242, 3, v0
    v_lshlrev_b32 v242, 3, v242
    v_lshl_add_u32 v241, v241, 5, v242
    v_bfe_u32 v242, v0, 3, 1
    v_xor_b32 v242, s57, v242
    v_lshlrev_b32 v242, 6, v242
    v_add3_u32 v240, v240, v241, v242
    v_add_u32 v244, s60, v240
    v_add_u32 v246, s61, v240
    v_xor_b32 v240, 64, v240
    v_add_u32 v245, s60, v240
    v_add_u32 v247, s61, v240
    v_and_b32 v240, 31, v0
    s_and_b32 s57, s3, 1
    s_lshl_b32 s58, s88, 6
    s_add_u32 s57, s57, s58
    v_lshl_add_u32 v240, v240, 1, s57
    v_mul_u32_u24 v240, 896, v240
    v_lshrrev_b32 v241, 5, v0
    v_lshl_add_u32 v240, v241, 3, v240
    s_lshr_b32 s57, s3, 1
    s_lshl_b32 s57, s57, 6
    s_lshl_b32 s58, s89, 7
    s_add_u32 s57, s57, s58
    v_add_u32 v248, s57, v240
    s_and_b32 s59, s3, 1
    s_lshl_b32 s58, s88, 6
    s_add_u32 s59, s59, s58
    v_lshrrev_b32 v240, 2, v0
    v_lshl_add_u32 v240, v240, 1, s59
    v_mul_u32_u24 v240, 896, v240
    v_and_b32 v241, 3, v0
    v_lshl_add_u32 v240, v241, 4, v240
    v_add_u32 v249, s57, v240
    s_mov_b32 s84, 0xbdd2d3e8
    s_mov_b32 s85, 0xbdd2d3e8
    s_lshr_b32 s57, s3, 1
    s_lshl_b32 s56, s40, 1
    s_add_u32 s56, s56, s57
    s_mul_i32 s56, s56, 144
    s_mul_i32 s58, s42, 36
    s_add_u32 s56, s56, s58
    s_mul_i32 s58, s41, 10
    s_add_u32 s56, s56, s58
    s_lshl_b32 s56, s56, 1
    s_and_b32 s58, s3, 1
    s_add_u32 s56, s56, s58
    s_lshl_b32 s56, s56, 10
    v_mov_b32 v250, 0xc0135761
    v_mov_b32 v251, 0xc0135761
    v_lshlrev_b32 v252, 4, v0
    s_lshl_b32 s58, s58, 10
    s_cmp_ge_u32 s44, 28
    s_cselect_b32 s58, 0x80000000, s58
    v_add_u32 v254, s58, v252
    s_lshr_b32 s57, s88, 1
    s_lshl_b32 s57, s57, 2
    s_add_u32 s57, s57, s3
    s_lshl_b32 s57, s57, 7
    v_and_b32 v253, 3, v0
    v_lshl_add_u32 v253, v253, 2, s57
    s_mov_b32 s49, 9437184
    v_accvgpr_read_b32 v204, a0
    v_accvgpr_read_b32 v205, a1
    v_accvgpr_read_b32 v206, a2
    v_accvgpr_read_b32 v207, a3
    v_lshlrev_b32 v200, 16, v204
    v_lshlrev_b32 v201, 16, v205
    v_lshlrev_b32 v202, 16, v206
    v_lshlrev_b32 v203, 16, v207
    v_and_b32 v204, s53, v204
    v_and_b32 v205, s53, v205
    v_and_b32 v206, s53, v206
    v_and_b32 v207, s53, v207
    v_fma_f32 v200, v200, v13, v14
    v_fma_f32 v201, v201, v13, v14
    v_fma_f32 v202, v202, v13, v14
    v_fma_f32 v203, v203, v13, v14
    v_fma_f32 v204, v204, v13, v14
    v_fma_f32 v205, v205, v13, v14
    v_fma_f32 v206, v206, v13, v14
    v_fma_f32 v207, v207, v13, v14
    v_cvt_pk_bf16_f32 v192, v200, v204
    v_cvt_pk_bf16_f32 v193, v201, v205
    v_cvt_pk_bf16_f32 v194, v202, v206
    v_cvt_pk_bf16_f32 v195, v203, v207
    v_accvgpr_write_b32 a0, v192
    v_accvgpr_write_b32 a1, v193
    v_accvgpr_write_b32 a2, v194
    v_accvgpr_write_b32 a3, v195
    s_add_u32 m0, s55, 20608
    s_nop 0
    buffer_load_dwordx4 v8, s[8:11], s50 offen offset:0  lds
    buffer_load_dwordx4 v9, s[8:11], s50 offen offset:1024  lds
    buffer_load_dwordx4 v10, s[8:11], s50 offen offset:2048  lds
    buffer_load_dwordx4 v11, s[8:11], s50 offen offset:3072  lds
    s_add_u32 m0, s55, 24704
    s_nop 0
    buffer_load_dwordx4 v12, s[8:11], s50 offen  lds
    s_add_u32 s50, s50, s99
    s_cmp_ge_u32 s50, 1605632
    s_cselect_b32 s50, s96, s50
    s_lshr_b32 s57, s88, 1
    s_lshl_b32 s57, s57, 2
    s_add_u32 s57, s57, s3
    s_lshl_b32 s57, s57, 7
    s_lshl_b32 s58, s40, 2
    s_add_u32 s58, s58, s42
    s_lshl_b32 s58, s58, 5
    s_add_u32 s58, s58, s41
    s_lshl_b32 s58, s58, 2
    v_and_b32 v242, 3, v0
    v_lshl_add_u32 v242, v242, 2, s57
    v_writelane_b32 v242, s58, 4
    s_mov_b32 s57, 9437184
    buffer_load_dword v243, v242, s[20:23], s57 offen sc1
    s_lshl_b32 s57, s2, 2
    s_add_u32 s57, s57, s3
    s_mul_i32 s58, s57, 1664
    v_min_u32 v199, 25, v0
    v_lshlrev_b32 v199, 6, v199
    buffer_load_dword a254, v199, s[24:27], s58 offen
    s_lshl_b32 s58, s57, 9
    v_min_u32 v199, 448, v199
    buffer_load_dword a253, v199, s[28:31], s58 offen
    s_waitcnt vmcnt(8) lgkmcnt(0)
    s_barrier
    ds_read_b64_tr_b16 a[112:113], v1 offset:0
    ds_read_b64_tr_b16 a[114:115], v1 offset:1280
    ds_read_b64_tr_b16 a[116:117], v1 offset:32
    ds_read_b64_tr_b16 a[118:119], v1 offset:1312
    ds_read_b64_tr_b16 a[120:121], v1 offset:64
    ds_read_b64_tr_b16 a[122:123], v1 offset:1344
    ds_read_b64_tr_b16 a[124:125], v1 offset:96
    ds_read_b64_tr_b16 a[126:127], v1 offset:1376
    ds_read_b64_tr_b16 a[128:129], v1 offset:128
    ds_read_b64_tr_b16 a[130:131], v1 offset:1408
    ds_read_b64_tr_b16 a[132:133], v1 offset:160
    ds_read_b64_tr_b16 a[134:135], v1 offset:1440
    ds_read_b64_tr_b16 a[136:137], v1 offset:192
    ds_read_b64_tr_b16 a[138:139], v1 offset:1472
    v_accvgpr_read_b32 v204, a4
    v_accvgpr_read_b32 v205, a5
    v_accvgpr_read_b32 v206, a6
    s_waitcnt lgkmcnt(12)
    v_mfma_f32_32x32x16_bf16 v[16:31], a[112:115], a[0:3], 0
    s_waitcnt lgkmcnt(6)
    ds_read_b64_tr_b16 a[140:141], v1 offset:224
    ds_read_b64_tr_b16 a[142:143], v1 offset:1504
    v_accvgpr_read_b32 v207, a7
    v_lshlrev_b32 v200, 16, v204
    v_lshlrev_b32 v201, 16, v205
    v_mfma_f32_32x32x16_bf16 v[32:47], a[116:119], a[0:3], 0
    ds_read_b64_tr_b16 a[144:145], v1 offset:256
    ds_read_b64_tr_b16 a[146:147], v1 offset:1536
    ds_read_b64_tr_b16 a[148:149], v1 offset:288
    v_lshlrev_b32 v202, 16, v206
    v_lshlrev_b32 v203, 16, v207
    v_and_b32 v204, s53, v204
    v_mfma_f32_32x32x16_bf16 v[48:63], a[120:123], a[0:3], 0
    ds_read_b64_tr_b16 a[150:151], v1 offset:1568
    ds_read_b64_tr_b16 a[152:153], v1 offset:5120
    ds_read_b64_tr_b16 a[154:155], v1 offset:6400
    v_and_b32 v205, s53, v205
    v_and_b32 v206, s53, v206
    v_and_b32 v207, s53, v207
    v_mfma_f32_32x32x16_bf16 v[64:79], a[124:127], a[0:3], 0
    s_waitcnt lgkmcnt(8)
    ds_read_b64_tr_b16 a[156:157], v1 offset:5152
    ds_read_b64_tr_b16 a[158:159], v1 offset:6432
    v_fma_f32 v200, v200, v13, v14
    v_fma_f32 v201, v201, v13, v14
    v_fma_f32 v202, v202, v13, v14
    v_mfma_f32_32x32x16_bf16 v[80:95], a[128:131], a[0:3], 0
    ds_read_b64_tr_b16 a[112:113], v1 offset:5184
    ds_read_b64_tr_b16 a[114:115], v1 offset:6464
    ds_read_b64_tr_b16 a[116:117], v1 offset:5216
    v_fma_f32 v203, v203, v13, v14
    v_fma_f32 v204, v204, v13, v14
    v_fma_f32 v205, v205, v13, v14
    v_mfma_f32_32x32x16_bf16 v[96:111], a[132:135], a[0:3], 0
    s_add_u32 m0, s55, 41216
    ds_read_b64_tr_b16 a[118:119], v1 offset:6496
    buffer_load_dwordx4 v8, s[8:11], s50 offen offset:0  lds
    v_fma_f32 v206, v206, v13, v14
    v_fma_f32 v207, v207, v13, v14
    v_cvt_pk_bf16_f32 v196, v200, v204
    v_mfma_f32_32x32x16_bf16 v[112:127], a[136:139], a[0:3], 0
    s_waitcnt lgkmcnt(8)
    ds_read_b64_tr_b16 a[120:121], v1 offset:5248
    ds_read_b64_tr_b16 a[122:123], v1 offset:6528
    ds_read_b64_tr_b16 a[124:125], v1 offset:5280
    v_cvt_pk_bf16_f32 v197, v201, v205
    v_cvt_pk_bf16_f32 v198, v202, v206
    v_mfma_f32_32x32x16_bf16 v[128:143], a[140:143], a[0:3], 0
    ds_read_b64_tr_b16 a[126:127], v1 offset:6560
    ds_read_b64_tr_b16 a[128:129], v1 offset:5312
    ds_read_b64_tr_b16 a[130:131], v1 offset:6592
    buffer_load_dwordx4 v9, s[8:11], s50 offen offset:1024  lds
    v_cvt_pk_bf16_f32 v199, v203, v207
    v_mfma_f32_32x32x16_bf16 v[144:159], a[144:147], a[0:3], 0
    v_mfma_f32_32x32x16_bf16 v[160:175], a[148:151], a[0:3], 0
    s_waitcnt lgkmcnt(8)
    ds_read_b64_tr_b16 a[132:133], v1 offset:5344
    buffer_load_dwordx4 v10, s[8:11], s50 offen offset:2048  lds
    v_accvgpr_read_b32 v204, a8
    v_accvgpr_read_b32 v205, a9
    v_accvgpr_read_b32 v206, a10
    v_mfma_f32_32x32x16_bf16 v[16:31], a[152:155], v[196:199], v[16:31]
    ds_read_b64_tr_b16 a[134:135], v1 offset:6624
    ds_read_b64_tr_b16 a[136:137], v1 offset:5376
    ds_read_b64_tr_b16 a[138:139], v1 offset:6656
    v_accvgpr_read_b32 v207, a11
    v_lshlrev_b32 v200, 16, v204
    v_lshlrev_b32 v201, 16, v205
    v_mfma_f32_32x32x16_bf16 v[32:47], a[156:159], v[196:199], v[32:47]
    ds_read_b64_tr_b16 a[140:141], v1 offset:5408
    ds_read_b64_tr_b16 a[142:143], v1 offset:6688
    buffer_load_dwordx4 v11, s[8:11], s50 offen offset:3072  lds
    v_lshlrev_b32 v202, 16, v206
    v_lshlrev_b32 v203, 16, v207
    v_and_b32 v204, s53, v204
    v_mfma_f32_32x32x16_bf16 v[48:63], a[112:115], v[196:199], v[48:63]
    s_waitcnt lgkmcnt(8)
    s_add_u32 m0, s55, 45312
    v_and_b32 v205, s53, v205
    v_and_b32 v206, s53, v206
    v_and_b32 v207, s53, v207
    v_fma_f32 v200, v200, v13, v14
    v_mfma_f32_32x32x16_bf16 v[64:79], a[116:119], v[196:199], v[64:79]
    buffer_load_dwordx4 v12, s[8:11], s50 offen  lds
    v_fma_f32 v201, v201, v13, v14
    v_fma_f32 v202, v202, v13, v14
    v_fma_f32 v203, v203, v13, v14
    v_fma_f32 v204, v204, v13, v14
    v_fma_f32 v205, v205, v13, v14
    v_mfma_f32_32x32x16_bf16 v[80:95], a[120:123], v[196:199], v[80:95]
    s_waitcnt vmcnt(8) lgkmcnt(0)
    s_barrier
    ds_read_b64_tr_b16 a[144:145], v1 offset:20608
    ds_read_b64_tr_b16 a[146:147], v1 offset:21888
    v_fma_f32 v206, v206, v13, v14
    v_fma_f32 v207, v207, v13, v14
    v_mfma_f32_32x32x16_bf16 v[96:111], a[124:127], v[196:199], v[96:111]
    s_add_u32 s50, s50, s98
    ds_read_b64_tr_b16 a[148:149], v1 offset:20640
    ds_read_b64_tr_b16 a[150:151], v1 offset:21920
    ds_read_b64_tr_b16 a[152:153], v1 offset:20672
    v_cvt_pk_bf16_f32 v192, v200, v204
    v_cvt_pk_bf16_f32 v193, v201, v205
    v_mfma_f32_32x32x16_bf16 v[112:127], a[128:131], v[196:199], v[112:127]
    s_add_u32 m0, s55, 61824
    ds_read_b64_tr_b16 a[154:155], v1 offset:21952
    ds_read_b64_tr_b16 a[156:157], v1 offset:20704
    ds_read_b64_tr_b16 a[158:159], v1 offset:21984
    buffer_load_dwordx4 v8, s[8:11], s50 offen offset:0  lds
    v_cvt_pk_bf16_f32 v194, v202, v206
    v_mfma_f32_32x32x16_bf16 v[128:143], a[132:135], v[196:199], v[128:143]
    ds_read_b64_tr_b16 a[112:113], v1 offset:20736
    ds_read_b64_tr_b16 a[114:115], v1 offset:22016
    ds_read_b64_tr_b16 a[116:117], v1 offset:20768
    v_cvt_pk_bf16_f32 v195, v203, v207
    v_mfma_f32_32x32x16_bf16 v[144:159], a[136:139], v[196:199], v[144:159]
    ds_read_b64_tr_b16 a[118:119], v1 offset:22048
    ds_read_b64_tr_b16 a[120:121], v1 offset:20800
    ds_read_b64_tr_b16 a[122:123], v1 offset:22080
    buffer_load_dwordx4 v9, s[8:11], s50 offen offset:1024  lds
    v_mfma_f32_32x32x16_bf16 v[160:175], a[140:143], v[196:199], v[160:175]
    s_waitcnt lgkmcnt(8)
    ds_read_b64_tr_b16 a[124:125], v1 offset:20832
    ds_read_b64_tr_b16 a[126:127], v1 offset:22112
    v_accvgpr_read_b32 v204, a12
    v_accvgpr_read_b32 v205, a13
    v_accvgpr_read_b32 v206, a14
    v_mfma_f32_32x32x16_bf16 v[16:31], a[144:147], v[192:195], v[16:31]
    ds_read_b64_tr_b16 a[128:129], v1 offset:20864
    ds_read_b64_tr_b16 a[130:131], v1 offset:22144
    buffer_load_dwordx4 v10, s[8:11], s50 offen offset:2048  lds
    v_accvgpr_read_b32 v207, a15
    v_lshlrev_b32 v200, 16, v204
    v_lshlrev_b32 v201, 16, v205
    v_mfma_f32_32x32x16_bf16 v[32:47], a[148:151], v[192:195], v[32:47]
    ds_read_b64_tr_b16 a[132:133], v1 offset:20896
    ds_read_b64_tr_b16 a[134:135], v1 offset:22176
    v_lshlrev_b32 v202, 16, v206
    v_lshlrev_b32 v203, 16, v207
    v_and_b32 v204, s53, v204
    v_and_b32 v205, s53, v205
    v_mfma_f32_32x32x16_bf16 v[48:63], a[152:155], v[192:195], v[48:63]
    s_waitcnt lgkmcnt(8)
    ds_read_b64_tr_b16 a[136:137], v1 offset:25728
    buffer_load_dwordx4 v11, s[8:11], s50 offen offset:3072  lds
    v_and_b32 v206, s53, v206
    v_and_b32 v207, s53, v207
    v_fma_f32 v200, v200, v13, v14
    v_mfma_f32_32x32x16_bf16 v[64:79], a[156:159], v[192:195], v[64:79]
    ds_read_b64_tr_b16 a[138:139], v1 offset:27008
    ds_read_b64_tr_b16 a[140:141], v1 offset:25760
    ds_read_b64_tr_b16 a[142:143], v1 offset:27040
    v_fma_f32 v201, v201, v13, v14
    v_fma_f32 v202, v202, v13, v14
    v_fma_f32 v203, v203, v13, v14
    v_mfma_f32_32x32x16_bf16 v[80:95], a[112:115], v[192:195], v[80:95]
    s_add_u32 m0, s55, 65920
    ds_read_b64_tr_b16 a[144:145], v1 offset:25792
    ds_read_b64_tr_b16 a[146:147], v1 offset:27072
    buffer_load_dwordx4 v12, s[8:11], s50 offen  lds
    v_fma_f32 v204, v204, v13, v14
    v_fma_f32 v205, v205, v13, v14
    v_mfma_f32_32x32x16_bf16 v[96:111], a[116:119], v[192:195], v[96:111]
    s_waitcnt lgkmcnt(8)
    ds_read_b64_tr_b16 a[148:149], v1 offset:25824
    ds_read_b64_tr_b16 a[150:151], v1 offset:27104
    ds_read_b64_tr_b16 a[152:153], v1 offset:25856
    v_fma_f32 v206, v206, v13, v14
    v_fma_f32 v207, v207, v13, v14
    v_mfma_f32_32x32x16_bf16 v[112:127], a[120:123], v[192:195], v[112:127]
    s_add_u32 s50, s50, s99
    ds_read_b64_tr_b16 a[154:155], v1 offset:27136
    ds_read_b64_tr_b16 a[156:157], v1 offset:25888
    ds_read_b64_tr_b16 a[158:159], v1 offset:27168
    v_cvt_pk_bf16_f32 v196, v200, v204
    v_cvt_pk_bf16_f32 v197, v201, v205
    v_mfma_f32_32x32x16_bf16 v[128:143], a[124:127], v[192:195], v[128:143]
    s_cmp_ge_u32 s50, 1605632
    s_cselect_b32 s50, s96, s50
    v_cvt_pk_bf16_f32 v198, v202, v206
    v_cvt_pk_bf16_f32 v199, v203, v207
    s_add_u32 m0, s55, 0
    v_mfma_f32_32x32x16_bf16 v[144:159], a[128:131], v[192:195], v[144:159]
    s_waitcnt lgkmcnt(8)
    ds_read_b64_tr_b16 a[112:113], v1 offset:25920
    ds_read_b64_tr_b16 a[114:115], v1 offset:27200
    ds_read_b64_tr_b16 a[116:117], v1 offset:25952
    buffer_load_dwordx4 v8, s[8:11], s50 offen offset:0  lds
    v_mfma_f32_32x32x16_bf16 v[160:175], a[132:135], v[192:195], v[160:175]
    ds_read_b64_tr_b16 a[118:119], v1 offset:27232
    ds_read_b64_tr_b16 a[120:121], v1 offset:25984
    ds_read_b64_tr_b16 a[122:123], v1 offset:27264
    v_accvgpr_read_b32 v204, a16
    v_accvgpr_read_b32 v205, a17
    v_accvgpr_read_b32 v206, a18
    v_mfma_f32_32x32x16_bf16 v[16:31], a[136:139], v[196:199], v[16:31]
    buffer_load_dwordx4 v9, s[8:11], s50 offen offset:1024  lds
    v_accvgpr_read_b32 v207, a19
    v_lshlrev_b32 v200, 16, v204
    v_lshlrev_b32 v201, 16, v205
    v_lshlrev_b32 v202, 16, v206
    v_lshlrev_b32 v203, 16, v207
    v_mfma_f32_32x32x16_bf16 v[32:47], a[140:143], v[196:199], v[32:47]
    s_waitcnt lgkmcnt(8)
    ds_read_b64_tr_b16 a[124:125], v1 offset:26016
    ds_read_b64_tr_b16 a[126:127], v1 offset:27296
    v_and_b32 v204, s53, v204
    v_and_b32 v205, s53, v205
    v_and_b32 v206, s53, v206
    v_mfma_f32_32x32x16_bf16 v[48:63], a[144:147], v[196:199], v[48:63]
    buffer_load_dwordx4 v10, s[8:11], s50 offen offset:2048  lds
    v_and_b32 v207, s53, v207
    v_fma_f32 v200, v200, v13, v14
    v_fma_f32 v201, v201, v13, v14
    v_fma_f32 v202, v202, v13, v14
    v_fma_f32 v203, v203, v13, v14
    v_mfma_f32_32x32x16_bf16 v[64:79], a[148:151], v[196:199], v[64:79]
    v_fma_f32 v204, v204, v13, v14
    v_fma_f32 v205, v205, v13, v14
    v_fma_f32 v206, v206, v13, v14
    v_fma_f32 v207, v207, v13, v14
    v_cvt_pk_bf16_f32 v192, v200, v204
    v_cvt_pk_bf16_f32 v193, v201, v205
    v_mfma_f32_32x32x16_bf16 v[80:95], a[152:155], v[196:199], v[80:95]
    s_waitcnt lgkmcnt(6)
    s_waitcnt vmcnt(8) lgkmcnt(0)
    s_barrier
    v_readlane_b32 s69, v243, 0
    v_readlane_b32 s70, v243, 1
    v_readlane_b32 s71, v243, 2
    v_readlane_b32 s72, v243, 3
    v_readlane_b32 s73, v243, 4
    v_cvt_pk_bf16_f32 v194, v202, v206
    v_mfma_f32_32x32x16_bf16 v[96:111], a[156:159], v[196:199], v[96:111]
    ds_read_b64_tr_b16 a[128:129], v228 offset:0
    ds_read_b64_tr_b16 a[130:131], v228 offset:1280
    ds_read_b64_tr_b16 a[132:133], v228 offset:32
    buffer_load_dwordx4 v11, s[8:11], s50 offen offset:3072  lds
    v_cvt_pk_bf16_f32 v195, v203, v207
    s_add_u32 m0, s55, 4096
    v_mfma_f32_32x32x16_bf16 v[112:127], a[112:115], v[196:199], v[112:127]
    ds_read_b64_tr_b16 a[134:135], v228 offset:1312
    ds_read_b64_tr_b16 a[136:137], v228 offset:64
    ds_read_b64_tr_b16 a[138:139], v228 offset:1344
    v_mfma_f32_32x32x16_bf16 v[128:143], a[116:119], v[196:199], v[128:143]
    ds_read_b64_tr_b16 a[140:141], v228 offset:96
    ds_read_b64_tr_b16 a[142:143], v228 offset:1376
    ds_read_b64_tr_b16 a[144:145], v228 offset:128
    buffer_load_dwordx4 v12, s[8:11], s50 offen  lds
    s_add_u32 s50, s50, s98
    s_add_u32 m0, s55, 20608
    v_mfma_f32_32x32x16_bf16 v[144:159], a[120:123], v[196:199], v[144:159]
    ds_read_b64_tr_b16 a[146:147], v228 offset:1408
    ds_read_b64_tr_b16 a[148:149], v228 offset:160
    ds_read_b64_tr_b16 a[150:151], v228 offset:1440
    v_mfma_f32_32x32x16_bf16 v[160:175], a[124:127], v[196:199], v[160:175]
    s_waitcnt lgkmcnt(6)
    ds_read_b64_tr_b16 a[152:153], v228 offset:192
    ds_read_b64_tr_b16 a[154:155], v228 offset:1472
    v_accvgpr_read_b32 v204, a20
    v_accvgpr_read_b32 v205, a21
    v_accvgpr_read_b32 v206, a22
    v_mfma_f32_32x32x16_bf16 v[16:31], a[128:131], v[192:195], v[16:31]
    ds_read_b64_tr_b16 a[156:157], v228 offset:224
    ds_read_b64_tr_b16 a[158:159], v228 offset:1504
    ds_read_b64_tr_b16 a[112:113], v228 offset:256
    v_accvgpr_read_b32 v207, a23
    v_lshlrev_b32 v200, 16, v204
    v_lshlrev_b32 v201, 16, v205
    v_mfma_f32_32x32x16_bf16 v[32:47], a[132:135], v[192:195], v[32:47]
    ds_read_b64_tr_b16 a[114:115], v228 offset:1536
    ds_read_b64_tr_b16 a[116:117], v228 offset:288
    ds_read_b64_tr_b16 a[118:119], v228 offset:1568
    v_lshlrev_b32 v202, 16, v206
    v_lshlrev_b32 v203, 16, v207
    v_and_b32 v204, s53, v204
    v_mfma_f32_32x32x16_bf16 v[48:63], a[136:139], v[192:195], v[48:63]
    s_waitcnt lgkmcnt(8)
    ds_read_b64_tr_b16 a[120:121], v228 offset:5120
    buffer_load_dwordx4 v8, s[8:11], s50 offen offset:0  lds
    v_and_b32 v205, s53, v205
    v_and_b32 v206, s53, v206
    v_and_b32 v207, s53, v207
    v_mfma_f32_32x32x16_bf16 v[64:79], a[140:143], v[192:195], v[64:79]
    ds_read_b64_tr_b16 a[122:123], v228 offset:6400
    ds_read_b64_tr_b16 a[124:125], v228 offset:5152
    ds_read_b64_tr_b16 a[126:127], v228 offset:6432
    v_fma_f32 v200, v200, v13, v14
    v_fma_f32 v201, v201, v13, v14
    v_fma_f32 v202, v202, v13, v14
    v_mfma_f32_32x32x16_bf16 v[80:95], a[144:147], v[192:195], v[80:95]
    ds_read_b64_tr_b16 a[128:129], v228 offset:5184
    ds_read_b64_tr_b16 a[130:131], v228 offset:6464
    buffer_load_dwordx4 v9, s[8:11], s50 offen offset:1024  lds
    v_fma_f32 v203, v203, v13, v14
    v_fma_f32 v204, v204, v13, v14
    v_fma_f32 v205, v205, v13, v14
    v_mfma_f32_32x32x16_bf16 v[96:111], a[148:151], v[192:195], v[96:111]
    s_waitcnt lgkmcnt(8)
    ds_read_b64_tr_b16 a[132:133], v228 offset:5216
    ds_read_b64_tr_b16 a[134:135], v228 offset:6496
    ds_read_b64_tr_b16 a[136:137], v228 offset:5248
    v_fma_f32 v206, v206, v13, v14
    v_fma_f32 v207, v207, v13, v14
    v_mfma_f32_32x32x16_bf16 v[112:127], a[152:155], v[192:195], v[112:127]
    ds_read_b64_tr_b16 a[138:139], v228 offset:6528
    ds_read_b64_tr_b16 a[140:141], v228 offset:5280
    ds_read_b64_tr_b16 a[142:143], v228 offset:6560
    buffer_load_dwordx4 v10, s[8:11], s50 offen offset:2048  lds
    v_cvt_pk_bf16_f32 v196, v200, v204
    v_cvt_pk_bf16_f32 v197, v201, v205
    v_mfma_f32_32x32x16_bf16 v[128:143], a[156:159], v[192:195], v[128:143]
    v_cvt_pk_bf16_f32 v198, v202, v206
    v_cvt_pk_bf16_f32 v199, v203, v207
    v_mfma_f32_32x32x16_bf16 v[144:159], a[112:115], v[192:195], v[144:159]
    s_waitcnt lgkmcnt(8)
    ds_read_b64_tr_b16 a[144:145], v228 offset:5312
    ds_read_b64_tr_b16 a[146:147], v228 offset:6592
    ds_read_b64_tr_b16 a[148:149], v228 offset:5344
    buffer_load_dwordx4 v11, s[8:11], s50 offen offset:3072  lds
    s_add_u32 m0, s55, 24704
    v_mfma_f32_32x32x16_bf16 v[160:175], a[116:119], v[192:195], v[160:175]
    ds_read_b64_tr_b16 a[150:151], v228 offset:6624
    ds_read_b64_tr_b16 a[152:153], v228 offset:5376
    ds_read_b64_tr_b16 a[154:155], v228 offset:6656
    v_accvgpr_read_b32 v204, a24
    v_accvgpr_read_b32 v205, a25
    v_accvgpr_read_b32 v206, a26
    v_mfma_f32_32x32x16_bf16 v[16:31], a[120:123], v[196:199], v[16:31]
    buffer_load_dwordx4 v12, s[8:11], s50 offen  lds
    v_accvgpr_read_b32 v207, a27
    v_lshlrev_b32 v200, 16, v204
    v_lshlrev_b32 v201, 16, v205
    v_lshlrev_b32 v202, 16, v206
    v_lshlrev_b32 v203, 16, v207
    v_mfma_f32_32x32x16_bf16 v[32:47], a[124:127], v[196:199], v[32:47]
    s_waitcnt lgkmcnt(8)
    ds_read_b64_tr_b16 a[156:157], v228 offset:5408
    ds_read_b64_tr_b16 a[158:159], v228 offset:6688
    v_and_b32 v204, s53, v204
    v_and_b32 v205, s53, v205
    v_and_b32 v206, s53, v206
    v_mfma_f32_32x32x16_bf16 v[48:63], a[128:131], v[196:199], v[48:63]
    s_add_u32 s50, s50, s99
    s_cmp_ge_u32 s50, 1605632
    s_cselect_b32 s50, s96, s50
    v_and_b32 v207, s53, v207
    v_fma_f32 v200, v200, v13, v14
    v_fma_f32 v201, v201, v13, v14
    v_mfma_f32_32x32x16_bf16 v[64:79], a[132:135], v[196:199], v[64:79]
    v_fma_f32 v202, v202, v13, v14
    v_fma_f32 v203, v203, v13, v14
    v_fma_f32 v204, v204, v13, v14
    v_fma_f32 v205, v205, v13, v14
    v_fma_f32 v206, v206, v13, v14
    v_fma_f32 v207, v207, v13, v14
    v_mfma_f32_32x32x16_bf16 v[80:95], a[136:139], v[196:199], v[80:95]
    s_waitcnt lgkmcnt(6)
    s_waitcnt vmcnt(10) lgkmcnt(0)
    s_barrier
    ds_read_b64_tr_b16 a[112:113], v228 offset:20608
    ds_read_b64_tr_b16 a[114:115], v228 offset:21888
    v_cvt_pk_bf16_f32 v192, v200, v204
    v_mfma_f32_32x32x16_bf16 v[96:111], a[140:143], v[196:199], v[96:111]
    s_add_u32 m0, s55, 41216
    ds_read_b64_tr_b16 a[116:117], v228 offset:20640
    ds_read_b64_tr_b16 a[118:119], v228 offset:21920
    ds_read_b64_tr_b16 a[120:121], v228 offset:20672
    buffer_load_dwordx4 v8, s[8:11], s50 offen offset:0  lds
    v_cvt_pk_bf16_f32 v193, v201, v205
    v_mfma_f32_32x32x16_bf16 v[112:127], a[144:147], v[196:199], v[112:127]
    ds_read_b64_tr_b16 a[122:123], v228 offset:21952
    ds_read_b64_tr_b16 a[124:125], v228 offset:20704
    ds_read_b64_tr_b16 a[126:127], v228 offset:21984
    v_cvt_pk_bf16_f32 v194, v202, v206
    v_cvt_pk_bf16_f32 v195, v203, v207
    v_mfma_f32_32x32x16_bf16 v[128:143], a[148:151], v[196:199], v[128:143]
    ds_read_b64_tr_b16 a[128:129], v228 offset:20736
    ds_read_b64_tr_b16 a[130:131], v228 offset:22016
    ds_read_b64_tr_b16 a[132:133], v228 offset:20768
    buffer_load_dwordx4 v9, s[8:11], s50 offen offset:1024  lds
    v_mfma_f32_32x32x16_bf16 v[144:159], a[152:155], v[196:199], v[144:159]
    ds_read_b64_tr_b16 a[134:135], v228 offset:22048
    ds_read_b64_tr_b16 a[136:137], v228 offset:20800
    ds_read_b64_tr_b16 a[138:139], v228 offset:22080
    v_mfma_f32_32x32x16_bf16 v[160:175], a[156:159], v[196:199], v[160:175]
    s_waitcnt lgkmcnt(8)
    ds_read_b64_tr_b16 a[140:141], v228 offset:20832
    buffer_load_dwordx4 v10, s[8:11], s50 offen offset:2048  lds
    v_accvgpr_read_b32 v204, a28
    v_accvgpr_read_b32 v205, a29
    v_accvgpr_read_b32 v206, a30
    v_mfma_f32_32x32x16_bf16 v[16:31], a[112:115], v[192:195], v[16:31]
    ds_read_b64_tr_b16 a[142:143], v228 offset:22112
    ds_read_b64_tr_b16 a[144:145], v228 offset:20864
    ds_read_b64_tr_b16 a[146:147], v228 offset:22144
    v_accvgpr_read_b32 v207, a31
    v_lshlrev_b32 v200, 16, v204
    v_lshlrev_b32 v201, 16, v205
    v_mfma_f32_32x32x16_bf16 v[32:47], a[116:119], v[192:195], v[32:47]
    ds_read_b64_tr_b16 a[148:149], v228 offset:20896
    ds_read_b64_tr_b16 a[150:151], v228 offset:22176
    buffer_load_dwordx4 v11, s[8:11], s50 offen offset:3072  lds
    v_lshlrev_b32 v202, 16, v206
    v_lshlrev_b32 v203, 16, v207
    v_and_b32 v204, s53, v204
    v_mfma_f32_32x32x16_bf16 v[48:63], a[120:123], v[192:195], v[48:63]
    s_waitcnt lgkmcnt(8)
    ds_read_b64_tr_b16 a[152:153], v228 offset:25728
    ds_read_b64_tr_b16 a[154:155], v228 offset:27008
    v_and_b32 v205, s53, v205
    v_and_b32 v206, s53, v206
    v_and_b32 v207, s53, v207
    v_mfma_f32_32x32x16_bf16 v[64:79], a[124:127], v[192:195], v[64:79]
    ds_read_b64_tr_b16 a[156:157], v228 offset:25760
    ds_read_b64_tr_b16 a[158:159], v228 offset:27040
    ds_read_b64_tr_b16 a[112:113], v228 offset:25792
    v_fma_f32 v200, v200, v13, v14
    v_fma_f32 v201, v201, v13, v14
    v_fma_f32 v202, v202, v13, v14
    v_mfma_f32_32x32x16_bf16 v[80:95], a[128:131], v[192:195], v[80:95]
    ds_read_b64_tr_b16 a[114:115], v228 offset:27072
    v_fma_f32 v203, v203, v13, v14
    v_fma_f32 v204, v204, v13, v14
    v_fma_f32 v205, v205, v13, v14
    v_fma_f32 v206, v206, v13, v14
    v_fma_f32 v207, v207, v13, v14
    v_mfma_f32_32x32x16_bf16 v[96:111], a[132:135], v[192:195], v[96:111]
    s_waitcnt lgkmcnt(8)
    ds_read_b64_tr_b16 a[116:117], v228 offset:25824
    ds_read_b64_tr_b16 a[118:119], v228 offset:27104
    ds_read_b64_tr_b16 a[120:121], v228 offset:25856
    v_cvt_pk_bf16_f32 v196, v200, v204
    v_cvt_pk_bf16_f32 v197, v201, v205
    v_mfma_f32_32x32x16_bf16 v[112:127], a[136:139], v[192:195], v[112:127]
    s_add_u32 m0, s55, 45312
    ds_read_b64_tr_b16 a[122:123], v228 offset:27136
    ds_read_b64_tr_b16 a[124:125], v228 offset:25888
    ds_read_b64_tr_b16 a[126:127], v228 offset:27168
    buffer_load_dwordx4 v12, s[8:11], s50 offen  lds
    v_cvt_pk_bf16_f32 v198, v202, v206
    v_mfma_f32_32x32x16_bf16 v[128:143], a[140:143], v[192:195], v[128:143]
    s_add_u32 s50, s50, s98
    s_add_u32 m0, s60, 0
    v_cvt_pk_bf16_f32 v199, v203, v207
    v_mfma_f32_32x32x16_bf16 v[144:159], a[144:147], v[192:195], v[144:159]
    s_waitcnt lgkmcnt(8)
    ds_read_b64_tr_b16 a[128:129], v228 offset:25920
    ds_read_b64_tr_b16 a[130:131], v228 offset:27200
    ds_read_b64_tr_b16 a[132:133], v228 offset:25952
    buffer_load_dwordx4 v15, s[24:27], s74 offen  lds
    v_mfma_f32_32x32x16_bf16 v[160:175], a[148:151], v[192:195], v[160:175]
    ds_read_b64_tr_b16 a[134:135], v228 offset:27232
    ds_read_b64_tr_b16 a[136:137], v228 offset:25984
    ds_read_b64_tr_b16 a[138:139], v228 offset:27264
    v_accvgpr_read_b32 v204, a32
    v_accvgpr_read_b32 v205, a33
    v_accvgpr_read_b32 v206, a34
    v_mfma_f32_32x32x16_bf16 v[16:31], a[152:155], v[196:199], v[16:31]
    buffer_load_dwordx4 v233, s[24:27], s74 offen offset:1024  lds
    v_accvgpr_read_b32 v207, a35
    v_lshlrev_b32 v200, 16, v204
    v_lshlrev_b32 v201, 16, v205
    v_lshlrev_b32 v202, 16, v206
    v_lshlrev_b32 v203, 16, v207
    v_mfma_f32_32x32x16_bf16 v[32:47], a[156:159], v[196:199], v[32:47]
    s_waitcnt lgkmcnt(8)
    ds_read_b64_tr_b16 a[140:141], v228 offset:26016
    ds_read_b64_tr_b16 a[142:143], v228 offset:27296
    v_and_b32 v204, s53, v204
    v_and_b32 v205, s53, v205
    v_and_b32 v206, s53, v206
    v_mfma_f32_32x32x16_bf16 v[48:63], a[112:115], v[196:199], v[48:63]
    s_add_u32 m0, s60, 2048
    s_add_u32 s46, s74, 14336
    buffer_load_dwordx4 v15, s[24:27], s46 offen  lds
    v_and_b32 v207, s53, v207
    v_fma_f32 v200, v200, v13, v14
    v_fma_f32 v201, v201, v13, v14
    v_mfma_f32_32x32x16_bf16 v[64:79], a[116:119], v[196:199], v[64:79]
    v_fma_f32 v202, v202, v13, v14
    v_fma_f32 v203, v203, v13, v14
    v_fma_f32 v204, v204, v13, v14
    v_fma_f32 v205, v205, v13, v14
    v_fma_f32 v206, v206, v13, v14
    v_fma_f32 v207, v207, v13, v14
    v_mfma_f32_32x32x16_bf16 v[80:95], a[120:123], v[196:199], v[80:95]
    s_waitcnt lgkmcnt(6)
    s_waitcnt vmcnt(13) lgkmcnt(0)
    s_barrier
    ds_read_b64_tr_b16 a[144:145], v1 offset:0
    ds_read_b64_tr_b16 a[146:147], v1 offset:1280
    v_cvt_pk_bf16_f32 v192, v200, v204
    v_mfma_f32_32x32x16_bf16 v[96:111], a[124:127], v[196:199], v[96:111]
    ds_read_b64_tr_b16 a[148:149], v1 offset:32
    ds_read_b64_tr_b16 a[150:151], v1 offset:1312
    ds_read_b64_tr_b16 a[152:153], v1 offset:64
    buffer_load_dwordx4 v233, s[24:27], s46 offen offset:1024  lds
    v_cvt_pk_bf16_f32 v193, v201, v205
    v_cvt_pk_bf16_f32 v194, v202, v206
    v_mfma_f32_32x32x16_bf16 v[112:127], a[128:131], v[196:199], v[112:127]
    s_add_u32 m0, s55, 61824
    ds_read_b64_tr_b16 a[154:155], v1 offset:1344
    ds_read_b64_tr_b16 a[156:157], v1 offset:96
    ds_read_b64_tr_b16 a[158:159], v1 offset:1376
    v_cvt_pk_bf16_f32 v195, v203, v207
    v_mfma_f32_32x32x16_bf16 v[128:143], a[132:135], v[196:199], v[128:143]
    ds_read_b64_tr_b16 a[112:113], v1 offset:128
    ds_read_b64_tr_b16 a[114:115], v1 offset:1408
    ds_read_b64_tr_b16 a[116:117], v1 offset:160
    buffer_load_dwordx4 v8, s[8:11], s50 offen offset:0  lds
    v_mfma_f32_32x32x16_bf16 v[144:159], a[136:139], v[196:199], v[144:159]
    ds_read_b64_tr_b16 a[118:119], v1 offset:1440
    ds_read_b64_tr_b16 a[120:121], v1 offset:192
    ds_read_b64_tr_b16 a[122:123], v1 offset:1472
    v_mfma_f32_32x32x16_bf16 v[160:175], a[140:143], v[196:199], v[160:175]
    s_waitcnt lgkmcnt(8)
    ds_read_b64_tr_b16 a[124:125], v1 offset:224
    buffer_load_dwordx4 v9, s[8:11], s50 offen offset:1024  lds
    v_accvgpr_read_b32 v204, a36
    v_accvgpr_read_b32 v205, a37
    v_accvgpr_read_b32 v206, a38
    v_mfma_f32_32x32x16_bf16 v[16:31], a[144:147], v[192:195], v[16:31]
    ds_read_b64_tr_b16 a[126:127], v1 offset:1504
    ds_read_b64_tr_b16 a[128:129], v1 offset:256
    ds_read_b64_tr_b16 a[130:131], v1 offset:1536
    v_accvgpr_read_b32 v207, a39
    v_lshlrev_b32 v200, 16, v204
    v_lshlrev_b32 v201, 16, v205
    v_mfma_f32_32x32x16_bf16 v[32:47], a[148:151], v[192:195], v[32:47]
    ds_read_b64_tr_b16 a[132:133], v1 offset:288
    ds_read_b64_tr_b16 a[134:135], v1 offset:1568
    buffer_load_dwordx4 v10, s[8:11], s50 offen offset:2048  lds
    v_lshlrev_b32 v202, 16, v206
    v_lshlrev_b32 v203, 16, v207
    v_and_b32 v204, s53, v204
    v_mfma_f32_32x32x16_bf16 v[48:63], a[152:155], v[192:195], v[48:63]
    s_waitcnt lgkmcnt(8)
    ds_read_b64_tr_b16 a[136:137], v1 offset:5120
    ds_read_b64_tr_b16 a[138:139], v1 offset:6400
    v_and_b32 v205, s53, v205
    v_and_b32 v206, s53, v206
    v_and_b32 v207, s53, v207
    v_mfma_f32_32x32x16_bf16 v[64:79], a[156:159], v[192:195], v[64:79]
    ds_read_b64_tr_b16 a[140:141], v1 offset:5152
    ds_read_b64_tr_b16 a[142:143], v1 offset:6432
    buffer_load_dwordx4 v11, s[8:11], s50 offen offset:3072  lds
    v_fma_f32 v200, v200, v13, v14
    v_fma_f32 v201, v201, v13, v14
    v_fma_f32 v202, v202, v13, v14
    v_mfma_f32_32x32x16_bf16 v[80:95], a[112:115], v[192:195], v[80:95]
    ds_read_b64_tr_b16 a[144:145], v1 offset:5184
    ds_read_b64_tr_b16 a[146:147], v1 offset:6464
    v_fma_f32 v203, v203, v13, v14
    v_fma_f32 v204, v204, v13, v14
    v_fma_f32 v205, v205, v13, v14
    v_fma_f32 v206, v206, v13, v14
    v_mfma_f32_32x32x16_bf16 v[96:111], a[116:119], v[192:195], v[96:111]
    s_waitcnt lgkmcnt(8)
    ds_read_b64_tr_b16 a[148:149], v1 offset:5216
    ds_read_b64_tr_b16 a[150:151], v1 offset:6496
    ds_read_b64_tr_b16 a[152:153], v1 offset:5248
    v_fma_f32 v207, v207, v13, v14
    v_cvt_pk_bf16_f32 v196, v200, v204
    v_mfma_f32_32x32x16_bf16 v[112:127], a[120:123], v[192:195], v[112:127]
    s_add_u32 m0, s55, 65920
    ds_read_b64_tr_b16 a[154:155], v1 offset:6528
    ds_read_b64_tr_b16 a[156:157], v1 offset:5280
    buffer_load_dwordx4 v12, s[8:11], s50 offen  lds
    v_cvt_pk_bf16_f32 v197, v201, v205
    v_cvt_pk_bf16_f32 v198, v202, v206
    v_mfma_f32_32x32x16_bf16 v[128:143], a[124:127], v[192:195], v[128:143]
    s_add_u32 s50, s50, s99
    s_cmp_ge_u32 s50, 1605632
    s_cselect_b32 s50, s96, s50
    ds_read_b64_tr_b16 a[158:159], v1 offset:6560
    v_cvt_pk_bf16_f32 v199, v203, v207
    s_add_u32 m0, s60, 4096
    v_mfma_f32_32x32x16_bf16 v[144:159], a[128:131], v[192:195], v[144:159]
    s_waitcnt lgkmcnt(8)
    s_add_u32 s46, s74, 28672
    ds_read_b64_tr_b16 a[112:113], v1 offset:5312
    ds_read_b64_tr_b16 a[114:115], v1 offset:6592
    ds_read_b64_tr_b16 a[116:117], v1 offset:5344
    buffer_load_dwordx4 v15, s[24:27], s46 offen  lds
    v_mfma_f32_32x32x16_bf16 v[160:175], a[132:135], v[192:195], v[160:175]
    ds_read_b64_tr_b16 a[118:119], v1 offset:6624
    ds_read_b64_tr_b16 a[120:121], v1 offset:5376
    ds_read_b64_tr_b16 a[122:123], v1 offset:6656
    v_accvgpr_read_b32 v204, a40
    v_accvgpr_read_b32 v205, a41
    v_accvgpr_read_b32 v206, a42
    v_mfma_f32_32x32x16_bf16 v[16:31], a[136:139], v[196:199], v[16:31]
    buffer_load_dwordx4 v233, s[24:27], s46 offen offset:1024  lds
    v_accvgpr_read_b32 v207, a43
    v_lshlrev_b32 v200, 16, v204
    v_lshlrev_b32 v201, 16, v205
    v_lshlrev_b32 v202, 16, v206
    v_lshlrev_b32 v203, 16, v207
    v_mfma_f32_32x32x16_bf16 v[32:47], a[140:143], v[196:199], v[32:47]
    s_waitcnt lgkmcnt(8)
    ds_read_b64_tr_b16 a[124:125], v1 offset:5408
    ds_read_b64_tr_b16 a[126:127], v1 offset:6688
    v_and_b32 v204, s53, v204
    v_and_b32 v205, s53, v205
    v_and_b32 v206, s53, v206
    v_mfma_f32_32x32x16_bf16 v[48:63], a[144:147], v[196:199], v[48:63]
    s_add_u32 m0, s60, 6144
    s_add_u32 s46, s74, 43008
    buffer_load_dwordx4 v15, s[24:27], s46 offen  lds
    v_and_b32 v207, s53, v207
    v_fma_f32 v200, v200, v13, v14
    v_fma_f32 v201, v201, v13, v14
    v_mfma_f32_32x32x16_bf16 v[64:79], a[148:151], v[196:199], v[64:79]
    v_fma_f32 v202, v202, v13, v14
    v_fma_f32 v203, v203, v13, v14
    v_fma_f32 v204, v204, v13, v14
    v_fma_f32 v205, v205, v13, v14
    v_fma_f32 v206, v206, v13, v14
    v_fma_f32 v207, v207, v13, v14
    v_mfma_f32_32x32x16_bf16 v[80:95], a[152:155], v[196:199], v[80:95]
    s_waitcnt lgkmcnt(6)
    s_waitcnt vmcnt(17) lgkmcnt(0)
    s_barrier
    ds_read_b64_tr_b16 a[128:129], v1 offset:20608
    ds_read_b64_tr_b16 a[130:131], v1 offset:21888
    v_cvt_pk_bf16_f32 v192, v200, v204
    v_mfma_f32_32x32x16_bf16 v[96:111], a[156:159], v[196:199], v[96:111]
    ds_read_b64_tr_b16 a[132:133], v1 offset:20640
    ds_read_b64_tr_b16 a[134:135], v1 offset:21920
    ds_read_b64_tr_b16 a[136:137], v1 offset:20672
    buffer_load_dwordx4 v233, s[24:27], s46 offen offset:1024  lds
    v_cvt_pk_bf16_f32 v193, v201, v205
    v_cvt_pk_bf16_f32 v194, v202, v206
    v_mfma_f32_32x32x16_bf16 v[112:127], a[112:115], v[196:199], v[112:127]
    s_add_u32 m0, s55, 0
    ds_read_b64_tr_b16 a[138:139], v1 offset:21952
    ds_read_b64_tr_b16 a[140:141], v1 offset:20704
    ds_read_b64_tr_b16 a[142:143], v1 offset:21984
    v_cvt_pk_bf16_f32 v195, v203, v207
    v_mfma_f32_32x32x16_bf16 v[128:143], a[116:119], v[196:199], v[128:143]
    ds_read_b64_tr_b16 a[144:145], v1 offset:20736
    ds_read_b64_tr_b16 a[146:147], v1 offset:22016
    ds_read_b64_tr_b16 a[148:149], v1 offset:20768
    buffer_load_dwordx4 v8, s[8:11], s50 offen offset:0  lds
    v_mfma_f32_32x32x16_bf16 v[144:159], a[120:123], v[196:199], v[144:159]
    ds_read_b64_tr_b16 a[150:151], v1 offset:22048
    ds_read_b64_tr_b16 a[152:153], v1 offset:20800
    ds_read_b64_tr_b16 a[154:155], v1 offset:22080
    v_mfma_f32_32x32x16_bf16 v[160:175], a[124:127], v[196:199], v[160:175]
    s_waitcnt lgkmcnt(8)
    ds_read_b64_tr_b16 a[156:157], v1 offset:20832
    buffer_load_dwordx4 v9, s[8:11], s50 offen offset:1024  lds
    v_accvgpr_read_b32 v204, a44
    v_accvgpr_read_b32 v205, a45
    v_accvgpr_read_b32 v206, a46
    v_mfma_f32_32x32x16_bf16 v[16:31], a[128:131], v[192:195], v[16:31]
    ds_read_b64_tr_b16 a[158:159], v1 offset:22112
    ds_read_b64_tr_b16 a[112:113], v1 offset:20864
    ds_read_b64_tr_b16 a[114:115], v1 offset:22144
    v_accvgpr_read_b32 v207, a47
    v_lshlrev_b32 v200, 16, v204
    v_lshlrev_b32 v201, 16, v205
    v_mfma_f32_32x32x16_bf16 v[32:47], a[132:135], v[192:195], v[32:47]
    ds_read_b64_tr_b16 a[116:117], v1 offset:20896
    ds_read_b64_tr_b16 a[118:119], v1 offset:22176
    buffer_load_dwordx4 v10, s[8:11], s50 offen offset:2048  lds
    v_lshlrev_b32 v202, 16, v206
    v_lshlrev_b32 v203, 16, v207
    v_and_b32 v204, s53, v204
    v_mfma_f32_32x32x16_bf16 v[48:63], a[136:139], v[192:195], v[48:63]
    s_waitcnt lgkmcnt(8)
    ds_read_b64_tr_b16 a[120:121], v1 offset:25728
    ds_read_b64_tr_b16 a[122:123], v1 offset:27008
    v_and_b32 v205, s53, v205
    v_and_b32 v206, s53, v206
    v_and_b32 v207, s53, v207
    v_mfma_f32_32x32x16_bf16 v[64:79], a[140:143], v[192:195], v[64:79]
    ds_read_b64_tr_b16 a[124:125], v1 offset:25760
    ds_read_b64_tr_b16 a[126:127], v1 offset:27040
    buffer_load_dwordx4 v11, s[8:11], s50 offen offset:3072  lds
    v_fma_f32 v200, v200, v13, v14
    v_fma_f32 v201, v201, v13, v14
    v_fma_f32 v202, v202, v13, v14
    v_mfma_f32_32x32x16_bf16 v[80:95], a[144:147], v[192:195], v[80:95]
    ds_read_b64_tr_b16 a[128:129], v1 offset:25792
    ds_read_b64_tr_b16 a[130:131], v1 offset:27072
    v_fma_f32 v203, v203, v13, v14
    v_fma_f32 v204, v204, v13, v14
    v_fma_f32 v205, v205, v13, v14
    v_fma_f32 v206, v206, v13, v14
    v_mfma_f32_32x32x16_bf16 v[96:111], a[148:151], v[192:195], v[96:111]
    s_waitcnt lgkmcnt(8)
    ds_read_b64_tr_b16 a[132:133], v1 offset:25824
    ds_read_b64_tr_b16 a[134:135], v1 offset:27104
    ds_read_b64_tr_b16 a[136:137], v1 offset:25856
    v_fma_f32 v207, v207, v13, v14
    v_cvt_pk_bf16_f32 v196, v200, v204
    v_mfma_f32_32x32x16_bf16 v[112:127], a[152:155], v[192:195], v[112:127]
    s_add_u32 m0, s55, 4096
    ds_read_b64_tr_b16 a[138:139], v1 offset:27136
    ds_read_b64_tr_b16 a[140:141], v1 offset:25888
    buffer_load_dwordx4 v12, s[8:11], s50 offen  lds
    v_cvt_pk_bf16_f32 v197, v201, v205
    v_cvt_pk_bf16_f32 v198, v202, v206
    v_mfma_f32_32x32x16_bf16 v[128:143], a[156:159], v[192:195], v[128:143]
    s_add_u32 s50, s50, s98
    s_add_u32 m0, s60, 8192
    ds_read_b64_tr_b16 a[142:143], v1 offset:27168
    v_cvt_pk_bf16_f32 v199, v203, v207
    s_add_u32 s46, s74, 57344
    v_mfma_f32_32x32x16_bf16 v[144:159], a[112:115], v[192:195], v[144:159]
    s_waitcnt lgkmcnt(8)
    ds_read_b64_tr_b16 a[144:145], v1 offset:25920
    ds_read_b64_tr_b16 a[146:147], v1 offset:27200
    ds_read_b64_tr_b16 a[148:149], v1 offset:25952
    buffer_load_dwordx4 v15, s[24:27], s46 offen  lds
    v_mfma_f32_32x32x16_bf16 v[160:175], a[116:119], v[192:195], v[160:175]
    ds_read_b64_tr_b16 a[150:151], v1 offset:27232
    ds_read_b64_tr_b16 a[152:153], v1 offset:25984
    ds_read_b64_tr_b16 a[154:155], v1 offset:27264
    v_accvgpr_read_b32 v204, a48
    v_accvgpr_read_b32 v205, a49
    v_accvgpr_read_b32 v206, a50
    v_mfma_f32_32x32x16_bf16 v[16:31], a[120:123], v[196:199], v[16:31]
    buffer_load_dwordx4 v233, s[24:27], s46 offen offset:1024  lds
    v_accvgpr_read_b32 v207, a51
    v_lshlrev_b32 v200, 16, v204
    v_lshlrev_b32 v201, 16, v205
    v_lshlrev_b32 v202, 16, v206
    v_lshlrev_b32 v203, 16, v207
    v_mfma_f32_32x32x16_bf16 v[32:47], a[124:127], v[196:199], v[32:47]
    s_waitcnt lgkmcnt(8)
    ds_read_b64_tr_b16 a[156:157], v1 offset:26016
    ds_read_b64_tr_b16 a[158:159], v1 offset:27296
    v_and_b32 v204, s53, v204
    v_and_b32 v205, s53, v205
    v_and_b32 v206, s53, v206
    v_mfma_f32_32x32x16_bf16 v[48:63], a[128:131], v[196:199], v[48:63]
    s_add_u32 m0, s60, 10240
    s_nop 0
    buffer_load_dwordx4 v15, s[24:27], s75 offen  lds
    v_and_b32 v207, s53, v207
    v_fma_f32 v200, v200, v13, v14
    v_fma_f32 v201, v201, v13, v14
    v_mfma_f32_32x32x16_bf16 v[64:79], a[132:135], v[196:199], v[64:79]
    v_fma_f32 v202, v202, v13, v14
    v_fma_f32 v203, v203, v13, v14
    v_fma_f32 v204, v204, v13, v14
    v_fma_f32 v205, v205, v13, v14
    v_fma_f32 v206, v206, v13, v14
    v_fma_f32 v207, v207, v13, v14
    v_mfma_f32_32x32x16_bf16 v[80:95], a[136:139], v[196:199], v[80:95]
    s_waitcnt lgkmcnt(6)
    s_waitcnt vmcnt(21) lgkmcnt(0)
    s_barrier
    ds_read_b64_tr_b16 a[112:113], v228 offset:0
    ds_read_b64_tr_b16 a[114:115], v228 offset:1280
    v_cvt_pk_bf16_f32 v192, v200, v204
    v_mfma_f32_32x32x16_bf16 v[96:111], a[140:143], v[196:199], v[96:111]
    ds_read_b64_tr_b16 a[116:117], v228 offset:32
    ds_read_b64_tr_b16 a[118:119], v228 offset:1312
    ds_read_b64_tr_b16 a[120:121], v228 offset:64
    buffer_load_dwordx4 v233, s[24:27], s75 offen offset:1024  lds
    v_cvt_pk_bf16_f32 v193, v201, v205
    v_cvt_pk_bf16_f32 v194, v202, v206
    v_mfma_f32_32x32x16_bf16 v[112:127], a[144:147], v[196:199], v[112:127]
    s_add_u32 m0, s55, 20608
    ds_read_b64_tr_b16 a[122:123], v228 offset:1344
    ds_read_b64_tr_b16 a[124:125], v228 offset:96
    ds_read_b64_tr_b16 a[126:127], v228 offset:1376
    v_cvt_pk_bf16_f32 v195, v203, v207
    v_mfma_f32_32x32x16_bf16 v[128:143], a[148:151], v[196:199], v[128:143]
    ds_read_b64_tr_b16 a[128:129], v228 offset:128
    ds_read_b64_tr_b16 a[130:131], v228 offset:1408
    ds_read_b64_tr_b16 a[132:133], v228 offset:160
    buffer_load_dwordx4 v8, s[8:11], s50 offen offset:0  lds
    v_mfma_f32_32x32x16_bf16 v[144:159], a[152:155], v[196:199], v[144:159]
    ds_read_b64_tr_b16 a[134:135], v228 offset:1440
    ds_read_b64_tr_b16 a[136:137], v228 offset:192
    ds_read_b64_tr_b16 a[138:139], v228 offset:1472
    v_mfma_f32_32x32x16_bf16 v[160:175], a[156:159], v[196:199], v[160:175]
    s_waitcnt lgkmcnt(8)
    ds_read_b64_tr_b16 a[140:141], v228 offset:224
    buffer_load_dwordx4 v9, s[8:11], s50 offen offset:1024  lds
    v_accvgpr_read_b32 v204, a52
    v_accvgpr_read_b32 v205, a53
    v_accvgpr_read_b32 v206, a54
    v_mfma_f32_32x32x16_bf16 v[16:31], a[112:115], v[192:195], v[16:31]
    ds_read_b64_tr_b16 a[142:143], v228 offset:1504
    ds_read_b64_tr_b16 a[144:145], v228 offset:256
    ds_read_b64_tr_b16 a[146:147], v228 offset:1536
    v_accvgpr_read_b32 v207, a55
    v_lshlrev_b32 v200, 16, v204
    v_lshlrev_b32 v201, 16, v205
    v_mfma_f32_32x32x16_bf16 v[32:47], a[116:119], v[192:195], v[32:47]
    ds_read_b64_tr_b16 a[148:149], v228 offset:288
    ds_read_b64_tr_b16 a[150:151], v228 offset:1568
    buffer_load_dwordx4 v10, s[8:11], s50 offen offset:2048  lds
    v_lshlrev_b32 v202, 16, v206
    v_lshlrev_b32 v203, 16, v207
    v_and_b32 v204, s53, v204
    v_mfma_f32_32x32x16_bf16 v[48:63], a[120:123], v[192:195], v[48:63]
    s_waitcnt lgkmcnt(8)
    ds_read_b64_tr_b16 a[152:153], v228 offset:5120
    ds_read_b64_tr_b16 a[154:155], v228 offset:6400
    v_and_b32 v205, s53, v205
    v_and_b32 v206, s53, v206
    v_and_b32 v207, s53, v207
    v_mfma_f32_32x32x16_bf16 v[64:79], a[124:127], v[192:195], v[64:79]
    ds_read_b64_tr_b16 a[156:157], v228 offset:5152
    ds_read_b64_tr_b16 a[158:159], v228 offset:6432
    buffer_load_dwordx4 v11, s[8:11], s50 offen offset:3072  lds
    v_fma_f32 v200, v200, v13, v14
    v_fma_f32 v201, v201, v13, v14
    v_fma_f32 v202, v202, v13, v14
    v_mfma_f32_32x32x16_bf16 v[80:95], a[128:131], v[192:195], v[80:95]
    ds_read_b64_tr_b16 a[112:113], v228 offset:5184
    ds_read_b64_tr_b16 a[114:115], v228 offset:6464
    v_fma_f32 v203, v203, v13, v14
    v_fma_f32 v204, v204, v13, v14
    v_fma_f32 v205, v205, v13, v14
    v_fma_f32 v206, v206, v13, v14
    v_mfma_f32_32x32x16_bf16 v[96:111], a[132:135], v[192:195], v[96:111]
    s_waitcnt lgkmcnt(8)
    ds_read_b64_tr_b16 a[116:117], v228 offset:5216
    ds_read_b64_tr_b16 a[118:119], v228 offset:6496
    ds_read_b64_tr_b16 a[120:121], v228 offset:5248
    v_fma_f32 v207, v207, v13, v14
    v_cvt_pk_bf16_f32 v196, v200, v204
    v_mfma_f32_32x32x16_bf16 v[112:127], a[136:139], v[192:195], v[112:127]
    s_add_u32 m0, s55, 24704
    ds_read_b64_tr_b16 a[122:123], v228 offset:6528
    ds_read_b64_tr_b16 a[124:125], v228 offset:5280
    buffer_load_dwordx4 v12, s[8:11], s50 offen  lds
    v_cvt_pk_bf16_f32 v197, v201, v205
    v_cvt_pk_bf16_f32 v198, v202, v206
    v_mfma_f32_32x32x16_bf16 v[128:143], a[140:143], v[192:195], v[128:143]
    s_add_u32 s50, s50, s99
    s_cmp_ge_u32 s50, 1605632
    s_cselect_b32 s50, s96, s50
    ds_read_b64_tr_b16 a[126:127], v228 offset:6560
    v_cvt_pk_bf16_f32 v199, v203, v207
    s_add_u32 m0, s60, 12288
    v_mfma_f32_32x32x16_bf16 v[144:159], a[144:147], v[192:195], v[144:159]
    s_waitcnt lgkmcnt(8)
    s_add_u32 s46, s75, 14336
    ds_read_b64_tr_b16 a[128:129], v228 offset:5312
    ds_read_b64_tr_b16 a[130:131], v228 offset:6592
    ds_read_b64_tr_b16 a[132:133], v228 offset:5344
    buffer_load_dwordx4 v15, s[24:27], s46 offen  lds
    v_mfma_f32_32x32x16_bf16 v[160:175], a[148:151], v[192:195], v[160:175]
    ds_read_b64_tr_b16 a[134:135], v228 offset:6624
    ds_read_b64_tr_b16 a[136:137], v228 offset:5376
    ds_read_b64_tr_b16 a[138:139], v228 offset:6656
    v_accvgpr_read_b32 v204, a56
    v_accvgpr_read_b32 v205, a57
    v_accvgpr_read_b32 v206, a58
    v_mfma_f32_32x32x16_bf16 v[16:31], a[152:155], v[196:199], v[16:31]
    buffer_load_dwordx4 v233, s[24:27], s46 offen offset:1024  lds
    v_accvgpr_read_b32 v207, a59
    v_lshlrev_b32 v200, 16, v204
    v_lshlrev_b32 v201, 16, v205
    v_lshlrev_b32 v202, 16, v206
    v_lshlrev_b32 v203, 16, v207
    v_mfma_f32_32x32x16_bf16 v[32:47], a[156:159], v[196:199], v[32:47]
    s_waitcnt lgkmcnt(8)
    ds_read_b64_tr_b16 a[140:141], v228 offset:5408
    ds_read_b64_tr_b16 a[142:143], v228 offset:6688
    v_and_b32 v204, s53, v204
    v_and_b32 v205, s53, v205
    v_and_b32 v206, s53, v206
    v_mfma_f32_32x32x16_bf16 v[48:63], a[112:115], v[196:199], v[48:63]
    s_add_u32 m0, s60, 14336
    s_add_u32 s46, s75, 28672
    buffer_load_dwordx4 v15, s[24:27], s46 offen  lds
    v_and_b32 v207, s53, v207
    v_fma_f32 v200, v200, v13, v14
    v_fma_f32 v201, v201, v13, v14
    v_mfma_f32_32x32x16_bf16 v[64:79], a[116:119], v[196:199], v[64:79]
    v_fma_f32 v202, v202, v13, v14
    v_fma_f32 v203, v203, v13, v14
    v_fma_f32 v204, v204, v13, v14
    v_fma_f32 v205, v205, v13, v14
    v_fma_f32 v206, v206, v13, v14
    v_fma_f32 v207, v207, v13, v14
    v_mfma_f32_32x32x16_bf16 v[80:95], a[120:123], v[196:199], v[80:95]
    s_waitcnt lgkmcnt(6)
    s_waitcnt vmcnt(21) lgkmcnt(0)
    s_barrier
    ds_read_b64_tr_b16 a[144:145], v228 offset:20608
    ds_read_b64_tr_b16 a[146:147], v228 offset:21888
    v_cvt_pk_bf16_f32 v192, v200, v204
    v_mfma_f32_32x32x16_bf16 v[96:111], a[124:127], v[196:199], v[96:111]
    ds_read_b64_tr_b16 a[148:149], v228 offset:20640
    ds_read_b64_tr_b16 a[150:151], v228 offset:21920
    ds_read_b64_tr_b16 a[152:153], v228 offset:20672
    buffer_load_dwordx4 v233, s[24:27], s46 offen offset:1024  lds
    v_cvt_pk_bf16_f32 v193, v201, v205
    v_cvt_pk_bf16_f32 v194, v202, v206
    v_mfma_f32_32x32x16_bf16 v[112:127], a[128:131], v[196:199], v[112:127]
    s_add_u32 m0, s55, 41216
    ds_read_b64_tr_b16 a[154:155], v228 offset:21952
    ds_read_b64_tr_b16 a[156:157], v228 offset:20704
    ds_read_b64_tr_b16 a[158:159], v228 offset:21984
    v_cvt_pk_bf16_f32 v195, v203, v207
    v_mfma_f32_32x32x16_bf16 v[128:143], a[132:135], v[196:199], v[128:143]
    ds_read_b64_tr_b16 a[112:113], v228 offset:20736
    ds_read_b64_tr_b16 a[114:115], v228 offset:22016
    ds_read_b64_tr_b16 a[116:117], v228 offset:20768
    buffer_load_dwordx4 v8, s[8:11], s50 offen offset:0  lds
    v_mfma_f32_32x32x16_bf16 v[144:159], a[136:139], v[196:199], v[144:159]
    ds_read_b64_tr_b16 a[118:119], v228 offset:22048
    ds_read_b64_tr_b16 a[120:121], v228 offset:20800
    ds_read_b64_tr_b16 a[122:123], v228 offset:22080
    v_mfma_f32_32x32x16_bf16 v[160:175], a[140:143], v[196:199], v[160:175]
    s_waitcnt lgkmcnt(8)
    ds_read_b64_tr_b16 a[124:125], v228 offset:20832
    buffer_load_dwordx4 v9, s[8:11], s50 offen offset:1024  lds
    v_accvgpr_read_b32 v204, a60
    v_accvgpr_read_b32 v205, a61
    v_accvgpr_read_b32 v206, a62
    v_mfma_f32_32x32x16_bf16 v[16:31], a[144:147], v[192:195], v[16:31]
    ds_read_b64_tr_b16 a[126:127], v228 offset:22112
    ds_read_b64_tr_b16 a[128:129], v228 offset:20864
    ds_read_b64_tr_b16 a[130:131], v228 offset:22144
    v_accvgpr_read_b32 v207, a63
    v_lshlrev_b32 v200, 16, v204
    v_lshlrev_b32 v201, 16, v205
    v_mfma_f32_32x32x16_bf16 v[32:47], a[148:151], v[192:195], v[32:47]
    ds_read_b64_tr_b16 a[132:133], v228 offset:20896
    ds_read_b64_tr_b16 a[134:135], v228 offset:22176
    buffer_load_dwordx4 v10, s[8:11], s50 offen offset:2048  lds
    v_lshlrev_b32 v202, 16, v206
    v_lshlrev_b32 v203, 16, v207
    v_and_b32 v204, s53, v204
    v_mfma_f32_32x32x16_bf16 v[48:63], a[152:155], v[192:195], v[48:63]
    s_waitcnt lgkmcnt(8)
    ds_read_b64_tr_b16 a[136:137], v228 offset:25728
    ds_read_b64_tr_b16 a[138:139], v228 offset:27008
    v_and_b32 v205, s53, v205
    v_and_b32 v206, s53, v206
    v_and_b32 v207, s53, v207
    v_mfma_f32_32x32x16_bf16 v[64:79], a[156:159], v[192:195], v[64:79]
    ds_read_b64_tr_b16 a[140:141], v228 offset:25760
    ds_read_b64_tr_b16 a[142:143], v228 offset:27040
    buffer_load_dwordx4 v11, s[8:11], s50 offen offset:3072  lds
    v_fma_f32 v200, v200, v13, v14
    v_fma_f32 v201, v201, v13, v14
    v_fma_f32 v202, v202, v13, v14
    v_mfma_f32_32x32x16_bf16 v[80:95], a[112:115], v[192:195], v[80:95]
    ds_read_b64_tr_b16 a[144:145], v228 offset:25792
    ds_read_b64_tr_b16 a[146:147], v228 offset:27072
    v_fma_f32 v203, v203, v13, v14
    v_fma_f32 v204, v204, v13, v14
    v_fma_f32 v205, v205, v13, v14
    v_fma_f32 v206, v206, v13, v14
    v_mfma_f32_32x32x16_bf16 v[96:111], a[116:119], v[192:195], v[96:111]
    s_waitcnt lgkmcnt(8)
    ds_read_b64_tr_b16 a[148:149], v228 offset:25824
    ds_read_b64_tr_b16 a[150:151], v228 offset:27104
    ds_read_b64_tr_b16 a[152:153], v228 offset:25856
    v_fma_f32 v207, v207, v13, v14
    v_cvt_pk_bf16_f32 v196, v200, v204
    v_mfma_f32_32x32x16_bf16 v[112:127], a[120:123], v[192:195], v[112:127]
    s_add_u32 m0, s55, 45312
    ds_read_b64_tr_b16 a[154:155], v228 offset:27136
    ds_read_b64_tr_b16 a[156:157], v228 offset:25888
    buffer_load_dwordx4 v12, s[8:11], s50 offen  lds
    v_cvt_pk_bf16_f32 v197, v201, v205
    v_cvt_pk_bf16_f32 v198, v202, v206
    v_mfma_f32_32x32x16_bf16 v[128:143], a[124:127], v[192:195], v[128:143]
    s_add_u32 s50, s50, s98
    ds_read_b64_tr_b16 a[158:159], v228 offset:27168
    v_cvt_pk_bf16_f32 v199, v203, v207
    v_mfma_f32_32x32x16_bf16 v[144:159], a[128:131], v[192:195], v[144:159]
    s_waitcnt lgkmcnt(8)
    ds_read_b64_tr_b16 a[112:113], v228 offset:25920
    ds_read_b64_tr_b16 a[114:115], v228 offset:27200
    ds_read_b64_tr_b16 a[116:117], v228 offset:25952
    v_mfma_f32_32x32x16_bf16 v[160:175], a[132:135], v[192:195], v[160:175]
    ds_read_b64_tr_b16 a[118:119], v228 offset:27232
    ds_read_b64_tr_b16 a[120:121], v228 offset:25984
    ds_read_b64_tr_b16 a[122:123], v228 offset:27264
    v_accvgpr_read_b32 v204, a64
    v_accvgpr_read_b32 v205, a65
    v_accvgpr_read_b32 v206, a66
    v_mfma_f32_32x32x16_bf16 v[16:31], a[136:139], v[196:199], v[16:31]
    v_accvgpr_read_b32 v207, a67
    v_lshlrev_b32 v200, 16, v204
    v_lshlrev_b32 v201, 16, v205
    v_lshlrev_b32 v202, 16, v206
    v_lshlrev_b32 v203, 16, v207
    v_and_b32 v204, s53, v204
    v_mfma_f32_32x32x16_bf16 v[32:47], a[140:143], v[196:199], v[32:47]
    s_waitcnt lgkmcnt(8)
    ds_read_b64_tr_b16 a[124:125], v228 offset:26016
    ds_read_b64_tr_b16 a[126:127], v228 offset:27296
    v_and_b32 v205, s53, v205
    v_and_b32 v206, s53, v206
    v_and_b32 v207, s53, v207
    v_mfma_f32_32x32x16_bf16 v[48:63], a[144:147], v[196:199], v[48:63]
    ds_read_b64_tr_b16 a[160:161], v244 offset:0
    ds_read_b64_tr_b16 a[162:163], v244 offset:1024
    ds_read_b64_tr_b16 a[164:165], v245 offset:0
    v_fma_f32 v200, v200, v13, v14
    v_fma_f32 v201, v201, v13, v14
    v_fma_f32 v202, v202, v13, v14
    v_mfma_f32_32x32x16_bf16 v[64:79], a[148:151], v[196:199], v[64:79]
    ds_read_b64_tr_b16 a[166:167], v245 offset:1024
    v_fma_f32 v203, v203, v13, v14
    v_fma_f32 v204, v204, v13, v14
    v_fma_f32 v205, v205, v13, v14
    v_fma_f32 v206, v206, v13, v14
    v_fma_f32 v207, v207, v13, v14
    v_mfma_f32_32x32x16_bf16 v[80:95], a[152:155], v[196:199], v[80:95]
    s_waitcnt lgkmcnt(8)
    s_waitcnt vmcnt(18) lgkmcnt(0)
    s_barrier
    ds_read_b64_tr_b16 a[128:129], v1 offset:0
    ds_read_b64_tr_b16 a[130:131], v1 offset:1280
    v_cvt_pk_bf16_f32 v192, v200, v204
    v_mfma_f32_32x32x16_bf16 v[96:111], a[156:159], v[196:199], v[96:111]
    s_mov_b32 s57, 28672
    ds_read_b64_tr_b16 a[132:133], v1 offset:32
    ds_read_b64_tr_b16 a[134:135], v1 offset:1312
    ds_read_b64_tr_b16 a[136:137], v1 offset:64
    buffer_load_dwordx4 a[48:51], v249, s[4:7], 0 offen
    v_cvt_pk_bf16_f32 v193, v201, v205
    v_mfma_f32_32x32x16_bf16 v[112:127], a[112:115], v[196:199], v[112:127]
    ds_read_b64_tr_b16 a[138:139], v1 offset:1344
    ds_read_b64_tr_b16 a[140:141], v1 offset:96
    ds_read_b64_tr_b16 a[142:143], v1 offset:1376
    v_cvt_pk_bf16_f32 v194, v202, v206
    v_cvt_pk_bf16_f32 v195, v203, v207
    v_mfma_f32_32x32x16_bf16 v[128:143], a[116:119], v[196:199], v[128:143]
    ds_read_b64_tr_b16 a[144:145], v1 offset:128
    ds_read_b64_tr_b16 a[146:147], v1 offset:1408
    ds_read_b64_tr_b16 a[148:149], v1 offset:160
    buffer_load_dwordx4 a[52:55], v249, s[4:7], s57 offen
    s_add_u32 m0, s55, 61824
    v_mfma_f32_32x32x16_bf16 v[144:159], a[120:123], v[196:199], v[144:159]
    ds_read_b64_tr_b16 a[150:151], v1 offset:1440
    ds_read_b64_tr_b16 a[152:153], v1 offset:192
    ds_read_b64_tr_b16 a[154:155], v1 offset:1472
    v_mfma_f32_32x32x16_bf16 v[160:175], a[124:127], v[196:199], v[160:175]
    s_waitcnt lgkmcnt(8)
    ds_read_b64_tr_b16 a[156:157], v1 offset:224
    buffer_load_dwordx4 v8, s[8:11], s50 offen offset:0  lds
    v_accvgpr_read_b32 v204, a68
    v_accvgpr_read_b32 v205, a69
    v_accvgpr_read_b32 v206, a70
    v_mfma_f32_32x32x16_bf16 v[16:31], a[128:131], v[192:195], v[16:31]
    ds_read_b64_tr_b16 a[158:159], v1 offset:1504
    ds_read_b64_tr_b16 a[112:113], v1 offset:256
    ds_read_b64_tr_b16 a[114:115], v1 offset:1536
    v_accvgpr_read_b32 v207, a71
    v_lshlrev_b32 v200, 16, v204
    v_lshlrev_b32 v201, 16, v205
    v_mfma_f32_32x32x16_bf16 v[32:47], a[132:135], v[192:195], v[32:47]
    ds_read_b64_tr_b16 a[116:117], v1 offset:288
    ds_read_b64_tr_b16 a[118:119], v1 offset:1568
    buffer_load_dwordx4 v9, s[8:11], s50 offen offset:1024  lds
    v_lshlrev_b32 v202, 16, v206
    v_lshlrev_b32 v203, 16, v207
    v_and_b32 v204, s53, v204
    v_mfma_f32_32x32x16_bf16 v[48:63], a[136:139], v[192:195], v[48:63]
    s_waitcnt lgkmcnt(8)
    ds_read_b64_tr_b16 a[120:121], v1 offset:5120
    ds_read_b64_tr_b16 a[122:123], v1 offset:6400
    v_and_b32 v205, s53, v205
    v_and_b32 v206, s53, v206
    v_and_b32 v207, s53, v207
    v_mfma_f32_32x32x16_bf16 v[64:79], a[140:143], v[192:195], v[64:79]
    ds_read_b64_tr_b16 a[124:125], v1 offset:5152
    ds_read_b64_tr_b16 a[126:127], v1 offset:6432
    buffer_load_dwordx4 v10, s[8:11], s50 offen offset:2048  lds
    v_fma_f32 v200, v200, v13, v14
    v_fma_f32 v201, v201, v13, v14
    v_fma_f32 v202, v202, v13, v14
    v_mfma_f32_32x32x16_bf16 v[80:95], a[144:147], v[192:195], v[80:95]
    ds_read_b64_tr_b16 a[128:129], v1 offset:5184
    ds_read_b64_tr_b16 a[130:131], v1 offset:6464
    v_fma_f32 v203, v203, v13, v14
    v_fma_f32 v204, v204, v13, v14
    v_fma_f32 v205, v205, v13, v14
    v_fma_f32 v206, v206, v13, v14
    v_mfma_f32_32x32x16_bf16 v[96:111], a[148:151], v[192:195], v[96:111]
    s_waitcnt lgkmcnt(8)
    ds_read_b64_tr_b16 a[132:133], v1 offset:5216
    ds_read_b64_tr_b16 a[134:135], v1 offset:6496
    buffer_load_dwordx4 v11, s[8:11], s50 offen offset:3072  lds
    v_fma_f32 v207, v207, v13, v14
    v_cvt_pk_bf16_f32 v196, v200, v204
    v_mfma_f32_32x32x16_bf16 v[112:127], a[152:155], v[192:195], v[112:127]
    s_add_u32 m0, s55, 65920
    ds_read_b64_tr_b16 a[136:137], v1 offset:5248
    ds_read_b64_tr_b16 a[138:139], v1 offset:6528
    ds_read_b64_tr_b16 a[140:141], v1 offset:5280
    v_cvt_pk_bf16_f32 v197, v201, v205
    v_cvt_pk_bf16_f32 v198, v202, v206
    v_mfma_f32_32x32x16_bf16 v[128:143], a[156:159], v[192:195], v[128:143]
    ds_read_b64_tr_b16 a[142:143], v1 offset:6560
    buffer_load_dwordx4 v12, s[8:11], s50 offen  lds
    v_cvt_pk_bf16_f32 v199, v203, v207
    s_add_u32 s50, s50, s99
    s_cmp_ge_u32 s50, 1605632
    s_cselect_b32 s50, s96, s50
    v_mfma_f32_32x32x16_bf16 v[144:159], a[112:115], v[192:195], v[144:159]
    s_waitcnt lgkmcnt(8)
    ds_read_b64_tr_b16 a[144:145], v1 offset:5312
    ds_read_b64_tr_b16 a[146:147], v1 offset:6592
    ds_read_b64_tr_b16 a[148:149], v1 offset:5344
    s_add_u32 m0, s60, 0
    s_add_u32 s46, s75, 43008
    v_mfma_f32_32x32x16_bf16 v[160:175], a[116:119], v[192:195], v[160:175]
    ds_read_b64_tr_b16 a[150:151], v1 offset:6624
    ds_read_b64_tr_b16 a[152:153], v1 offset:5376
    buffer_load_dwordx4 v15, s[24:27], s46 offen  lds
    v_accvgpr_read_b32 v204, a72
    v_accvgpr_read_b32 v205, a73
    v_accvgpr_read_b32 v206, a74
    v_mfma_f32_32x32x16_bf16 v[16:31], a[120:123], v[196:199], v[16:31]
    ds_read_b64_tr_b16 a[154:155], v1 offset:6656
    v_accvgpr_read_b32 v207, a75
    v_lshlrev_b32 v200, 16, v204
    v_lshlrev_b32 v201, 16, v205
    v_lshlrev_b32 v202, 16, v206
    v_lshlrev_b32 v203, 16, v207
    v_mfma_f32_32x32x16_bf16 v[32:47], a[124:127], v[196:199], v[32:47]
    s_waitcnt lgkmcnt(8)
    ds_read_b64_tr_b16 a[156:157], v1 offset:5408
    buffer_load_dwordx4 v233, s[24:27], s46 offen offset:1024  lds
    v_and_b32 v204, s53, v204
    v_and_b32 v205, s53, v205
    v_and_b32 v206, s53, v206
    v_mfma_f32_32x32x16_bf16 v[48:63], a[128:131], v[196:199], v[48:63]
    ds_read_b64_tr_b16 a[158:159], v1 offset:6688
    ds_read_b64_tr_b16 a[168:169], v244 offset:2048
    ds_read_b64_tr_b16 a[170:171], v244 offset:3072
    v_and_b32 v207, s53, v207
    v_fma_f32 v200, v200, v13, v14
    v_fma_f32 v201, v201, v13, v14
    v_mfma_f32_32x32x16_bf16 v[64:79], a[132:135], v[196:199], v[64:79]
    ds_read_b64_tr_b16 a[172:173], v245 offset:2048
    ds_read_b64_tr_b16 a[174:175], v245 offset:3072
    v_fma_f32 v202, v202, v13, v14
    v_fma_f32 v203, v203, v13, v14
    v_fma_f32 v204, v204, v13, v14
    v_fma_f32 v205, v205, v13, v14
    v_mfma_f32_32x32x16_bf16 v[80:95], a[136:139], v[196:199], v[80:95]
    s_waitcnt lgkmcnt(8)
    v_fma_f32 v206, v206, v13, v14
    v_fma_f32 v207, v207, v13, v14
    v_cvt_pk_bf16_f32 v192, v200, v204
    v_cvt_pk_bf16_f32 v193, v201, v205
    v_cvt_pk_bf16_f32 v194, v202, v206
    v_mfma_f32_32x32x16_bf16 v[96:111], a[140:143], v[196:199], v[96:111]
    s_waitcnt vmcnt(18) lgkmcnt(0)
    s_barrier
    ds_read_b64_tr_b16 a[112:113], v1 offset:20608
    ds_read_b64_tr_b16 a[114:115], v1 offset:21888
    ds_read_b64_tr_b16 a[116:117], v1 offset:20640
    v_cvt_pk_bf16_f32 v195, v203, v207
    v_mfma_f32_32x32x16_bf16 v[112:127], a[144:147], v[196:199], v[112:127]
    s_add_u32 m0, s55, 0
    ds_read_b64_tr_b16 a[118:119], v1 offset:21920
    ds_read_b64_tr_b16 a[120:121], v1 offset:20672
    ds_read_b64_tr_b16 a[122:123], v1 offset:21952
    buffer_load_dwordx4 v8, s[8:11], s50 offen offset:0  lds
    v_mfma_f32_32x32x16_bf16 v[128:143], a[148:151], v[196:199], v[128:143]
    ds_read_b64_tr_b16 a[124:125], v1 offset:20704
    ds_read_b64_tr_b16 a[126:127], v1 offset:21984
    ds_read_b64_tr_b16 a[128:129], v1 offset:20736
    v_mfma_f32_32x32x16_bf16 v[144:159], a[152:155], v[196:199], v[144:159]
    ds_read_b64_tr_b16 a[130:131], v1 offset:22016
    ds_read_b64_tr_b16 a[132:133], v1 offset:20768
    ds_read_b64_tr_b16 a[134:135], v1 offset:22048
    buffer_load_dwordx4 v9, s[8:11], s50 offen offset:1024  lds
    v_mfma_f32_32x32x16_bf16 v[160:175], a[156:159], v[196:199], v[160:175]
    s_waitcnt lgkmcnt(6)
    ds_read_b64_tr_b16 a[136:137], v1 offset:20800
    ds_read_b64_tr_b16 a[138:139], v1 offset:22080
    v_accvgpr_read_b32 v204, a76
    v_accvgpr_read_b32 v205, a77
    v_accvgpr_read_b32 v206, a78
    v_mfma_f32_32x32x16_bf16 v[16:31], a[112:115], v[192:195], v[16:31]
    ds_read_b64_tr_b16 a[140:141], v1 offset:20832
    ds_read_b64_tr_b16 a[142:143], v1 offset:22112
    ds_read_b64_tr_b16 a[144:145], v1 offset:20864
    v_accvgpr_read_b32 v207, a79
    v_lshlrev_b32 v200, 16, v204
    v_lshlrev_b32 v201, 16, v205
    v_mfma_f32_32x32x16_bf16 v[32:47], a[116:119], v[192:195], v[32:47]
    ds_read_b64_tr_b16 a[146:147], v1 offset:22144
    ds_read_b64_tr_b16 a[148:149], v1 offset:20896
    ds_read_b64_tr_b16 a[150:151], v1 offset:22176
    v_lshlrev_b32 v202, 16, v206
    v_lshlrev_b32 v203, 16, v207
    v_and_b32 v204, s53, v204
    v_mfma_f32_32x32x16_bf16 v[48:63], a[120:123], v[192:195], v[48:63]
    s_waitcnt lgkmcnt(8)
    ds_read_b64_tr_b16 a[152:153], v1 offset:25728
    buffer_load_dwordx4 v10, s[8:11], s50 offen offset:2048  lds
    v_and_b32 v205, s53, v205
    v_and_b32 v206, s53, v206
    v_and_b32 v207, s53, v207
    v_mfma_f32_32x32x16_bf16 v[64:79], a[124:127], v[192:195], v[64:79]
    ds_read_b64_tr_b16 a[154:155], v1 offset:27008
    ds_read_b64_tr_b16 a[156:157], v1 offset:25760
    ds_read_b64_tr_b16 a[158:159], v1 offset:27040
    v_fma_f32 v200, v200, v13, v14
    v_fma_f32 v201, v201, v13, v14
    v_fma_f32 v202, v202, v13, v14
    v_mfma_f32_32x32x16_bf16 v[80:95], a[128:131], v[192:195], v[80:95]
    ds_read_b64_tr_b16 a[112:113], v1 offset:25792
    ds_read_b64_tr_b16 a[114:115], v1 offset:27072
    buffer_load_dwordx4 v11, s[8:11], s50 offen offset:3072  lds
    v_fma_f32 v203, v203, v13, v14
    v_fma_f32 v204, v204, v13, v14
    v_fma_f32 v205, v205, v13, v14
    v_mfma_f32_32x32x16_bf16 v[96:111], a[132:135], v[192:195], v[96:111]
    s_waitcnt lgkmcnt(8)
    ds_read_b64_tr_b16 a[116:117], v1 offset:25824
    ds_read_b64_tr_b16 a[118:119], v1 offset:27104
    ds_read_b64_tr_b16 a[120:121], v1 offset:25856
    v_fma_f32 v206, v206, v13, v14
    v_fma_f32 v207, v207, v13, v14
    v_mfma_f32_32x32x16_bf16 v[112:127], a[136:139], v[192:195], v[112:127]
    s_add_u32 m0, s55, 4096
    ds_read_b64_tr_b16 a[122:123], v1 offset:27136
    ds_read_b64_tr_b16 a[124:125], v1 offset:25888
    buffer_load_dwordx4 v12, s[8:11], s50 offen  lds
    v_cvt_pk_bf16_f32 v196, v200, v204
    v_cvt_pk_bf16_f32 v197, v201, v205
    v_mfma_f32_32x32x16_bf16 v[128:143], a[140:143], v[192:195], v[128:143]
    s_add_u32 s50, s50, s98
    ds_read_b64_tr_b16 a[126:127], v1 offset:27168
    v_cvt_pk_bf16_f32 v198, v202, v206
    v_cvt_pk_bf16_f32 v199, v203, v207
    s_add_u32 m0, s60, 2048
    s_add_u32 s46, s75, 57344
    v_mfma_f32_32x32x16_bf16 v[144:159], a[144:147], v[192:195], v[144:159]
    s_waitcnt lgkmcnt(8)
    ds_read_b64_tr_b16 a[128:129], v1 offset:25920
    ds_read_b64_tr_b16 a[130:131], v1 offset:27200
    ds_read_b64_tr_b16 a[132:133], v1 offset:25952
    buffer_load_dwordx4 v15, s[24:27], s46 offen  lds
    v_mfma_f32_32x32x16_bf16 v[160:175], a[148:151], v[192:195], v[160:175]
    ds_read_b64_tr_b16 a[134:135], v1 offset:27232
    ds_read_b64_tr_b16 a[136:137], v1 offset:25984
    ds_read_b64_tr_b16 a[138:139], v1 offset:27264
    v_accvgpr_read_b32 v204, a80
    v_accvgpr_read_b32 v205, a81
    v_accvgpr_read_b32 v206, a82
    v_mfma_f32_32x32x16_bf16 v[16:31], a[152:155], v[196:199], v[16:31]
    buffer_load_dwordx4 v233, s[24:27], s46 offen offset:1024  lds
    v_accvgpr_read_b32 v207, a83
    v_lshlrev_b32 v200, 16, v204
    v_lshlrev_b32 v201, 16, v205
    v_lshlrev_b32 v202, 16, v206
    v_lshlrev_b32 v203, 16, v207
    v_mfma_f32_32x32x16_bf16 v[32:47], a[156:159], v[196:199], v[32:47]
    s_waitcnt lgkmcnt(8)
    ds_read_b64_tr_b16 a[140:141], v1 offset:26016
    ds_read_b64_tr_b16 a[142:143], v1 offset:27296
    v_and_b32 v204, s53, v204
    v_and_b32 v205, s53, v205
    v_and_b32 v206, s53, v206
    v_mfma_f32_32x32x16_bf16 v[48:63], a[112:115], v[196:199], v[48:63]
    ds_read_b64_tr_b16 a[176:177], v244 offset:4096
    ds_read_b64_tr_b16 a[178:179], v244 offset:5120
    ds_read_b64_tr_b16 a[180:181], v245 offset:4096
    v_and_b32 v207, s53, v207
    v_fma_f32 v200, v200, v13, v14
    v_fma_f32 v201, v201, v13, v14
    v_mfma_f32_32x32x16_bf16 v[64:79], a[116:119], v[196:199], v[64:79]
    ds_read_b64_tr_b16 a[182:183], v245 offset:5120
    v_fma_f32 v202, v202, v13, v14
    v_fma_f32 v203, v203, v13, v14
    v_fma_f32 v204, v204, v13, v14
    v_fma_f32 v205, v205, v13, v14
    v_fma_f32 v206, v206, v13, v14
    v_mfma_f32_32x32x16_bf16 v[80:95], a[120:123], v[196:199], v[80:95]
    s_waitcnt lgkmcnt(8)
    s_waitcnt vmcnt(16) lgkmcnt(0)
    s_barrier
    ds_read_b64_tr_b16 a[144:145], v228 offset:0
    v_fma_f32 v207, v207, v13, v14
    v_cvt_pk_bf16_f32 v192, v200, v204
    v_mfma_f32_32x32x16_bf16 v[96:111], a[124:127], v[196:199], v[96:111]
    s_add_u32 m0, s55, 20608
    ds_read_b64_tr_b16 a[146:147], v228 offset:1280
    ds_read_b64_tr_b16 a[148:149], v228 offset:32
    ds_read_b64_tr_b16 a[150:151], v228 offset:1312
    buffer_load_dwordx4 v8, s[8:11], s50 offen offset:0  lds
    v_cvt_pk_bf16_f32 v193, v201, v205
    v_mfma_f32_32x32x16_bf16 v[112:127], a[128:131], v[196:199], v[112:127]
    ds_read_b64_tr_b16 a[152:153], v228 offset:64
    ds_read_b64_tr_b16 a[154:155], v228 offset:1344
    ds_read_b64_tr_b16 a[156:157], v228 offset:96
    v_cvt_pk_bf16_f32 v194, v202, v206
    v_cvt_pk_bf16_f32 v195, v203, v207
    v_mfma_f32_32x32x16_bf16 v[128:143], a[132:135], v[196:199], v[128:143]
    ds_read_b64_tr_b16 a[158:159], v228 offset:1376
    ds_read_b64_tr_b16 a[112:113], v228 offset:128
    ds_read_b64_tr_b16 a[114:115], v228 offset:1408
    buffer_load_dwordx4 v9, s[8:11], s50 offen offset:1024  lds
    v_mfma_f32_32x32x16_bf16 v[144:159], a[136:139], v[196:199], v[144:159]
    ds_read_b64_tr_b16 a[116:117], v228 offset:160
    ds_read_b64_tr_b16 a[118:119], v228 offset:1440
    ds_read_b64_tr_b16 a[120:121], v228 offset:192
    v_mfma_f32_32x32x16_bf16 v[160:175], a[140:143], v[196:199], v[160:175]
    s_waitcnt lgkmcnt(7)
    ds_read_b64_tr_b16 a[122:123], v228 offset:1472
    ds_read_b64_tr_b16 a[124:125], v228 offset:224
    buffer_load_dwordx4 v10, s[8:11], s50 offen offset:2048  lds
    v_accvgpr_read_b32 v204, a84
    v_accvgpr_read_b32 v205, a85
    v_accvgpr_read_b32 v206, a86
    v_mfma_f32_32x32x16_bf16 v[16:31], a[144:147], v[192:195], v[16:31]
    ds_read_b64_tr_b16 a[126:127], v228 offset:1504
    ds_read_b64_tr_b16 a[128:129], v228 offset:256
    ds_read_b64_tr_b16 a[130:131], v228 offset:1536
    v_accvgpr_read_b32 v207, a87
    v_lshlrev_b32 v200, 16, v204
    v_lshlrev_b32 v201, 16, v205
    v_mfma_f32_32x32x16_bf16 v[32:47], a[148:151], v[192:195], v[32:47]
    ds_read_b64_tr_b16 a[132:133], v228 offset:288
    ds_read_b64_tr_b16 a[134:135], v228 offset:1568
    buffer_load_dwordx4 v11, s[8:11], s50 offen offset:3072  lds
    v_lshlrev_b32 v202, 16, v206
    v_lshlrev_b32 v203, 16, v207
    v_and_b32 v204, s53, v204
    v_mfma_f32_32x32x16_bf16 v[48:63], a[152:155], v[192:195], v[48:63]
    s_waitcnt lgkmcnt(8)
    ds_read_b64_tr_b16 a[136:137], v228 offset:5120
    ds_read_b64_tr_b16 a[138:139], v228 offset:6400
    v_and_b32 v205, s53, v205
    v_and_b32 v206, s53, v206
    v_and_b32 v207, s53, v207
    v_mfma_f32_32x32x16_bf16 v[64:79], a[156:159], v[192:195], v[64:79]
    ds_read_b64_tr_b16 a[140:141], v228 offset:5152
    ds_read_b64_tr_b16 a[142:143], v228 offset:6432
    ds_read_b64_tr_b16 a[144:145], v228 offset:5184
    v_fma_f32 v200, v200, v13, v14
    v_fma_f32 v201, v201, v13, v14
    v_fma_f32 v202, v202, v13, v14
    v_mfma_f32_32x32x16_bf16 v[80:95], a[112:115], v[192:195], v[80:95]
    ds_read_b64_tr_b16 a[146:147], v228 offset:6464
    v_fma_f32 v203, v203, v13, v14
    v_fma_f32 v204, v204, v13, v14
    v_fma_f32 v205, v205, v13, v14
    v_fma_f32 v206, v206, v13, v14
    v_fma_f32 v207, v207, v13, v14
    v_mfma_f32_32x32x16_bf16 v[96:111], a[116:119], v[192:195], v[96:111]
    s_waitcnt lgkmcnt(8)
    ds_read_b64_tr_b16 a[148:149], v228 offset:5216
    ds_read_b64_tr_b16 a[150:151], v228 offset:6496
    ds_read_b64_tr_b16 a[152:153], v228 offset:5248
    v_cvt_pk_bf16_f32 v196, v200, v204
    v_cvt_pk_bf16_f32 v197, v201, v205
    v_mfma_f32_32x32x16_bf16 v[112:127], a[120:123], v[192:195], v[112:127]
    s_add_u32 m0, s55, 24704
    ds_read_b64_tr_b16 a[154:155], v228 offset:6528
    ds_read_b64_tr_b16 a[156:157], v228 offset:5280
    ds_read_b64_tr_b16 a[158:159], v228 offset:6560
    buffer_load_dwordx4 v12, s[8:11], s50 offen  lds
    v_cvt_pk_bf16_f32 v198, v202, v206
    v_mfma_f32_32x32x16_bf16 v[128:143], a[124:127], v[192:195], v[128:143]
    s_add_u32 s50, s50, s99
    s_cmp_ge_u32 s50, 1605632
    s_cselect_b32 s50, s96, s50
    v_cvt_pk_bf16_f32 v199, v203, v207
    s_add_u32 m0, s60, 4096
    v_mfma_f32_32x32x16_bf16 v[144:159], a[128:131], v[192:195], v[144:159]
    s_waitcnt lgkmcnt(8)
    ds_read_b64_tr_b16 a[112:113], v228 offset:5312
    ds_read_b64_tr_b16 a[114:115], v228 offset:6592
    ds_read_b64_tr_b16 a[116:117], v228 offset:5344
    buffer_load_dwordx4 v15, s[24:27], s76 offen  lds
    v_mfma_f32_32x32x16_bf16 v[160:175], a[132:135], v[192:195], v[160:175]
    ds_read_b64_tr_b16 a[118:119], v228 offset:6624
    ds_read_b64_tr_b16 a[120:121], v228 offset:5376
    ds_read_b64_tr_b16 a[122:123], v228 offset:6656
    v_accvgpr_read_b32 v204, a88
    v_accvgpr_read_b32 v205, a89
    v_accvgpr_read_b32 v206, a90
    v_mfma_f32_32x32x16_bf16 v[16:31], a[136:139], v[196:199], v[16:31]
    buffer_load_dwordx4 v233, s[24:27], s76 offen offset:1024  lds
    v_accvgpr_read_b32 v207, a91
    v_lshlrev_b32 v200, 16, v204
    v_lshlrev_b32 v201, 16, v205
    v_lshlrev_b32 v202, 16, v206
    v_lshlrev_b32 v203, 16, v207
    v_mfma_f32_32x32x16_bf16 v[32:47], a[140:143], v[196:199], v[32:47]
    s_waitcnt lgkmcnt(8)
    ds_read_b64_tr_b16 a[124:125], v228 offset:5408
    ds_read_b64_tr_b16 a[126:127], v228 offset:6688
    v_and_b32 v204, s53, v204
    v_and_b32 v205, s53, v205
    v_and_b32 v206, s53, v206
    v_mfma_f32_32x32x16_bf16 v[48:63], a[144:147], v[196:199], v[48:63]
    ds_read_b64_tr_b16 a[184:185], v244 offset:6144
    ds_read_b64_tr_b16 a[186:187], v244 offset:7168
    ds_read_b64_tr_b16 a[188:189], v245 offset:6144
    v_and_b32 v207, s53, v207
    v_fma_f32 v200, v200, v13, v14
    v_fma_f32 v201, v201, v13, v14
    v_mfma_f32_32x32x16_bf16 v[64:79], a[148:151], v[196:199], v[64:79]
    ds_read_b64_tr_b16 a[190:191], v245 offset:7168
    v_fma_f32 v202, v202, v13, v14
    v_fma_f32 v203, v203, v13, v14
    v_fma_f32 v204, v204, v13, v14
    v_fma_f32 v205, v205, v13, v14
    v_fma_f32 v206, v206, v13, v14
    v_mfma_f32_32x32x16_bf16 v[80:95], a[152:155], v[196:199], v[80:95]
    s_waitcnt lgkmcnt(8)
    s_waitcnt vmcnt(16) lgkmcnt(0)
    s_barrier
    ds_read_b64_tr_b16 a[128:129], v228 offset:20608
    v_fma_f32 v207, v207, v13, v14
    v_cvt_pk_bf16_f32 v192, v200, v204
    v_mfma_f32_32x32x16_bf16 v[96:111], a[156:159], v[196:199], v[96:111]
    s_add_u32 m0, s60, 6144
    s_add_u32 s46, s76, 14336
    ds_read_b64_tr_b16 a[130:131], v228 offset:21888
    ds_read_b64_tr_b16 a[132:133], v228 offset:20640
    ds_read_b64_tr_b16 a[134:135], v228 offset:21920
    v_cvt_pk_bf16_f32 v193, v201, v205
    v_mfma_f32_32x32x16_bf16 v[112:127], a[112:115], v[196:199], v[112:127]
    ds_read_b64_tr_b16 a[136:137], v228 offset:20672
    ds_read_b64_tr_b16 a[138:139], v228 offset:21952
    ds_read_b64_tr_b16 a[140:141], v228 offset:20704
    buffer_load_dwordx4 v15, s[24:27], s46 offen  lds
    v_cvt_pk_bf16_f32 v194, v202, v206
    v_cvt_pk_bf16_f32 v195, v203, v207
    v_mfma_f32_32x32x16_bf16 v[128:143], a[116:119], v[196:199], v[128:143]
    ds_read_b64_tr_b16 a[142:143], v228 offset:21984
    ds_read_b64_tr_b16 a[144:145], v228 offset:20736
    ds_read_b64_tr_b16 a[146:147], v228 offset:22016
    v_mfma_f32_32x32x16_bf16 v[144:159], a[120:123], v[196:199], v[144:159]
    ds_read_b64_tr_b16 a[148:149], v228 offset:20768
    ds_read_b64_tr_b16 a[150:151], v228 offset:22048
    ds_read_b64_tr_b16 a[152:153], v228 offset:20800
    buffer_load_dwordx4 v233, s[24:27], s46 offen offset:1024  lds
    v_mfma_f32_32x32x16_bf16 v[160:175], a[124:127], v[196:199], v[160:175]
    s_waitcnt lgkmcnt(7)
    ds_read_b64_tr_b16 a[154:155], v228 offset:22080
    ds_read_b64_tr_b16 a[156:157], v228 offset:20832
    v_accvgpr_read_b32 v204, a92
    v_accvgpr_read_b32 v205, a93
    v_accvgpr_read_b32 v206, a94
    v_mfma_f32_32x32x16_bf16 v[16:31], a[128:131], v[192:195], v[16:31]
    ds_read_b64_tr_b16 a[158:159], v228 offset:22112
    ds_read_b64_tr_b16 a[112:113], v228 offset:20864
    ds_read_b64_tr_b16 a[114:115], v228 offset:22144
    v_accvgpr_read_b32 v207, a95
    v_lshlrev_b32 v200, 16, v204
    v_lshlrev_b32 v201, 16, v205
    v_mfma_f32_32x32x16_bf16 v[32:47], a[132:135], v[192:195], v[32:47]
    ds_read_b64_tr_b16 a[116:117], v228 offset:20896
    ds_read_b64_tr_b16 a[118:119], v228 offset:22176
    v_lshlrev_b32 v202, 16, v206
    v_lshlrev_b32 v203, 16, v207
    v_and_b32 v204, s53, v204
    v_and_b32 v205, s53, v205
    v_mfma_f32_32x32x16_bf16 v[48:63], a[136:139], v[192:195], v[48:63]
    s_waitcnt lgkmcnt(8)
    ds_read_b64_tr_b16 a[120:121], v228 offset:25728
    ds_read_b64_tr_b16 a[122:123], v228 offset:27008
    v_and_b32 v206, s53, v206
    v_and_b32 v207, s53, v207
    v_fma_f32 v200, v200, v13, v14
    v_mfma_f32_32x32x16_bf16 v[64:79], a[140:143], v[192:195], v[64:79]
    ds_read_b64_tr_b16 a[124:125], v228 offset:25760
    ds_read_b64_tr_b16 a[126:127], v228 offset:27040
    ds_read_b64_tr_b16 a[128:129], v228 offset:25792
    v_fma_f32 v201, v201, v13, v14
    v_fma_f32 v202, v202, v13, v14
    v_fma_f32 v203, v203, v13, v14
    v_mfma_f32_32x32x16_bf16 v[80:95], a[144:147], v[192:195], v[80:95]
    ds_read_b64_tr_b16 a[130:131], v228 offset:27072
    v_fma_f32 v204, v204, v13, v14
    v_fma_f32 v205, v205, v13, v14
    v_fma_f32 v206, v206, v13, v14
    v_fma_f32 v207, v207, v13, v14
    v_cvt_pk_bf16_f32 v196, v200, v204
    v_mfma_f32_32x32x16_bf16 v[96:111], a[148:151], v[192:195], v[96:111]
    s_waitcnt lgkmcnt(8)
    ds_read_b64_tr_b16 a[132:133], v228 offset:25824
    ds_read_b64_tr_b16 a[134:135], v228 offset:27104
    ds_read_b64_tr_b16 a[136:137], v228 offset:25856
    v_cvt_pk_bf16_f32 v197, v201, v205
    v_cvt_pk_bf16_f32 v198, v202, v206
    v_mfma_f32_32x32x16_bf16 v[112:127], a[152:155], v[192:195], v[112:127]
    ds_read_b64_tr_b16 a[138:139], v228 offset:27136
    ds_read_b64_tr_b16 a[140:141], v228 offset:25888
    ds_read_b64_tr_b16 a[142:143], v228 offset:27168
    v_cvt_pk_bf16_f32 v199, v203, v207
    v_mfma_f32_32x32x16_bf16 v[128:143], a[156:159], v[192:195], v[128:143]
    v_mfma_f32_32x32x16_bf16 v[144:159], a[112:115], v[192:195], v[144:159]
    s_waitcnt lgkmcnt(8)
    ds_read_b64_tr_b16 a[144:145], v228 offset:25920
    ds_read_b64_tr_b16 a[146:147], v228 offset:27200
    ds_read_b64_tr_b16 a[148:149], v228 offset:25952
    v_mfma_f32_32x32x16_bf16 v[160:175], a[116:119], v[192:195], v[160:175]
    ds_read_b64_tr_b16 a[150:151], v228 offset:27232
    ds_read_b64_tr_b16 a[152:153], v228 offset:25984
    ds_read_b64_tr_b16 a[154:155], v228 offset:27264
    v_accvgpr_read_b32 v204, a96
    v_accvgpr_read_b32 v205, a97
    v_accvgpr_read_b32 v206, a98
    v_mfma_f32_32x32x16_bf16 v[16:31], a[120:123], v[196:199], v[16:31]
    v_accvgpr_read_b32 v207, a99
    v_lshlrev_b32 v200, 16, v204
    v_lshlrev_b32 v201, 16, v205
    v_lshlrev_b32 v202, 16, v206
    v_lshlrev_b32 v203, 16, v207
    v_and_b32 v204, s53, v204
    v_mfma_f32_32x32x16_bf16 v[32:47], a[124:127], v[196:199], v[32:47]
    s_waitcnt lgkmcnt(8)
    ds_read_b64_tr_b16 a[156:157], v228 offset:26016
    ds_read_b64_tr_b16 a[158:159], v228 offset:27296
    v_and_b32 v205, s53, v205
    v_and_b32 v206, s53, v206
    v_and_b32 v207, s53, v207
    v_mfma_f32_32x32x16_bf16 v[48:63], a[128:131], v[196:199], v[48:63]
    ds_read_b64_tr_b16 a[192:193], v244 offset:8192
    ds_read_b64_tr_b16 a[194:195], v244 offset:9216
    ds_read_b64_tr_b16 a[196:197], v245 offset:8192
    v_fma_f32 v200, v200, v13, v14
    v_fma_f32 v201, v201, v13, v14
    v_fma_f32 v202, v202, v13, v14
    v_mfma_f32_32x32x16_bf16 v[64:79], a[132:135], v[196:199], v[64:79]
    ds_read_b64_tr_b16 a[198:199], v245 offset:9216
    v_fma_f32 v203, v203, v13, v14
    v_fma_f32 v204, v204, v13, v14
    v_fma_f32 v205, v205, v13, v14
    v_fma_f32 v206, v206, v13, v14
    v_fma_f32 v207, v207, v13, v14
    v_mfma_f32_32x32x16_bf16 v[80:95], a[136:139], v[196:199], v[80:95]
    s_waitcnt lgkmcnt(8)
    s_waitcnt vmcnt(11) lgkmcnt(0)
    s_barrier
    ds_read_b64_tr_b16 a[112:113], v1 offset:0
    ds_read_b64_tr_b16 a[114:115], v1 offset:1280
    v_cvt_pk_bf16_f32 v192, v200, v204
    v_mfma_f32_32x32x16_bf16 v[96:111], a[140:143], v[196:199], v[96:111]
    s_add_u32 m0, s60, 8192
    s_add_u32 s46, s76, 28672
    ds_read_b64_tr_b16 a[116:117], v1 offset:32
    ds_read_b64_tr_b16 a[118:119], v1 offset:1312
    ds_read_b64_tr_b16 a[120:121], v1 offset:64
    v_cvt_pk_bf16_f32 v193, v201, v205
    v_mfma_f32_32x32x16_bf16 v[112:127], a[144:147], v[196:199], v[112:127]
    ds_read_b64_tr_b16 a[122:123], v1 offset:1344
    ds_read_b64_tr_b16 a[124:125], v1 offset:96
    ds_read_b64_tr_b16 a[126:127], v1 offset:1376
    buffer_load_dwordx4 v15, s[24:27], s46 offen  lds
    v_cvt_pk_bf16_f32 v194, v202, v206
    v_cvt_pk_bf16_f32 v195, v203, v207
    v_mfma_f32_32x32x16_bf16 v[128:143], a[148:151], v[196:199], v[128:143]
    ds_read_b64_tr_b16 a[128:129], v1 offset:128
    ds_read_b64_tr_b16 a[130:131], v1 offset:1408
    ds_read_b64_tr_b16 a[132:133], v1 offset:160
    v_mfma_f32_32x32x16_bf16 v[144:159], a[152:155], v[196:199], v[144:159]
    ds_read_b64_tr_b16 a[134:135], v1 offset:1440
    ds_read_b64_tr_b16 a[136:137], v1 offset:192
    ds_read_b64_tr_b16 a[138:139], v1 offset:1472
    buffer_load_dwordx4 v233, s[24:27], s46 offen offset:1024  lds
    v_mfma_f32_32x32x16_bf16 v[160:175], a[156:159], v[196:199], v[160:175]
    s_waitcnt lgkmcnt(8)
    ds_read_b64_tr_b16 a[140:141], v1 offset:224
    ds_read_b64_tr_b16 a[142:143], v1 offset:1504
    v_accvgpr_read_b32 v204, a100
    v_accvgpr_read_b32 v205, a101
    v_accvgpr_read_b32 v206, a102
    v_mfma_f32_32x32x16_bf16 v[16:31], a[112:115], v[192:195], v[16:31]
    ds_read_b64_tr_b16 a[144:145], v1 offset:256
    ds_read_b64_tr_b16 a[146:147], v1 offset:1536
    ds_read_b64_tr_b16 a[148:149], v1 offset:288
    v_accvgpr_read_b32 v207, a103
    v_lshlrev_b32 v200, 16, v204
    v_lshlrev_b32 v201, 16, v205
    v_mfma_f32_32x32x16_bf16 v[32:47], a[116:119], v[192:195], v[32:47]
    ds_read_b64_tr_b16 a[150:151], v1 offset:1568
    v_lshlrev_b32 v202, 16, v206
    v_lshlrev_b32 v203, 16, v207
    v_and_b32 v204, s53, v204
    v_and_b32 v205, s53, v205
    v_and_b32 v206, s53, v206
    v_mfma_f32_32x32x16_bf16 v[48:63], a[120:123], v[192:195], v[48:63]
    s_waitcnt lgkmcnt(8)
    ds_read_b64_tr_b16 a[152:153], v1 offset:5120
    ds_read_b64_tr_b16 a[154:155], v1 offset:6400
    v_and_b32 v207, s53, v207
    v_fma_f32 v200, v200, v13, v14
    v_fma_f32 v201, v201, v13, v14
    v_mfma_f32_32x32x16_bf16 v[64:79], a[124:127], v[192:195], v[64:79]
    ds_read_b64_tr_b16 a[156:157], v1 offset:5152
    ds_read_b64_tr_b16 a[158:159], v1 offset:6432
    ds_read_b64_tr_b16 a[112:113], v1 offset:5184
    v_fma_f32 v202, v202, v13, v14
    v_fma_f32 v203, v203, v13, v14
    v_fma_f32 v204, v204, v13, v14
    v_mfma_f32_32x32x16_bf16 v[80:95], a[128:131], v[192:195], v[80:95]
    ds_read_b64_tr_b16 a[114:115], v1 offset:6464
    v_fma_f32 v205, v205, v13, v14
    v_fma_f32 v206, v206, v13, v14
    v_fma_f32 v207, v207, v13, v14
    v_cvt_pk_bf16_f32 v196, v200, v204
    v_cvt_pk_bf16_f32 v197, v201, v205
    v_mfma_f32_32x32x16_bf16 v[96:111], a[132:135], v[192:195], v[96:111]
    s_waitcnt lgkmcnt(8)
    ds_read_b64_tr_b16 a[116:117], v1 offset:5216
    ds_read_b64_tr_b16 a[118:119], v1 offset:6496
    ds_read_b64_tr_b16 a[120:121], v1 offset:5248
    v_cvt_pk_bf16_f32 v198, v202, v206
    v_cvt_pk_bf16_f32 v199, v203, v207
    v_mfma_f32_32x32x16_bf16 v[112:127], a[136:139], v[192:195], v[112:127]
    ds_read_b64_tr_b16 a[122:123], v1 offset:6528
    ds_read_b64_tr_b16 a[124:125], v1 offset:5280
    ds_read_b64_tr_b16 a[126:127], v1 offset:6560
    v_mfma_f32_32x32x16_bf16 v[128:143], a[140:143], v[192:195], v[128:143]
    v_mfma_f32_32x32x16_bf16 v[144:159], a[144:147], v[192:195], v[144:159]
    s_waitcnt lgkmcnt(8)
    ds_read_b64_tr_b16 a[128:129], v1 offset:5312
    ds_read_b64_tr_b16 a[130:131], v1 offset:6592
    ds_read_b64_tr_b16 a[132:133], v1 offset:5344
    v_mfma_f32_32x32x16_bf16 v[160:175], a[148:151], v[192:195], v[160:175]
    ds_read_b64_tr_b16 a[134:135], v1 offset:6624
    ds_read_b64_tr_b16 a[136:137], v1 offset:5376
    ds_read_b64_tr_b16 a[138:139], v1 offset:6656
    v_accvgpr_read_b32 v204, a104
    v_accvgpr_read_b32 v205, a105
    v_accvgpr_read_b32 v206, a106
    v_mfma_f32_32x32x16_bf16 v[16:31], a[152:155], v[196:199], v[16:31]
    v_accvgpr_read_b32 v207, a107
    v_lshlrev_b32 v200, 16, v204
    v_lshlrev_b32 v201, 16, v205
    v_lshlrev_b32 v202, 16, v206
    v_lshlrev_b32 v203, 16, v207
    v_and_b32 v204, s53, v204
    v_mfma_f32_32x32x16_bf16 v[32:47], a[156:159], v[196:199], v[32:47]
    s_waitcnt lgkmcnt(8)
    ds_read_b64_tr_b16 a[140:141], v1 offset:5408
    ds_read_b64_tr_b16 a[142:143], v1 offset:6688
    v_and_b32 v205, s53, v205
    v_and_b32 v206, s53, v206
    v_and_b32 v207, s53, v207
    v_mfma_f32_32x32x16_bf16 v[48:63], a[112:115], v[196:199], v[48:63]
    ds_read_b64_tr_b16 a[200:201], v244 offset:10240
    ds_read_b64_tr_b16 a[202:203], v244 offset:11264
    ds_read_b64_tr_b16 a[204:205], v245 offset:10240
    v_fma_f32 v200, v200, v13, v14
    v_fma_f32 v201, v201, v13, v14
    v_fma_f32 v202, v202, v13, v14
    v_mfma_f32_32x32x16_bf16 v[64:79], a[116:119], v[196:199], v[64:79]
    ds_read_b64_tr_b16 a[206:207], v245 offset:11264
    v_fma_f32 v203, v203, v13, v14
    v_fma_f32 v204, v204, v13, v14
    v_fma_f32 v205, v205, v13, v14
    v_fma_f32 v206, v206, v13, v14
    v_fma_f32 v207, v207, v13, v14
    v_mfma_f32_32x32x16_bf16 v[80:95], a[120:123], v[196:199], v[80:95]
    s_waitcnt lgkmcnt(8)
    s_waitcnt vmcnt(6) lgkmcnt(0)
    s_barrier
    ds_read_b64_tr_b16 a[144:145], v1 offset:20608
    ds_read_b64_tr_b16 a[146:147], v1 offset:21888
    v_cvt_pk_bf16_f32 v192, v200, v204
    v_mfma_f32_32x32x16_bf16 v[96:111], a[124:127], v[196:199], v[96:111]
    s_add_u32 m0, s60, 10240
    s_add_u32 s46, s76, 43008
    ds_read_b64_tr_b16 a[148:149], v1 offset:20640
    ds_read_b64_tr_b16 a[150:151], v1 offset:21920
    ds_read_b64_tr_b16 a[152:153], v1 offset:20672
    v_cvt_pk_bf16_f32 v193, v201, v205
    v_mfma_f32_32x32x16_bf16 v[112:127], a[128:131], v[196:199], v[112:127]
    ds_read_b64_tr_b16 a[154:155], v1 offset:21952
    ds_read_b64_tr_b16 a[156:157], v1 offset:20704
    ds_read_b64_tr_b16 a[158:159], v1 offset:21984
    buffer_load_dwordx4 v15, s[24:27], s46 offen  lds
    v_cvt_pk_bf16_f32 v194, v202, v206
    v_cvt_pk_bf16_f32 v195, v203, v207
    v_mfma_f32_32x32x16_bf16 v[128:143], a[132:135], v[196:199], v[128:143]
    ds_read_b64_tr_b16 a[112:113], v1 offset:20736
    ds_read_b64_tr_b16 a[114:115], v1 offset:22016
    ds_read_b64_tr_b16 a[116:117], v1 offset:20768
    v_mfma_f32_32x32x16_bf16 v[144:159], a[136:139], v[196:199], v[144:159]
    ds_read_b64_tr_b16 a[118:119], v1 offset:22048
    ds_read_b64_tr_b16 a[120:121], v1 offset:20800
    ds_read_b64_tr_b16 a[122:123], v1 offset:22080
    buffer_load_dwordx4 v233, s[24:27], s46 offen offset:1024  lds
    v_mfma_f32_32x32x16_bf16 v[160:175], a[140:143], v[196:199], v[160:175]
    s_waitcnt lgkmcnt(8)
    ds_read_b64_tr_b16 a[124:125], v1 offset:20832
    ds_read_b64_tr_b16 a[126:127], v1 offset:22112
    v_accvgpr_read_b32 v204, a108
    v_accvgpr_read_b32 v205, a109
    v_accvgpr_read_b32 v206, a110
    v_mfma_f32_32x32x16_bf16 v[16:31], a[144:147], v[192:195], v[16:31]
    ds_read_b64_tr_b16 a[128:129], v1 offset:20864
    ds_read_b64_tr_b16 a[130:131], v1 offset:22144
    ds_read_b64_tr_b16 a[132:133], v1 offset:20896
    v_accvgpr_read_b32 v207, a111
    v_lshlrev_b32 v200, 16, v204
    v_lshlrev_b32 v201, 16, v205
    v_mfma_f32_32x32x16_bf16 v[32:47], a[148:151], v[192:195], v[32:47]
    ds_read_b64_tr_b16 a[134:135], v1 offset:22176
    v_lshlrev_b32 v202, 16, v206
    v_lshlrev_b32 v203, 16, v207
    v_and_b32 v204, s53, v204
    v_and_b32 v205, s53, v205
    v_and_b32 v206, s53, v206
    v_mfma_f32_32x32x16_bf16 v[48:63], a[152:155], v[192:195], v[48:63]
    s_waitcnt lgkmcnt(8)
    ds_read_b64_tr_b16 a[136:137], v1 offset:25728
    ds_read_b64_tr_b16 a[138:139], v1 offset:27008
    v_and_b32 v207, s53, v207
    v_fma_f32 v200, v200, v13, v14
    v_fma_f32 v201, v201, v13, v14
    v_mfma_f32_32x32x16_bf16 v[64:79], a[156:159], v[192:195], v[64:79]
    ds_read_b64_tr_b16 a[140:141], v1 offset:25760
    ds_read_b64_tr_b16 a[142:143], v1 offset:27040
    ds_read_b64_tr_b16 a[144:145], v1 offset:25792
    v_fma_f32 v202, v202, v13, v14
    v_fma_f32 v203, v203, v13, v14
    v_fma_f32 v204, v204, v13, v14
    v_mfma_f32_32x32x16_bf16 v[80:95], a[112:115], v[192:195], v[80:95]
    ds_read_b64_tr_b16 a[146:147], v1 offset:27072
    v_fma_f32 v205, v205, v13, v14
    v_fma_f32 v206, v206, v13, v14
    v_fma_f32 v207, v207, v13, v14
    v_cvt_pk_bf16_f32 v196, v200, v204
    v_cvt_pk_bf16_f32 v197, v201, v205
    v_mfma_f32_32x32x16_bf16 v[96:111], a[116:119], v[192:195], v[96:111]
    s_waitcnt lgkmcnt(8)
    ds_read_b64_tr_b16 a[148:149], v1 offset:25824
    ds_read_b64_tr_b16 a[150:151], v1 offset:27104
    ds_read_b64_tr_b16 a[152:153], v1 offset:25856
    v_cvt_pk_bf16_f32 v198, v202, v206
    v_cvt_pk_bf16_f32 v199, v203, v207
    v_mfma_f32_32x32x16_bf16 v[112:127], a[120:123], v[192:195], v[112:127]
    ds_read_b64_tr_b16 a[154:155], v1 offset:27136
    ds_read_b64_tr_b16 a[156:157], v1 offset:25888
    ds_read_b64_tr_b16 a[158:159], v1 offset:27168
    v_mfma_f32_32x32x16_bf16 v[128:143], a[124:127], v[192:195], v[128:143]
    v_mfma_f32_32x32x16_bf16 v[144:159], a[128:131], v[192:195], v[144:159]
    s_waitcnt lgkmcnt(8)
    ds_read_b64_tr_b16 a[112:113], v1 offset:25920
    ds_read_b64_tr_b16 a[114:115], v1 offset:27200
    ds_read_b64_tr_b16 a[116:117], v1 offset:25952
    v_mfma_f32_32x32x16_bf16 v[160:175], a[132:135], v[192:195], v[160:175]
    ds_read_b64_tr_b16 a[118:119], v1 offset:27232
    ds_read_b64_tr_b16 a[120:121], v1 offset:25984
    ds_read_b64_tr_b16 a[122:123], v1 offset:27264
    v_mfma_f32_32x32x16_bf16 v[16:31], a[136:139], v[196:199], v[16:31]
    v_mfma_f32_32x32x16_bf16 v[32:47], a[140:143], v[196:199], v[32:47]
    s_waitcnt lgkmcnt(8)
    ds_read_b64_tr_b16 a[124:125], v1 offset:26016
    ds_read_b64_tr_b16 a[126:127], v1 offset:27296
    v_mfma_f32_32x32x16_bf16 v[48:63], a[144:147], v[196:199], v[48:63]
    v_mfma_f32_32x32x16_bf16 v[64:79], a[148:151], v[196:199], v[64:79]
    v_mfma_f32_32x32x16_bf16 v[80:95], a[152:155], v[196:199], v[80:95]
    s_waitcnt lgkmcnt(6)
    s_waitcnt lgkmcnt(0)
    s_barrier
    v_mfma_f32_32x32x16_bf16 v[96:111], a[156:159], v[196:199], v[96:111]
    v_mfma_f32_32x32x16_bf16 v[112:127], a[112:115], v[196:199], v[112:127]
    v_mfma_f32_32x32x16_bf16 v[128:143], a[116:119], v[196:199], v[128:143]
    v_mfma_f32_32x32x16_bf16 v[144:159], a[120:123], v[196:199], v[144:159]
    v_mfma_f32_32x32x16_bf16 v[160:175], a[124:127], v[196:199], v[160:175]
    s_add_u32 m0, s61, 0
    s_add_u32 s46, s76, 57344
    buffer_load_dwordx4 v15, s[24:27], s46 offen  lds
    v_pk_mul_f32 v[200:201], v[16:17], v[16:17]
    v_pk_mul_f32 v[202:203], v[18:19], v[18:19]
    v_pk_mul_f32 v[204:205], v[20:21], v[20:21]
    v_pk_mul_f32 v[206:207], v[22:23], v[22:23]
    v_pk_fma_f32 v[200:201], v[200:201], s[84:85], v[250:251]
    v_pk_fma_f32 v[202:203], v[202:203], s[84:85], v[250:251]
    v_pk_fma_f32 v[204:205], v[204:205], s[84:85], v[250:251]
    v_pk_fma_f32 v[206:207], v[206:207], s[84:85], v[250:251]
    v_pk_mul_f32 v[200:201], v[200:201], v[16:17]
    v_pk_mul_f32 v[202:203], v[202:203], v[18:19]
    v_pk_mul_f32 v[204:205], v[204:205], v[20:21]
    v_pk_mul_f32 v[206:207], v[206:207], v[22:23]
    v_exp_f32 v200, v200
    v_exp_f32 v201, v201
    v_exp_f32 v202, v202
    v_exp_f32 v203, v203
    v_exp_f32 v204, v204
    v_exp_f32 v205, v205
    v_exp_f32 v206, v206
    v_exp_f32 v207, v207
    v_pk_mul_f32 v[24:25], v[24:25], v[16:17]
    v_pk_mul_f32 v[26:27], v[26:27], v[18:19]
    v_pk_mul_f32 v[28:29], v[28:29], v[20:21]
    v_pk_mul_f32 v[30:31], v[30:31], v[22:23]
    v_pk_add_f32 v[200:201], v[200:201], 1.0 op_sel_hi:[1,0]
    v_pk_add_f32 v[202:203], v[202:203], 1.0 op_sel_hi:[1,0]
    v_pk_add_f32 v[204:205], v[204:205], 1.0 op_sel_hi:[1,0]
    v_pk_add_f32 v[206:207], v[206:207], 1.0 op_sel_hi:[1,0]
    v_rcp_f32 v200, v200
    v_rcp_f32 v201, v201
    v_rcp_f32 v202, v202
    v_rcp_f32 v203, v203
    v_rcp_f32 v204, v204
    v_rcp_f32 v205, v205
    v_rcp_f32 v206, v206
    v_rcp_f32 v207, v207
    v_pk_mul_f32 v[24:25], v[24:25], v[200:201]
    v_pk_mul_f32 v[26:27], v[26:27], v[202:203]
    v_pk_mul_f32 v[28:29], v[28:29], v[204:205]
    v_pk_mul_f32 v[30:31], v[30:31], v[206:207]
    v_cvt_pk_bf16_f32 v16, v24, v25
    v_cvt_pk_bf16_f32 v17, v26, v27
    v_cvt_pk_bf16_f32 v18, v28, v29
    v_cvt_pk_bf16_f32 v19, v30, v31
    s_add_u32 s57, s56, 0
    buffer_store_dwordx4 v[16:19], v252, s[20:23], s57 offen offset:0 sc1
    v_pk_mul_f32 v[200:201], v[32:33], v[32:33]
    v_pk_mul_f32 v[202:203], v[34:35], v[34:35]
    v_pk_mul_f32 v[204:205], v[36:37], v[36:37]
    v_pk_mul_f32 v[206:207], v[38:39], v[38:39]
    v_pk_fma_f32 v[200:201], v[200:201], s[84:85], v[250:251]
    v_pk_fma_f32 v[202:203], v[202:203], s[84:85], v[250:251]
    v_pk_fma_f32 v[204:205], v[204:205], s[84:85], v[250:251]
    v_pk_fma_f32 v[206:207], v[206:207], s[84:85], v[250:251]
    v_pk_mul_f32 v[200:201], v[200:201], v[32:33]
    v_pk_mul_f32 v[202:203], v[202:203], v[34:35]
    v_pk_mul_f32 v[204:205], v[204:205], v[36:37]
    v_pk_mul_f32 v[206:207], v[206:207], v[38:39]
    v_exp_f32 v200, v200
    v_exp_f32 v201, v201
    v_exp_f32 v202, v202
    v_exp_f32 v203, v203
    v_exp_f32 v204, v204
    v_exp_f32 v205, v205
    v_exp_f32 v206, v206
    v_exp_f32 v207, v207
    v_pk_mul_f32 v[40:41], v[40:41], v[32:33]
    v_pk_mul_f32 v[42:43], v[42:43], v[34:35]
    v_pk_mul_f32 v[44:45], v[44:45], v[36:37]
    v_pk_mul_f32 v[46:47], v[46:47], v[38:39]
    v_pk_add_f32 v[200:201], v[200:201], 1.0 op_sel_hi:[1,0]
    v_pk_add_f32 v[202:203], v[202:203], 1.0 op_sel_hi:[1,0]
    v_pk_add_f32 v[204:205], v[204:205], 1.0 op_sel_hi:[1,0]
    v_pk_add_f32 v[206:207], v[206:207], 1.0 op_sel_hi:[1,0]
    v_rcp_f32 v200, v200
    v_rcp_f32 v201, v201
    v_rcp_f32 v202, v202
    v_rcp_f32 v203, v203
    v_rcp_f32 v204, v204
    v_rcp_f32 v205, v205
    v_rcp_f32 v206, v206
    v_rcp_f32 v207, v207
    v_pk_mul_f32 v[40:41], v[40:41], v[200:201]
    v_pk_mul_f32 v[42:43], v[42:43], v[202:203]
    v_pk_mul_f32 v[44:45], v[44:45], v[204:205]
    v_pk_mul_f32 v[46:47], v[46:47], v[206:207]
    v_cvt_pk_bf16_f32 v32, v40, v41
    v_cvt_pk_bf16_f32 v33, v42, v43
    v_cvt_pk_bf16_f32 v34, v44, v45
    v_cvt_pk_bf16_f32 v35, v46, v47
    buffer_store_dwordx4 v[32:35], v252, s[20:23], s57 offen offset:2048 sc1
    v_pk_mul_f32 v[200:201], v[48:49], v[48:49]
    v_pk_mul_f32 v[202:203], v[50:51], v[50:51]
    v_pk_mul_f32 v[204:205], v[52:53], v[52:53]
    v_pk_mul_f32 v[206:207], v[54:55], v[54:55]
    v_pk_fma_f32 v[200:201], v[200:201], s[84:85], v[250:251]
    v_pk_fma_f32 v[202:203], v[202:203], s[84:85], v[250:251]
    v_pk_fma_f32 v[204:205], v[204:205], s[84:85], v[250:251]
    v_pk_fma_f32 v[206:207], v[206:207], s[84:85], v[250:251]
    buffer_load_dwordx4 v233, s[24:27], s46 offen offset:1024  lds
    v_pk_mul_f32 v[200:201], v[200:201], v[48:49]
    v_pk_mul_f32 v[202:203], v[202:203], v[50:51]
    v_pk_mul_f32 v[204:205], v[204:205], v[52:53]
    v_pk_mul_f32 v[206:207], v[206:207], v[54:55]
    v_exp_f32 v200, v200
    v_exp_f32 v201, v201
    v_exp_f32 v202, v202
    v_exp_f32 v203, v203
    v_exp_f32 v204, v204
    v_exp_f32 v205, v205
    v_exp_f32 v206, v206
    v_exp_f32 v207, v207
    v_pk_mul_f32 v[56:57], v[56:57], v[48:49]
    v_pk_mul_f32 v[58:59], v[58:59], v[50:51]
    v_pk_mul_f32 v[60:61], v[60:61], v[52:53]
    v_pk_mul_f32 v[62:63], v[62:63], v[54:55]
    v_pk_add_f32 v[200:201], v[200:201], 1.0 op_sel_hi:[1,0]
    v_pk_add_f32 v[202:203], v[202:203], 1.0 op_sel_hi:[1,0]
    v_pk_add_f32 v[204:205], v[204:205], 1.0 op_sel_hi:[1,0]
    v_pk_add_f32 v[206:207], v[206:207], 1.0 op_sel_hi:[1,0]
    v_rcp_f32 v200, v200
    v_rcp_f32 v201, v201
    v_rcp_f32 v202, v202
    v_rcp_f32 v203, v203
    v_rcp_f32 v204, v204
    v_rcp_f32 v205, v205
    v_rcp_f32 v206, v206
    v_rcp_f32 v207, v207
    v_pk_mul_f32 v[56:57], v[56:57], v[200:201]
    v_pk_mul_f32 v[58:59], v[58:59], v[202:203]
    v_pk_mul_f32 v[60:61], v[60:61], v[204:205]
    v_pk_mul_f32 v[62:63], v[62:63], v[206:207]
    v_cvt_pk_bf16_f32 v48, v56, v57
    v_cvt_pk_bf16_f32 v49, v58, v59
    v_cvt_pk_bf16_f32 v50, v60, v61
    v_cvt_pk_bf16_f32 v51, v62, v63
    s_add_u32 s57, s56, 4096
    buffer_store_dwordx4 v[48:51], v252, s[20:23], s57 offen offset:0 sc1
    v_pk_mul_f32 v[200:201], v[64:65], v[64:65]
    v_pk_mul_f32 v[202:203], v[66:67], v[66:67]
    v_pk_mul_f32 v[204:205], v[68:69], v[68:69]
    v_pk_mul_f32 v[206:207], v[70:71], v[70:71]
    v_pk_fma_f32 v[200:201], v[200:201], s[84:85], v[250:251]
    v_pk_fma_f32 v[202:203], v[202:203], s[84:85], v[250:251]
    v_pk_fma_f32 v[204:205], v[204:205], s[84:85], v[250:251]
    v_pk_fma_f32 v[206:207], v[206:207], s[84:85], v[250:251]
    v_pk_mul_f32 v[200:201], v[200:201], v[64:65]
    v_pk_mul_f32 v[202:203], v[202:203], v[66:67]
    v_pk_mul_f32 v[204:205], v[204:205], v[68:69]
    v_pk_mul_f32 v[206:207], v[206:207], v[70:71]
    v_exp_f32 v200, v200
    v_exp_f32 v201, v201
    v_exp_f32 v202, v202
    v_exp_f32 v203, v203
    v_exp_f32 v204, v204
    v_exp_f32 v205, v205
    v_exp_f32 v206, v206
    v_exp_f32 v207, v207
    v_pk_mul_f32 v[72:73], v[72:73], v[64:65]
    v_pk_mul_f32 v[74:75], v[74:75], v[66:67]
    v_pk_mul_f32 v[76:77], v[76:77], v[68:69]
    v_pk_mul_f32 v[78:79], v[78:79], v[70:71]
    v_pk_add_f32 v[200:201], v[200:201], 1.0 op_sel_hi:[1,0]
    v_pk_add_f32 v[202:203], v[202:203], 1.0 op_sel_hi:[1,0]
    v_pk_add_f32 v[204:205], v[204:205], 1.0 op_sel_hi:[1,0]
    v_pk_add_f32 v[206:207], v[206:207], 1.0 op_sel_hi:[1,0]
    v_rcp_f32 v200, v200
    v_rcp_f32 v201, v201
    v_rcp_f32 v202, v202
    v_rcp_f32 v203, v203
    v_rcp_f32 v204, v204
    v_rcp_f32 v205, v205
    v_rcp_f32 v206, v206
    v_rcp_f32 v207, v207
    v_pk_mul_f32 v[72:73], v[72:73], v[200:201]
    v_pk_mul_f32 v[74:75], v[74:75], v[202:203]
    v_pk_mul_f32 v[76:77], v[76:77], v[204:205]
    v_pk_mul_f32 v[78:79], v[78:79], v[206:207]
    v_cvt_pk_bf16_f32 v64, v72, v73
    v_cvt_pk_bf16_f32 v65, v74, v75
    v_cvt_pk_bf16_f32 v66, v76, v77
    v_cvt_pk_bf16_f32 v67, v78, v79
    buffer_store_dwordx4 v[64:67], v252, s[20:23], s57 offen offset:2048 sc1
    v_pk_mul_f32 v[200:201], v[80:81], v[80:81]
    v_pk_mul_f32 v[202:203], v[82:83], v[82:83]
    v_pk_mul_f32 v[204:205], v[84:85], v[84:85]
    v_pk_mul_f32 v[206:207], v[86:87], v[86:87]
    v_pk_fma_f32 v[200:201], v[200:201], s[84:85], v[250:251]
    v_pk_fma_f32 v[202:203], v[202:203], s[84:85], v[250:251]
    v_pk_fma_f32 v[204:205], v[204:205], s[84:85], v[250:251]
    v_pk_fma_f32 v[206:207], v[206:207], s[84:85], v[250:251]
    v_pk_mul_f32 v[200:201], v[200:201], v[80:81]
    v_pk_mul_f32 v[202:203], v[202:203], v[82:83]
    v_pk_mul_f32 v[204:205], v[204:205], v[84:85]
    v_pk_mul_f32 v[206:207], v[206:207], v[86:87]
    v_exp_f32 v200, v200
    v_exp_f32 v201, v201
    v_exp_f32 v202, v202
    v_exp_f32 v203, v203
    s_add_u32 m0, s61, 2048
    s_nop 0
    buffer_load_dwordx4 v15, s[24:27], s77 offen  lds
    v_exp_f32 v204, v204
    v_exp_f32 v205, v205
    v_exp_f32 v206, v206
    v_exp_f32 v207, v207
    v_pk_mul_f32 v[88:89], v[88:89], v[80:81]
    v_pk_mul_f32 v[90:91], v[90:91], v[82:83]
    v_pk_mul_f32 v[92:93], v[92:93], v[84:85]
    v_pk_mul_f32 v[94:95], v[94:95], v[86:87]
    v_pk_add_f32 v[200:201], v[200:201], 1.0 op_sel_hi:[1,0]
    v_pk_add_f32 v[202:203], v[202:203], 1.0 op_sel_hi:[1,0]
    v_pk_add_f32 v[204:205], v[204:205], 1.0 op_sel_hi:[1,0]
    v_pk_add_f32 v[206:207], v[206:207], 1.0 op_sel_hi:[1,0]
    v_rcp_f32 v200, v200
    v_rcp_f32 v201, v201
    v_rcp_f32 v202, v202
    v_rcp_f32 v203, v203
    v_rcp_f32 v204, v204
    v_rcp_f32 v205, v205
    v_rcp_f32 v206, v206
    v_rcp_f32 v207, v207
    v_pk_mul_f32 v[88:89], v[88:89], v[200:201]
    v_pk_mul_f32 v[90:91], v[90:91], v[202:203]
    v_pk_mul_f32 v[92:93], v[92:93], v[204:205]
    v_pk_mul_f32 v[94:95], v[94:95], v[206:207]
    v_cvt_pk_bf16_f32 v80, v88, v89
    v_cvt_pk_bf16_f32 v81, v90, v91
    v_cvt_pk_bf16_f32 v82, v92, v93
    v_cvt_pk_bf16_f32 v83, v94, v95
    s_add_u32 s57, s56, 8192
    buffer_store_dwordx4 v[80:83], v252, s[20:23], s57 offen offset:0 sc1
    v_pk_mul_f32 v[200:201], v[96:97], v[96:97]
    v_pk_mul_f32 v[202:203], v[98:99], v[98:99]
    v_pk_mul_f32 v[204:205], v[100:101], v[100:101]
    v_pk_mul_f32 v[206:207], v[102:103], v[102:103]
    v_pk_fma_f32 v[200:201], v[200:201], s[84:85], v[250:251]
    v_pk_fma_f32 v[202:203], v[202:203], s[84:85], v[250:251]
    v_pk_fma_f32 v[204:205], v[204:205], s[84:85], v[250:251]
    v_pk_fma_f32 v[206:207], v[206:207], s[84:85], v[250:251]
    v_pk_mul_f32 v[200:201], v[200:201], v[96:97]
    v_pk_mul_f32 v[202:203], v[202:203], v[98:99]
    v_pk_mul_f32 v[204:205], v[204:205], v[100:101]
    v_pk_mul_f32 v[206:207], v[206:207], v[102:103]
    v_exp_f32 v200, v200
    v_exp_f32 v201, v201
    v_exp_f32 v202, v202
    v_exp_f32 v203, v203
    v_exp_f32 v204, v204
    v_exp_f32 v205, v205
    v_exp_f32 v206, v206
    v_exp_f32 v207, v207
    v_pk_mul_f32 v[104:105], v[104:105], v[96:97]
    v_pk_mul_f32 v[106:107], v[106:107], v[98:99]
    v_pk_mul_f32 v[108:109], v[108:109], v[100:101]
    v_pk_mul_f32 v[110:111], v[110:111], v[102:103]
    v_pk_add_f32 v[200:201], v[200:201], 1.0 op_sel_hi:[1,0]
    v_pk_add_f32 v[202:203], v[202:203], 1.0 op_sel_hi:[1,0]
    v_pk_add_f32 v[204:205], v[204:205], 1.0 op_sel_hi:[1,0]
    v_pk_add_f32 v[206:207], v[206:207], 1.0 op_sel_hi:[1,0]
    v_rcp_f32 v200, v200
    v_rcp_f32 v201, v201
    v_rcp_f32 v202, v202
    v_rcp_f32 v203, v203
    v_rcp_f32 v204, v204
    v_rcp_f32 v205, v205
    v_rcp_f32 v206, v206
    v_rcp_f32 v207, v207
    v_pk_mul_f32 v[104:105], v[104:105], v[200:201]
    v_pk_mul_f32 v[106:107], v[106:107], v[202:203]
    v_pk_mul_f32 v[108:109], v[108:109], v[204:205]
    v_pk_mul_f32 v[110:111], v[110:111], v[206:207]
    v_cvt_pk_bf16_f32 v96, v104, v105
    v_cvt_pk_bf16_f32 v97, v106, v107
    v_cvt_pk_bf16_f32 v98, v108, v109
    v_cvt_pk_bf16_f32 v99, v110, v111
    buffer_store_dwordx4 v[96:99], v252, s[20:23], s57 offen offset:2048 sc1
    v_pk_mul_f32 v[200:201], v[112:113], v[112:113]
    v_pk_mul_f32 v[202:203], v[114:115], v[114:115]
    v_pk_mul_f32 v[204:205], v[116:117], v[116:117]
    v_pk_mul_f32 v[206:207], v[118:119], v[118:119]
    v_pk_fma_f32 v[200:201], v[200:201], s[84:85], v[250:251]
    v_pk_fma_f32 v[202:203], v[202:203], s[84:85], v[250:251]
    v_pk_fma_f32 v[204:205], v[204:205], s[84:85], v[250:251]
    v_pk_fma_f32 v[206:207], v[206:207], s[84:85], v[250:251]
    v_pk_mul_f32 v[200:201], v[200:201], v[112:113]
    v_pk_mul_f32 v[202:203], v[202:203], v[114:115]
    v_pk_mul_f32 v[204:205], v[204:205], v[116:117]
    v_pk_mul_f32 v[206:207], v[206:207], v[118:119]
    v_exp_f32 v200, v200
    v_exp_f32 v201, v201
    v_exp_f32 v202, v202
    v_exp_f32 v203, v203
    v_exp_f32 v204, v204
    v_exp_f32 v205, v205
    v_exp_f32 v206, v206
    v_exp_f32 v207, v207
    v_pk_mul_f32 v[120:121], v[120:121], v[112:113]
    v_pk_mul_f32 v[122:123], v[122:123], v[114:115]
    v_pk_mul_f32 v[124:125], v[124:125], v[116:117]
    v_pk_mul_f32 v[126:127], v[126:127], v[118:119]
    buffer_load_dwordx4 v233, s[24:27], s77 offen offset:1024  lds
    v_pk_add_f32 v[200:201], v[200:201], 1.0 op_sel_hi:[1,0]
    v_pk_add_f32 v[202:203], v[202:203], 1.0 op_sel_hi:[1,0]
    v_pk_add_f32 v[204:205], v[204:205], 1.0 op_sel_hi:[1,0]
    v_pk_add_f32 v[206:207], v[206:207], 1.0 op_sel_hi:[1,0]
    v_rcp_f32 v200, v200
    v_rcp_f32 v201, v201
    v_rcp_f32 v202, v202
    v_rcp_f32 v203, v203
    v_rcp_f32 v204, v204
    v_rcp_f32 v205, v205
    v_rcp_f32 v206, v206
    v_rcp_f32 v207, v207
    v_pk_mul_f32 v[120:121], v[120:121], v[200:201]
    v_pk_mul_f32 v[122:123], v[122:123], v[202:203]
    v_pk_mul_f32 v[124:125], v[124:125], v[204:205]
    v_pk_mul_f32 v[126:127], v[126:127], v[206:207]
    v_cvt_pk_bf16_f32 v112, v120, v121
    v_cvt_pk_bf16_f32 v113, v122, v123
    v_cvt_pk_bf16_f32 v114, v124, v125
    v_cvt_pk_bf16_f32 v115, v126, v127
    s_add_u32 s57, s56, 12288
    buffer_store_dwordx4 v[112:115], v252, s[20:23], s57 offen offset:0 sc1
    v_pk_mul_f32 v[200:201], v[128:129], v[128:129]
    v_pk_mul_f32 v[202:203], v[130:131], v[130:131]
    v_pk_mul_f32 v[204:205], v[132:133], v[132:133]
    v_pk_mul_f32 v[206:207], v[134:135], v[134:135]
    v_pk_fma_f32 v[200:201], v[200:201], s[84:85], v[250:251]
    v_pk_fma_f32 v[202:203], v[202:203], s[84:85], v[250:251]
    v_pk_fma_f32 v[204:205], v[204:205], s[84:85], v[250:251]
    v_pk_fma_f32 v[206:207], v[206:207], s[84:85], v[250:251]
    v_pk_mul_f32 v[200:201], v[200:201], v[128:129]
    v_pk_mul_f32 v[202:203], v[202:203], v[130:131]
    v_pk_mul_f32 v[204:205], v[204:205], v[132:133]
    v_pk_mul_f32 v[206:207], v[206:207], v[134:135]
    v_exp_f32 v200, v200
    v_exp_f32 v201, v201
    v_exp_f32 v202, v202
    v_exp_f32 v203, v203
    v_exp_f32 v204, v204
    v_exp_f32 v205, v205
    v_exp_f32 v206, v206
    v_exp_f32 v207, v207
    v_pk_mul_f32 v[136:137], v[136:137], v[128:129]
    v_pk_mul_f32 v[138:139], v[138:139], v[130:131]
    v_pk_mul_f32 v[140:141], v[140:141], v[132:133]
    v_pk_mul_f32 v[142:143], v[142:143], v[134:135]
    v_pk_add_f32 v[200:201], v[200:201], 1.0 op_sel_hi:[1,0]
    v_pk_add_f32 v[202:203], v[202:203], 1.0 op_sel_hi:[1,0]
    v_pk_add_f32 v[204:205], v[204:205], 1.0 op_sel_hi:[1,0]
    v_pk_add_f32 v[206:207], v[206:207], 1.0 op_sel_hi:[1,0]
    v_rcp_f32 v200, v200
    v_rcp_f32 v201, v201
    v_rcp_f32 v202, v202
    v_rcp_f32 v203, v203
    v_rcp_f32 v204, v204
    v_rcp_f32 v205, v205
    v_rcp_f32 v206, v206
    v_rcp_f32 v207, v207
    v_pk_mul_f32 v[136:137], v[136:137], v[200:201]
    v_pk_mul_f32 v[138:139], v[138:139], v[202:203]
    v_pk_mul_f32 v[140:141], v[140:141], v[204:205]
    v_pk_mul_f32 v[142:143], v[142:143], v[206:207]
    v_cvt_pk_bf16_f32 v128, v136, v137
    v_cvt_pk_bf16_f32 v129, v138, v139
    v_cvt_pk_bf16_f32 v130, v140, v141
    v_cvt_pk_bf16_f32 v131, v142, v143
    buffer_store_dwordx4 v[128:131], v252, s[20:23], s57 offen offset:2048 sc1
    v_pk_mul_f32 v[200:201], v[144:145], v[144:145]
    v_pk_mul_f32 v[202:203], v[146:147], v[146:147]
    v_pk_mul_f32 v[204:205], v[148:149], v[148:149]
    v_pk_mul_f32 v[206:207], v[150:151], v[150:151]
    v_pk_fma_f32 v[200:201], v[200:201], s[84:85], v[250:251]
    v_pk_fma_f32 v[202:203], v[202:203], s[84:85], v[250:251]
    v_pk_fma_f32 v[204:205], v[204:205], s[84:85], v[250:251]
    v_pk_fma_f32 v[206:207], v[206:207], s[84:85], v[250:251]
    v_pk_mul_f32 v[200:201], v[200:201], v[144:145]
    v_pk_mul_f32 v[202:203], v[202:203], v[146:147]
    v_pk_mul_f32 v[204:205], v[204:205], v[148:149]
    v_pk_mul_f32 v[206:207], v[206:207], v[150:151]
    v_exp_f32 v200, v200
    v_exp_f32 v201, v201
    v_exp_f32 v202, v202
    v_exp_f32 v203, v203
    v_exp_f32 v204, v204
    v_exp_f32 v205, v205
    v_exp_f32 v206, v206
    v_exp_f32 v207, v207
    v_pk_mul_f32 v[152:153], v[152:153], v[144:145]
    v_pk_mul_f32 v[154:155], v[154:155], v[146:147]
    v_pk_mul_f32 v[156:157], v[156:157], v[148:149]
    v_pk_mul_f32 v[158:159], v[158:159], v[150:151]
    v_pk_add_f32 v[200:201], v[200:201], 1.0 op_sel_hi:[1,0]
    v_pk_add_f32 v[202:203], v[202:203], 1.0 op_sel_hi:[1,0]
    v_pk_add_f32 v[204:205], v[204:205], 1.0 op_sel_hi:[1,0]
    v_pk_add_f32 v[206:207], v[206:207], 1.0 op_sel_hi:[1,0]
    v_rcp_f32 v200, v200
    v_rcp_f32 v201, v201
    v_rcp_f32 v202, v202
    v_rcp_f32 v203, v203
    s_add_u32 m0, s61, 4096
    s_add_u32 s46, s77, 14336
    buffer_load_dwordx4 v15, s[24:27], s46 offen  lds
    v_rcp_f32 v204, v204
    v_rcp_f32 v205, v205
    v_rcp_f32 v206, v206
    v_rcp_f32 v207, v207
    v_pk_mul_f32 v[152:153], v[152:153], v[200:201]
    v_pk_mul_f32 v[154:155], v[154:155], v[202:203]
    v_pk_mul_f32 v[156:157], v[156:157], v[204:205]
    v_pk_mul_f32 v[158:159], v[158:159], v[206:207]
    v_cvt_pk_bf16_f32 v144, v152, v153
    v_cvt_pk_bf16_f32 v145, v154, v155
    v_cvt_pk_bf16_f32 v146, v156, v157
    v_cvt_pk_bf16_f32 v147, v158, v159
    s_add_u32 s57, s56, 16384
    buffer_store_dwordx4 v[144:147], v252, s[20:23], s57 offen offset:0 sc1
    v_pk_mul_f32 v[200:201], v[160:161], v[160:161]
    v_pk_mul_f32 v[202:203], v[162:163], v[162:163]
    v_pk_mul_f32 v[204:205], v[164:165], v[164:165]
    v_pk_mul_f32 v[206:207], v[166:167], v[166:167]
    v_pk_fma_f32 v[200:201], v[200:201], s[84:85], v[250:251]
    v_pk_fma_f32 v[202:203], v[202:203], s[84:85], v[250:251]
    v_pk_fma_f32 v[204:205], v[204:205], s[84:85], v[250:251]
    v_pk_fma_f32 v[206:207], v[206:207], s[84:85], v[250:251]
    v_pk_mul_f32 v[200:201], v[200:201], v[160:161]
    v_pk_mul_f32 v[202:203], v[202:203], v[162:163]
    v_pk_mul_f32 v[204:205], v[204:205], v[164:165]
    v_pk_mul_f32 v[206:207], v[206:207], v[166:167]
    v_exp_f32 v200, v200
    v_exp_f32 v201, v201
    v_exp_f32 v202, v202
    v_exp_f32 v203, v203
    v_exp_f32 v204, v204
    v_exp_f32 v205, v205
    v_exp_f32 v206, v206
    v_exp_f32 v207, v207
    v_pk_mul_f32 v[168:169], v[168:169], v[160:161]
    v_pk_mul_f32 v[170:171], v[170:171], v[162:163]
    v_pk_mul_f32 v[172:173], v[172:173], v[164:165]
    v_pk_mul_f32 v[174:175], v[174:175], v[166:167]
    v_pk_add_f32 v[200:201], v[200:201], 1.0 op_sel_hi:[1,0]
    v_pk_add_f32 v[202:203], v[202:203], 1.0 op_sel_hi:[1,0]
    v_pk_add_f32 v[204:205], v[204:205], 1.0 op_sel_hi:[1,0]
    v_pk_add_f32 v[206:207], v[206:207], 1.0 op_sel_hi:[1,0]
    v_rcp_f32 v200, v200
    v_rcp_f32 v201, v201
    v_rcp_f32 v202, v202
    v_rcp_f32 v203, v203
    v_rcp_f32 v204, v204
    v_rcp_f32 v205, v205
    v_rcp_f32 v206, v206
    v_rcp_f32 v207, v207
    v_pk_mul_f32 v[168:169], v[168:169], v[200:201]
    v_pk_mul_f32 v[170:171], v[170:171], v[202:203]
    v_pk_mul_f32 v[172:173], v[172:173], v[204:205]
    v_pk_mul_f32 v[174:175], v[174:175], v[206:207]
    v_cvt_pk_bf16_f32 v160, v168, v169
    v_cvt_pk_bf16_f32 v161, v170, v171
    v_cvt_pk_bf16_f32 v162, v172, v173
    v_cvt_pk_bf16_f32 v163, v174, v175
    buffer_store_dwordx4 v[160:163], v252, s[20:23], s57 offen offset:2048 sc1
    v_mov_b32 v14, s69
    v_writelane_b32 v14, s70, 1
    v_writelane_b32 v14, s71, 2
    v_writelane_b32 v14, s72, 3
    v_xor_b32 v249, 0x400, v254
    buffer_load_dwordx4 v233, s[24:27], s46 offen offset:1024  lds
    s_add_u32 m0, s61, 6144
    s_add_u32 s46, s77, 28672
    buffer_load_dwordx4 v15, s[24:27], s46 offen  lds
    buffer_load_dwordx4 v233, s[24:27], s46 offen offset:1024  lds
    ds_read_b64_tr_b16 a[208:209], v244 offset:12288
    ds_read_b64_tr_b16 a[210:211], v244 offset:13312
    ds_read_b64_tr_b16 a[212:213], v245 offset:12288
    ds_read_b64_tr_b16 a[214:215], v245 offset:13312
    s_add_u32 m0, s61, 8192
    s_add_u32 s46, s77, 43008
    buffer_load_dwordx4 v15, s[24:27], s46 offen  lds
    buffer_load_dwordx4 v233, s[24:27], s46 offen offset:1024  lds
    ds_read_b64_tr_b16 a[216:217], v244 offset:14336
    ds_read_b64_tr_b16 a[218:219], v244 offset:15360
    ds_read_b64_tr_b16 a[220:221], v245 offset:14336
    ds_read_b64_tr_b16 a[222:223], v245 offset:15360
    s_add_u32 m0, s61, 10240
    s_add_u32 s46, s77, 57344
    buffer_load_dwordx4 v15, s[24:27], s46 offen  lds
    buffer_load_dwordx4 v233, s[24:27], s46 offen offset:1024  lds
    ds_read_b64_tr_b16 a[224:225], v244 offset:0
    ds_read_b64_tr_b16 a[226:227], v244 offset:1024
    ds_read_b64_tr_b16 a[228:229], v245 offset:0
    ds_read_b64_tr_b16 a[230:231], v245 offset:1024
    s_waitcnt vmcnt(7)
    s_barrier
    s_cmp_lg_u32 s3, 0
    s_cbranch_scc1 L_noflag_F
    s_lshl_b32 s57, s40, 2
    s_add_u32 s57, s57, s42
    s_lshl_b32 s58, s57, 5
    s_add_u32 s58, s58, s41
    s_lshl_b32 s58, s58, 2
    s_add_u32 s58, s58, 9437184
    s_add_u32 s59, s73, 1
    s_mov_b64 exec, 1
    v_mov_b32 v5, s59
    v_mov_b32 v6, 0
    buffer_store_dword v5, v6, s[20:23], s58 offen sc1
    s_lshl_b32 s57, s57, 2
    s_lshl_b32 s58, 1, s41
    v_mov_b32 v7, s58
    buffer_atomic_or v7, v6, s[36:39], s57 offen sc1
    s_mov_b64 exec, -1
L_noflag_F:
    s_add_u32 m0, s61, 12288
    s_nop 0
    buffer_load_dwordx4 v15, s[24:27], s64 offen  lds
    buffer_load_dwordx4 v233, s[24:27], s64 offen offset:1024  lds
    ds_read_b64_tr_b16 a[232:233], v244 offset:2048
    ds_read_b64_tr_b16 a[234:235], v244 offset:3072
    ds_read_b64_tr_b16 a[236:237], v245 offset:2048
    ds_read_b64_tr_b16 a[238:239], v245 offset:3072
    s_add_u32 m0, s61, 14336
    s_add_u32 s46, s64, 14336
    buffer_load_dwordx4 v15, s[24:27], s46 offen  lds
    buffer_load_dwordx4 v233, s[24:27], s46 offen offset:1024  lds
    ds_read_b64_tr_b16 a[240:241], v244 offset:4096
    ds_read_b64_tr_b16 a[242:243], v244 offset:5120
    ds_read_b64_tr_b16 a[244:245], v245 offset:4096
    ds_read_b64_tr_b16 a[246:247], v245 offset:5120
    s_add_u32 m0, s61, 16384
    s_add_u32 s46, s64, 28672
    buffer_load_dwordx4 v15, s[24:27], s46 offen  lds
    buffer_load_dwordx4 v233, s[24:27], s46 offen offset:1024  lds
    ds_read_b64_tr_b16 a[248:249], v244 offset:6144
    ds_read_b64_tr_b16 a[250:251], v244 offset:7168
    ds_read_b64_tr_b16 a[252:253], v245 offset:6144
    ds_read_b64_tr_b16 a[254:255], v245 offset:7168
    s_add_u32 m0, s61, 18432
    s_add_u32 s46, s64, 43008
    buffer_load_dwordx4 v15, s[24:27], s46 offen  lds
    buffer_load_dwordx4 v233, s[24:27], s46 offen offset:1024  lds
    ds_read_b64_tr_b16 a[0:1], v244 offset:8192
    ds_read_b64_tr_b16 a[2:3], v244 offset:9216
    ds_read_b64_tr_b16 a[4:5], v245 offset:8192
    ds_read_b64_tr_b16 a[6:7], v245 offset:9216
    s_waitcnt lgkmcnt(15)
    s_add_u32 m0, s60, 12288
    s_nop 0
    buffer_load_dwordx4 v15, s[28:31], s66 offen  lds
    buffer_load_dwordx4 v233, s[28:31], s66 offen offset:1024  lds
    ds_read_b64_tr_b16 a[8:9], v244 offset:10240
    ds_read_b64_tr_b16 a[10:11], v244 offset:11264
    ds_read_b64_tr_b16 a[12:13], v245 offset:10240
    ds_read_b64_tr_b16 a[14:15], v245 offset:11264
    s_add_u32 m0, s60, 14336
    s_add_u32 s46, s66, 14336
    buffer_load_dwordx4 v15, s[28:31], s46 offen  lds
    buffer_load_dwordx4 v233, s[28:31], s46 offen offset:1024  lds
    ds_read_b64_tr_b16 a[16:17], v246 offset:0
    ds_read_b64_tr_b16 a[18:19], v246 offset:1024
    ds_read_b64_tr_b16 a[20:21], v247 offset:0
    ds_read_b64_tr_b16 a[22:23], v247 offset:1024
    s_add_u32 m0, s60, 0
    s_add_u32 s46, s66, 25088
    buffer_load_dwordx4 v15, s[28:31], s46 offen  lds
    buffer_load_dwordx4 v233, s[28:31], s46 offen offset:1024  lds
    ds_read_b64_tr_b16 a[24:25], v246 offset:2048
    ds_read_b64_tr_b16 a[26:27], v246 offset:3072
    ds_read_b64_tr_b16 a[28:29], v247 offset:2048
    ds_read_b64_tr_b16 a[30:31], v247 offset:3072
    s_waitcnt lgkmcnt(15)
    s_add_u32 m0, s60, 2048
    s_add_u32 s46, s66, 39424
    buffer_load_dwordx4 v15, s[28:31], s46 offen  lds
    buffer_load_dwordx4 v233, s[28:31], s46 offen offset:1024  lds
    s_waitcnt vmcnt(22)
    ds_read_b64_tr_b16 a[32:33], v246 offset:4096
    ds_read_b64_tr_b16 a[34:35], v246 offset:5120
    ds_read_b64_tr_b16 a[36:37], v247 offset:4096
    ds_read_b64_tr_b16 a[38:39], v247 offset:5120
    s_add_u32 m0, s60, 4096
    s_nop 0
    buffer_load_dwordx4 v15, s[24:27], s65 offen  lds
    buffer_load_dwordx4 v233, s[24:27], s65 offen offset:1024  lds
    s_waitcnt vmcnt(22)
    ds_read_b64_tr_b16 a[40:41], v246 offset:6144
    ds_read_b64_tr_b16 a[42:43], v246 offset:7168
    ds_read_b64_tr_b16 a[44:45], v247 offset:6144
    ds_read_b64_tr_b16 a[46:47], v247 offset:7168
    s_mov_b32 s50, s49
    buffer_load_dword v13, v253, s[20:23], s50 offen sc1
    s_add_u32 m0, s60, 6144
    s_add_u32 s46, s65, 14336
    buffer_load_dwordx4 v15, s[24:27], s46 offen  lds
    buffer_load_dwordx4 v233, s[24:27], s46 offen offset:1024  lds
    s_waitcnt lgkmcnt(15)
    s_add_u32 m0, s60, 8192
    s_add_u32 s46, s65, 28672
    buffer_load_dwordx4 v15, s[24:27], s46 offen  lds
    buffer_load_dwordx4 v233, s[24:27], s46 offen offset:1024  lds
    s_add_u32 m0, s60, 10240
    s_add_u32 s46, s65, 43008
    buffer_load_dwordx4 v15, s[24:27], s46 offen  lds
    buffer_load_dwordx4 v233, s[24:27], s46 offen offset:1024  lds
    s_waitcnt vmcnt(6)
    s_mov_b32 s91, 0
    v_cmp_ne_u32 vcc, v13, v14
    s_and_b32 s57, vcc_lo, 3
    s_cmp_eq_u32 s57, 3
    s_cbranch_scc1 L_pollFF_ok
L_pollFF:
    s_sleep 1
    buffer_load_dword v13, v253, s[20:23], s50 offen sc1
    s_add_u32 s91, s91, 1
    s_waitcnt vmcnt(0)
    v_cmp_ne_u32 vcc, v13, v14
    s_and_b32 s57, vcc_lo, 3
    s_cmp_eq_u32 s57, 3
    s_cbranch_scc1 L_pollFF_ok
    s_and_b32 s57, s91, 63
    s_cmp_lg_u32 s57, 0
    s_cbranch_scc1 L_pollFF
    v_lshrrev_b32 v13, 7, v253
    v_lshlrev_b32 v13, 2, v13
    buffer_load_dword v13, v13, s[36:39], 0 offen sc1
    s_waitcnt vmcnt(0)
    v_readfirstlane_b32 vcc_lo, v13
    s_and_b32 s57, vcc_lo, 3
    s_cmp_eq_u32 s57, 3
    s_cbranch_scc1 L_pollFF_ok
    s_cmp_lt_u32 s91, 0x40000
    s_cbranch_scc1 L_pollFF
L_pollFF_ok:
    s_and_b32 s90, vcc_lo, 15
    s_cmp_eq_u32 s90, 15
    s_cselect_b32 s51, 0x40000000, s49
    buffer_load_dwordx4 a[56:59], v254, s[20:23], s78 offen offset:0 sc1
    buffer_load_dwordx4 a[60:63], v249, s[20:23], s78 offen offset:0 sc1
    buffer_load_dwordx4 a[64:67], v254, s[20:23], s78 offen offset:2048 sc1
    buffer_load_dwordx4 a[68:71], v249, s[20:23], s78 offen offset:2048 sc1
    s_add_u32 s68, s78, 4096
    buffer_load_dwordx4 a[72:75], v254, s[20:23], s68 offen offset:0 sc1
    buffer_load_dwordx4 a[76:79], v249, s[20:23], s68 offen offset:0 sc1
    buffer_load_dwordx4 a[80:83], v254, s[20:23], s68 offen offset:2048 sc1
    buffer_load_dwordx4 a[84:87], v249, s[20:23], s68 offen offset:2048 sc1
    v_mov_b32 v1, v233
    s_branch L_join
L_typeB:
    v_and_b32 v1, 31, v0
    v_lshrrev_b32 v2, 5, v0
    v_bfe_u32 v3, v0, 1, 3
    v_xor_b32 v2, v2, v3
    v_lshlrev_b32 v1, 7, v1
    v_lshl_add_u32 v1, v2, 4, v1
    s_lshl_b32 s57, s100, 6
    v_xor_b32 v1, s57, v1
    v_add_u32 v236, s60, v1
    v_xor_b32 v237, 32, v236
    v_xor_b32 v238, 64, v236
    v_xor_b32 v239, 96, v236
    v_mov_b32 v200, 0
    v_mov_b32 v201, 0
    v_mov_b32 v202, 0
    v_mov_b32 v203, 0
    s_sub_u32 s8, s66, 4096
    s_subb_u32 s9, s67, 0
    s_mov_b32 s10, 1208320
    s_mov_b32 s11, 0x20000
    s_sub_u32 s12, s72, 4096
    s_subb_u32 s13, s73, 0
    s_mov_b32 s14, 1609728
    s_mov_b32 s15, 0x20000
    s_sub_u32 s16, s74, 4096
    s_subb_u32 s17, s75, 0
    s_mov_b32 s18, 1609728
    s_mov_b32 s19, 0x20000
    s_mul_i32 s96, s100, 28672
    s_mul_i32 s52, s46, 57344
    s_add_u32 s52, s52, s96
    s_lshl_b32 s99, s96, 1
    s_sub_u32 s98, 28672, s99
    s_add_u32 s99, s99, 28672
    s_mul_i32 s50, s52, 3
    s_lshl_b32 s51, s52, 2
    s_lshl_b32 s57, s3, 3
    v_lshrrev_b32 v1, 3, v0
    v_add_u32 v1, s57, v1
    v_and_b32 v2, 7, v0
    v_lshrrev_b32 v3, 2, v0
    v_and_b32 v3, 4, v3
    v_xor_b32 v2, v2, v3
    s_lshl_b32 s57, s42, 1
    s_add_u32 s57, s57, s41
    s_mul_i32 s57, s57, 112
    s_add_u32 s57, s57, 3872
    v_mul_u32_u24 v3, 2688, v1
    v_lshl_add_u32 v3, v2, 4, v3
    v_add_u32 v3, s57, v3
    v_cmp_eq_u32 vcc, 7, v2
    v_mov_b32 v4, 0x80000000
    s_nop 0
    v_cndmask_b32 v8, v3, v4, vcc
    v_subrev_u32 v9, 128, v8
    v_subrev_u32 v10, 256, v8
    s_mul_i32 s57, s42, 896
    s_lshl_b32 s58, s41, 7
    s_add_u32 s57, s57, s58
    s_add_u32 s57, s57, 3840
    v_mul_u32_u24 v3, 3584, v1
    v_lshl_add_u32 v3, v2, 4, v3
    v_add_u32 v12, s57, v3
    v_subrev_u32 v11, 3072, v12
    s_mul_i32 s55, s3, 5152
    s_mul_i32 s61, s3, 20608
    s_and_b32 s88, s44, 3
    s_lshl_b32 s57, s43, 2
    s_add_u32 s88, s88, s57
    s_lshr_b32 s89, s44, 2
    s_mul_i32 s62, s3, 401408
    s_mul_i32 s63, s3, 100352
    s_mov_b32 s20, s82
    s_mov_b32 s21, s83
    s_mov_b32 s22, 9445376
    s_mov_b32 s23, 0x20000
    s_mov_b32 s24, s76
    s_mov_b32 s25, s77
    s_mov_b32 s26, 1605632
    s_mov_b32 s27, 0x20000
    s_mov_b32 s28, s68
    s_mov_b32 s29, s69
    s_mov_b32 s30, 401408
    s_mov_b32 s31, 0x20000
    s_mov_b32 s32, s78
    s_mov_b32 s33, s79
    s_mov_b32 s34, 1835008
    s_mov_b32 s35, 0x20000
    s_mov_b32 s36, s80
    s_mov_b32 s37, s81
    s_mov_b32 s38, 256
    s_mov_b32 s39, 0x20000
    s_mul_i32 s97, s88, 144
    s_mul_i32 s57, s3, 36
    s_add_u32 s97, s97, s57
    s_lshl_b32 s97, s97, 11
    s_add_u32 s57, s88, s89
    s_mov_b32 s57, 0
    s_and_b32 s58, s57, 3
    s_mul_i32 s59, s58, 71680
    s_add_u32 s59, s59, s62
    s_add_u32 s74, s59, 114688
    s_mul_i32 s59, s58, 10240
    s_add_u32 s78, s59, s97
    s_add_u32 s57, s57, 1
    s_and_b32 s58, s57, 3
    s_mul_i32 s59, s58, 71680
    s_add_u32 s59, s59, s62
    s_add_u32 s75, s59, 114688
    s_mul_i32 s59, s58, 10240
    s_add_u32 s79, s59, s97
    s_add_u32 s57, s57, 1
    s_and_b32 s58, s57, 3
    s_mul_i32 s59, s58, 71680
    s_add_u32 s59, s59, s62
    s_add_u32 s76, s59, 114688
    s_mul_i32 s59, s58, 10240
    s_add_u32 s80, s59, s97
    s_add_u32 s57, s57, 1
    s_and_b32 s58, s57, 3
    s_mul_i32 s59, s58, 71680
    s_add_u32 s59, s59, s62
    s_add_u32 s77, s59, 114688
    s_mul_i32 s59, s58, 10240
    s_add_u32 s81, s59, s97
    s_add_u32 s57, s57, 1
    s_lshr_b32 s57, s89, 1
    s_add_u32 s57, s57, s88
    s_mov_b32 s57, 0
    s_and_b32 s58, s57, 1
    s_mul_i32 s59, s58, 57344
    s_add_u32 s64, s59, s62
    s_mul_i32 s59, s58, 50176
    s_add_u32 s66, s59, s63
    s_lshl_b32 s59, s58, 14
    s_add_u32 s59, s59, s97
    s_add_u32 s82, s59, 40960
    s_add_u32 s57, s57, 1
    s_and_b32 s58, s57, 1
    s_mul_i32 s59, s58, 57344
    s_add_u32 s65, s59, s62
    s_mul_i32 s59, s58, 50176
    s_add_u32 s67, s59, s63
    s_lshl_b32 s59, s58, 14
    s_add_u32 s59, s59, s97
    s_add_u32 s83, s59, 40960
    s_add_u32 s57, s57, 1
    v_lshrrev_b32 v240, 3, v0
    v_mul_u32_u24 v240, 896, v240
    v_and_b32 v241, 7, v0
    v_lshrrev_b32 v242, 2, v0
    v_and_b32 v242, 4, v242
    v_xor_b32 v241, v241, v242
    v_lshl_add_u32 v15, v241, 4, v240
    s_lshl_b32 s57, s89, 7
    s_cmp_ge_u32 s44, 28
    s_cselect_b32 s57, 0x80000000, s57
    v_add_u32 v15, s57, v15
    v_add_u32 v233, 6144, v15
    v_lshrrev_b32 v240, 5, v0
    v_bfe_u32 v241, v0, 2, 2
    v_bfe_u32 v242, v0, 4, 1
    v_and_b32 v243, 3, v0
    v_lshlrev_b32 v243, 3, v243
    v_bfe_u32 v244, v0, 3, 1
    v_lshlrev_b32 v244, 6, v244
    v_mul_u32_u24 v240, 5152, v240
    v_lshl_add_u32 v240, v241, 7, v240
    v_lshl_add_u32 v245, v242, 5, v243
    v_xor_b32 v1, v245, v244
    v_add_u32 v1, v1, v240
    v_add_u32 v245, 56, v245
    v_xor_b32 v2, v245, v244
    v_add_u32 v2, v2, v240
    v_mul_u32_u24 v245, 1056, v242
    v_add3_u32 v245, v245, v243, v240
    v_add_u32 v3, v245, v244
    v_xor_b32 v244, 64, v244
    v_add_u32 v4, v245, v244
    s_cmp_ge_u32 s3, 2
    s_cselect_b64 vcc, -1, 0
    v_cndmask_b32 v5, v1, v2, vcc
    s_and_b32 s57, s3, 1
    s_add_u32 s57, s57, 1
    s_lshl_b32 s57, s57, 10
    v_add_u32 v5, s57, v5
    v_and_b32 v240, 15, v0
    v_mul_u32_u24 v240, 912, v240
    v_lshrrev_b32 v241, 5, v0
    v_lshl_add_u32 v240, v241, 4, v240
    s_lshl_b32 s57, s100, 6
    s_add_u32 s57, s57, 147968
    v_add_u32 v7, s57, v240
    s_lshl_b32 s57, s100, 7
    s_sub_u32 s101, 64, s57
    v_add_u32 v228, 41216, v1
    v_add_u32 v229, 41216, v2
    v_add_u32 v230, 41216, v3
    v_add_u32 v231, 41216, v4
    v_add_u32 v232, 41216, v5
    s_add_u32 m0, s60, 8192
    s_nop 0
    buffer_load_dwordx4 v234, s[4:7], s49 offen  lds
    s_add_u32 m0, s60, 9216
    s_add_u32 s58, s49, 14336
    buffer_load_dwordx4 v235, s[4:7], s58 offen  lds
    s_add_u32 m0, s60, 10240
    s_add_u32 s58, s49, 28672
    buffer_load_dwordx4 v234, s[4:7], s58 offen  lds
    s_add_u32 m0, s60, 11264
    s_add_u32 s58, s49, 43008
    buffer_load_dwordx4 v235, s[4:7], s58 offen  lds
    s_add_u32 s45, s45, 128
    s_cmp_eq_u32 s45, 896
    s_cselect_b32 s45, 0, s45
    s_add_u32 s49, s48, s45
    s_add_u32 m0, s60, 12288
    s_nop 0
    buffer_load_dwordx4 v234, s[4:7], s49 offen  lds
    s_add_u32 m0, s60, 13312
    s_add_u32 s58, s49, 14336
    buffer_load_dwordx4 v235, s[4:7], s58 offen  lds
    s_add_u32 m0, s60, 14336
    s_add_u32 s58, s49, 28672
    buffer_load_dwordx4 v234, s[4:7], s58 offen  lds
    s_add_u32 m0, s60, 15360
    s_add_u32 s58, s49, 43008
    buffer_load_dwordx4 v235, s[4:7], s58 offen  lds
    s_add_u32 s45, s45, 128
    s_cmp_eq_u32 s45, 896
    s_cselect_b32 s45, 0, s45
    s_add_u32 s49, s48, s45
    s_waitcnt vmcnt(12)
    ds_read_b128 v[16:19], v236 offset:0
    ds_read_b128 v[20:23], v237 offset:0
    ds_read_b128 v[24:27], v238 offset:0
    ds_read_b128 v[28:31], v239 offset:0
    ds_read_b128 a[0:3], v236 offset:0
    ds_read_b128 a[4:7], v237 offset:0
    ds_read_b128 a[8:11], v238 offset:0
    ds_read_b128 a[12:15], v239 offset:0
    s_waitcnt vmcnt(8)
    ds_read_b128 v[32:35], v236 offset:4096
    ds_read_b128 v[36:39], v237 offset:4096
    ds_read_b128 v[40:43], v238 offset:4096
    ds_read_b128 v[44:47], v239 offset:4096
    ds_read_b128 a[16:19], v236 offset:4096
    ds_read_b128 a[20:23], v237 offset:4096
    ds_read_b128 a[24:27], v238 offset:4096
    ds_read_b128 a[28:31], v239 offset:4096
    s_waitcnt lgkmcnt(8)
    s_add_u32 m0, s60, 0
    s_nop 0
    buffer_load_dwordx4 v234, s[4:7], s49 offen  lds
    s_add_u32 m0, s60, 1024
    s_add_u32 s58, s49, 14336
    buffer_load_dwordx4 v235, s[4:7], s58 offen  lds
    s_add_u32 m0, s60, 2048
    s_add_u32 s58, s49, 28672
    buffer_load_dwordx4 v234, s[4:7], s58 offen  lds
    s_add_u32 m0, s60, 3072
    s_add_u32 s58, s49, 43008
    buffer_load_dwordx4 v235, s[4:7], s58 offen  lds
    s_add_u32 s45, s45, 128
    s_cmp_eq_u32 s45, 896
    s_cselect_b32 s45, 0, s45
    s_add_u32 s49, s48, s45
    v_dot2c_f32_bf16 v200, v16, v16
    v_dot2c_f32_bf16 v202, s54, v16
    v_dot2c_f32_bf16 v201, v17, v17
    v_dot2c_f32_bf16 v203, s54, v17
    v_dot2c_f32_bf16 v200, v18, v18
    v_dot2c_f32_bf16 v202, s54, v18
    v_dot2c_f32_bf16 v201, v19, v19
    v_dot2c_f32_bf16 v203, s54, v19
    v_dot2c_f32_bf16 v200, v20, v20
    v_dot2c_f32_bf16 v202, s54, v20
    v_dot2c_f32_bf16 v201, v21, v21
    v_dot2c_f32_bf16 v203, s54, v21
    v_dot2c_f32_bf16 v200, v22, v22
    v_dot2c_f32_bf16 v202, s54, v22
    v_dot2c_f32_bf16 v201, v23, v23
    v_dot2c_f32_bf16 v203, s54, v23
    v_dot2c_f32_bf16 v200, v24, v24
    v_dot2c_f32_bf16 v202, s54, v24
    v_dot2c_f32_bf16 v201, v25, v25
    v_dot2c_f32_bf16 v203, s54, v25
    v_dot2c_f32_bf16 v200, v26, v26
    v_dot2c_f32_bf16 v202, s54, v26
    v_dot2c_f32_bf16 v201, v27, v27
    v_dot2c_f32_bf16 v203, s54, v27
    v_dot2c_f32_bf16 v200, v28, v28
    v_dot2c_f32_bf16 v202, s54, v28
    v_dot2c_f32_bf16 v201, v29, v29
    v_dot2c_f32_bf16 v203, s54, v29
    v_dot2c_f32_bf16 v200, v30, v30
    v_dot2c_f32_bf16 v202, s54, v30
    v_dot2c_f32_bf16 v201, v31, v31
    v_dot2c_f32_bf16 v203, s54, v31
    s_waitcnt vmcnt(8)
    ds_read_b128 v[16:19], v236 offset:8192
    ds_read_b128 v[20:23], v237 offset:8192
    ds_read_b128 v[24:27], v238 offset:8192
    ds_read_b128 v[28:31], v239 offset:8192
    ds_read_b128 a[32:35], v236 offset:8192
    ds_read_b128 a[36:39], v237 offset:8192
    ds_read_b128 a[40:43], v238 offset:8192
    ds_read_b128 a[44:47], v239 offset:8192
    s_waitcnt lgkmcnt(8)
    s_add_u32 m0, s60, 4096
    s_nop 0
    buffer_load_dwordx4 v234, s[4:7], s49 offen  lds
    s_add_u32 m0, s60, 5120
    s_add_u32 s58, s49, 14336
    buffer_load_dwordx4 v235, s[4:7], s58 offen  lds
    s_add_u32 m0, s60, 6144
    s_add_u32 s58, s49, 28672
    buffer_load_dwordx4 v234, s[4:7], s58 offen  lds
    s_add_u32 m0, s60, 7168
    s_add_u32 s58, s49, 43008
    buffer_load_dwordx4 v235, s[4:7], s58 offen  lds
    s_add_u32 s45, s45, 128
    s_cmp_eq_u32 s45, 896
    s_cselect_b32 s45, 0, s45
    s_add_u32 s49, s48, s45
    v_dot2c_f32_bf16 v200, v32, v32
    v_dot2c_f32_bf16 v202, s54, v32
    v_dot2c_f32_bf16 v201, v33, v33
    v_dot2c_f32_bf16 v203, s54, v33
    v_dot2c_f32_bf16 v200, v34, v34
    v_dot2c_f32_bf16 v202, s54, v34
    v_dot2c_f32_bf16 v201, v35, v35
    v_dot2c_f32_bf16 v203, s54, v35
    v_dot2c_f32_bf16 v200, v36, v36
    v_dot2c_f32_bf16 v202, s54, v36
    v_dot2c_f32_bf16 v201, v37, v37
    v_dot2c_f32_bf16 v203, s54, v37
    v_dot2c_f32_bf16 v200, v38, v38
    v_dot2c_f32_bf16 v202, s54, v38
    v_dot2c_f32_bf16 v201, v39, v39
    v_dot2c_f32_bf16 v203, s54, v39
    v_dot2c_f32_bf16 v200, v40, v40
    v_dot2c_f32_bf16 v202, s54, v40
    v_dot2c_f32_bf16 v201, v41, v41
    v_dot2c_f32_bf16 v203, s54, v41
    v_dot2c_f32_bf16 v200, v42, v42
    v_dot2c_f32_bf16 v202, s54, v42
    v_dot2c_f32_bf16 v201, v43, v43
    v_dot2c_f32_bf16 v203, s54, v43
    v_dot2c_f32_bf16 v200, v44, v44
    v_dot2c_f32_bf16 v202, s54, v44
    v_dot2c_f32_bf16 v201, v45, v45
    v_dot2c_f32_bf16 v203, s54, v45
    v_dot2c_f32_bf16 v200, v46, v46
    v_dot2c_f32_bf16 v202, s54, v46
    v_dot2c_f32_bf16 v201, v47, v47
    v_dot2c_f32_bf16 v203, s54, v47
    s_waitcnt vmcnt(8)
    ds_read_b128 v[32:35], v236 offset:12288
    ds_read_b128 v[36:39], v237 offset:12288
    ds_read_b128 v[40:43], v238 offset:12288
    ds_read_b128 v[44:47], v239 offset:12288
    ds_read_b128 a[48:51], v236 offset:12288
    ds_read_b128 a[52:55], v237 offset:12288
    ds_read_b128 a[56:59], v238 offset:12288
    ds_read_b128 a[60:63], v239 offset:12288
    s_waitcnt lgkmcnt(8)
    s_add_u32 m0, s60, 8192
    s_nop 0
    buffer_load_dwordx4 v234, s[4:7], s49 offen  lds
    s_add_u32 m0, s60, 9216
    s_add_u32 s58, s49, 14336
    buffer_load_dwordx4 v235, s[4:7], s58 offen  lds
    s_add_u32 m0, s60, 10240
    s_add_u32 s58, s49, 28672
    buffer_load_dwordx4 v234, s[4:7], s58 offen  lds
    s_add_u32 m0, s60, 11264
    s_add_u32 s58, s49, 43008
    buffer_load_dwordx4 v235, s[4:7], s58 offen  lds
    s_add_u32 s45, s45, 128
    s_cmp_eq_u32 s45, 896
    s_cselect_b32 s45, 0, s45
    s_add_u32 s49, s48, s45
    v_lshlrev_b32 v240, 4, v0
    s_and_b32 s57, s3, 1
    s_mul_i32 s57, s57, 7168
    s_lshr_b32 s58, s3, 1
    s_mul_i32 s58, s58, 896
    s_sub_u32 s57, s57, s58
    s_add_u32 s57, s57, s48
    s_sub_u32 s57, s57, 13440
    s_cmp_eq_u32 s40, 0
    s_cselect_b32 s57, 0x40000000, s57
    s_mul_i32 s58, s3, 3648
    s_mov_b32 exec_hi, 0x00ffffff
    s_add_u32 m0, s58, 147968
    s_nop 0
    buffer_load_dwordx4 v240, s[4:7], s57 offen lds
    s_add_u32 m0, s58, 148880
    s_add_u32 s57, s57, 1792
    buffer_load_dwordx4 v240, s[4:7], s57 offen lds
    s_add_u32 m0, s58, 149792
    s_add_u32 s57, s57, 1792
    buffer_load_dwordx4 v240, s[4:7], s57 offen lds
    s_add_u32 m0, s58, 150704
    s_add_u32 s57, s57, 1792
    buffer_load_dwordx4 v240, s[4:7], s57 offen lds
    s_mov_b32 exec_hi, -1
    v_dot2c_f32_bf16 v200, v16, v16
    v_dot2c_f32_bf16 v202, s54, v16
    v_dot2c_f32_bf16 v201, v17, v17
    v_dot2c_f32_bf16 v203, s54, v17
    v_dot2c_f32_bf16 v200, v18, v18
    v_dot2c_f32_bf16 v202, s54, v18
    v_dot2c_f32_bf16 v201, v19, v19
    v_dot2c_f32_bf16 v203, s54, v19
    v_dot2c_f32_bf16 v200, v20, v20
    v_dot2c_f32_bf16 v202, s54, v20
    v_dot2c_f32_bf16 v201, v21, v21
    v_dot2c_f32_bf16 v203, s54, v21
    v_dot2c_f32_bf16 v200, v22, v22
    v_dot2c_f32_bf16 v202, s54, v22
    v_dot2c_f32_bf16 v201, v23, v23
    v_dot2c_f32_bf16 v203, s54, v23
    v_dot2c_f32_bf16 v200, v24, v24
    v_dot2c_f32_bf16 v202, s54, v24
    v_dot2c_f32_bf16 v201, v25, v25
    v_dot2c_f32_bf16 v203, s54, v25
    v_dot2c_f32_bf16 v200, v26, v26
    v_dot2c_f32_bf16 v202, s54, v26
    v_dot2c_f32_bf16 v201, v27, v27
    v_dot2c_f32_bf16 v203, s54, v27
    v_dot2c_f32_bf16 v200, v28, v28
    v_dot2c_f32_bf16 v202, s54, v28
    v_dot2c_f32_bf16 v201, v29, v29
    v_dot2c_f32_bf16 v203, s54, v29
    v_dot2c_f32_bf16 v200, v30, v30
    v_dot2c_f32_bf16 v202, s54, v30
    v_dot2c_f32_bf16 v201, v31, v31
    v_dot2c_f32_bf16 v203, s54, v31
    s_waitcnt vmcnt(12)
    ds_read_b128 v[16:19], v236 offset:0
    ds_read_b128 v[20:23], v237 offset:0
    ds_read_b128 v[24:27], v238 offset:0
    ds_read_b128 v[28:31], v239 offset:0
    ds_read_b128 a[64:67], v236 offset:0
    ds_read_b128 a[68:71], v237 offset:0
    ds_read_b128 a[72:75], v238 offset:0
    ds_read_b128 a[76:79], v239 offset:0
    s_waitcnt lgkmcnt(12)
    v_dot2c_f32_bf16 v200, v32, v32
    v_dot2c_f32_bf16 v202, s54, v32
    v_dot2c_f32_bf16 v201, v33, v33
    v_dot2c_f32_bf16 v203, s54, v33
    v_dot2c_f32_bf16 v200, v34, v34
    v_dot2c_f32_bf16 v202, s54, v34
    v_dot2c_f32_bf16 v201, v35, v35
    v_dot2c_f32_bf16 v203, s54, v35
    v_dot2c_f32_bf16 v200, v36, v36
    v_dot2c_f32_bf16 v202, s54, v36
    v_dot2c_f32_bf16 v201, v37, v37
    v_dot2c_f32_bf16 v203, s54, v37
    v_dot2c_f32_bf16 v200, v38, v38
    v_dot2c_f32_bf16 v202, s54, v38
    v_dot2c_f32_bf16 v201, v39, v39
    v_dot2c_f32_bf16 v203, s54, v39
    v_dot2c_f32_bf16 v200, v40, v40
    v_dot2c_f32_bf16 v202, s54, v40
    v_dot2c_f32_bf16 v201, v41, v41
    v_dot2c_f32_bf16 v203, s54, v41
    v_dot2c_f32_bf16 v200, v42, v42
    v_dot2c_f32_bf16 v202, s54, v42
    v_dot2c_f32_bf16 v201, v43, v43
    v_dot2c_f32_bf16 v203, s54, v43
    v_dot2c_f32_bf16 v200, v44, v44
    v_dot2c_f32_bf16 v202, s54, v44
    v_dot2c_f32_bf16 v201, v45, v45
    v_dot2c_f32_bf16 v203, s54, v45
    v_dot2c_f32_bf16 v200, v46, v46
    v_dot2c_f32_bf16 v202, s54, v46
    v_dot2c_f32_bf16 v201, v47, v47
    v_dot2c_f32_bf16 v203, s54, v47
    s_waitcnt vmcnt(8)
    ds_read_b128 v[32:35], v236 offset:4096
    ds_read_b128 v[36:39], v237 offset:4096
    ds_read_b128 v[40:43], v238 offset:4096
    ds_read_b128 v[44:47], v239 offset:4096
    ds_read_b128 a[80:83], v236 offset:4096
    ds_read_b128 a[84:87], v237 offset:4096
    ds_read_b128 a[88:91], v238 offset:4096
    ds_read_b128 a[92:95], v239 offset:4096
    s_add_u32 m0, s55, 0
    s_nop 0
    buffer_load_dwordx4 v8, s[8:11], s50 offen offset:0  lds
    buffer_load_dwordx4 v9, s[8:11], s50 offen offset:1024  lds
    s_waitcnt lgkmcnt(12)
    v_dot2c_f32_bf16 v200, v16, v16
    v_dot2c_f32_bf16 v202, s54, v16
    v_dot2c_f32_bf16 v201, v17, v17
    v_dot2c_f32_bf16 v203, s54, v17
    v_dot2c_f32_bf16 v200, v18, v18
    v_dot2c_f32_bf16 v202, s54, v18
    v_dot2c_f32_bf16 v201, v19, v19
    v_dot2c_f32_bf16 v203, s54, v19
    v_dot2c_f32_bf16 v200, v20, v20
    v_dot2c_f32_bf16 v202, s54, v20
    v_dot2c_f32_bf16 v201, v21, v21
    v_dot2c_f32_bf16 v203, s54, v21
    v_dot2c_f32_bf16 v200, v22, v22
    v_dot2c_f32_bf16 v202, s54, v22
    v_dot2c_f32_bf16 v201, v23, v23
    v_dot2c_f32_bf16 v203, s54, v23
    v_dot2c_f32_bf16 v200, v24, v24
    v_dot2c_f32_bf16 v202, s54, v24
    v_dot2c_f32_bf16 v201, v25, v25
    v_dot2c_f32_bf16 v203, s54, v25
    v_dot2c_f32_bf16 v200, v26, v26
    v_dot2c_f32_bf16 v202, s54, v26
    v_dot2c_f32_bf16 v201, v27, v27
    v_dot2c_f32_bf16 v203, s54, v27
    v_dot2c_f32_bf16 v200, v28, v28
    v_dot2c_f32_bf16 v202, s54, v28
    v_dot2c_f32_bf16 v201, v29, v29
    v_dot2c_f32_bf16 v203, s54, v29
    v_dot2c_f32_bf16 v200, v30, v30
    v_dot2c_f32_bf16 v202, s54, v30
    v_dot2c_f32_bf16 v201, v31, v31
    v_dot2c_f32_bf16 v203, s54, v31
    s_waitcnt vmcnt(6)
    ds_read_b128 v[16:19], v236 offset:8192
    ds_read_b128 v[20:23], v237 offset:8192
    ds_read_b128 v[24:27], v238 offset:8192
    ds_read_b128 v[28:31], v239 offset:8192
    ds_read_b128 a[96:99], v236 offset:8192
    ds_read_b128 a[100:103], v237 offset:8192
    ds_read_b128 a[104:107], v238 offset:8192
    ds_read_b128 a[108:111], v239 offset:8192
    buffer_load_dwordx4 v10, s[8:11], s50 offen offset:2048  lds
    buffer_load_dwordx4 v11, s[12:15], s51 offen offset:3072  lds
    s_add_u32 m0, s55, 4128
    s_nop 0
    buffer_load_dwordx4 v12, s[16:19], s51 offen  lds
    s_waitcnt lgkmcnt(12)
    v_dot2c_f32_bf16 v200, v32, v32
    v_dot2c_f32_bf16 v202, s54, v32
    v_dot2c_f32_bf16 v201, v33, v33
    v_dot2c_f32_bf16 v203, s54, v33
    v_dot2c_f32_bf16 v200, v34, v34
    v_dot2c_f32_bf16 v202, s54, v34
    v_dot2c_f32_bf16 v201, v35, v35
    v_dot2c_f32_bf16 v203, s54, v35
    v_dot2c_f32_bf16 v200, v36, v36
    v_dot2c_f32_bf16 v202, s54, v36
    v_dot2c_f32_bf16 v201, v37, v37
    v_dot2c_f32_bf16 v203, s54, v37
    v_dot2c_f32_bf16 v200, v38, v38
    v_dot2c_f32_bf16 v202, s54, v38
    v_dot2c_f32_bf16 v201, v39, v39
    v_dot2c_f32_bf16 v203, s54, v39
    v_dot2c_f32_bf16 v200, v40, v40
    v_dot2c_f32_bf16 v202, s54, v40
    v_dot2c_f32_bf16 v201, v41, v41
    v_dot2c_f32_bf16 v203, s54, v41
    v_dot2c_f32_bf16 v200, v42, v42
    v_dot2c_f32_bf16 v202, s54, v42
    v_dot2c_f32_bf16 v201, v43, v43
    v_dot2c_f32_bf16 v203, s54, v43
    v_dot2c_f32_bf16 v200, v44, v44
    v_dot2c_f32_bf16 v202, s54, v44
    v_dot2c_f32_bf16 v201, v45, v45
    v_dot2c_f32_bf16 v203, s54, v45
    v_dot2c_f32_bf16 v200, v46, v46
    v_dot2c_f32_bf16 v202, s54, v46
    v_dot2c_f32_bf16 v201, v47, v47
    v_dot2c_f32_bf16 v203, s54, v47
    s_waitcnt lgkmcnt(4)
    v_dot2c_f32_bf16 v200, v16, v16
    v_dot2c_f32_bf16 v202, s54, v16
    v_dot2c_f32_bf16 v201, v17, v17
    v_dot2c_f32_bf16 v203, s54, v17
    v_dot2c_f32_bf16 v200, v18, v18
    v_dot2c_f32_bf16 v202, s54, v18
    v_dot2c_f32_bf16 v201, v19, v19
    v_dot2c_f32_bf16 v203, s54, v19
    v_dot2c_f32_bf16 v200, v20, v20
    v_dot2c_f32_bf16 v202, s54, v20
    v_dot2c_f32_bf16 v201, v21, v21
    v_dot2c_f32_bf16 v203, s54, v21
    v_dot2c_f32_bf16 v200, v22, v22
    v_dot2c_f32_bf16 v202, s54, v22
    v_dot2c_f32_bf16 v201, v23, v23
    v_dot2c_f32_bf16 v203, s54, v23
    v_dot2c_f32_bf16 v200, v24, v24
    v_dot2c_f32_bf16 v202, s54, v24
    v_dot2c_f32_bf16 v201, v25, v25
    v_dot2c_f32_bf16 v203, s54, v25
    v_dot2c_f32_bf16 v200, v26, v26
    v_dot2c_f32_bf16 v202, s54, v26
    v_dot2c_f32_bf16 v201, v27, v27
    v_dot2c_f32_bf16 v203, s54, v27
    v_dot2c_f32_bf16 v200, v28, v28
    v_dot2c_f32_bf16 v202, s54, v28
    v_dot2c_f32_bf16 v201, v29, v29
    v_dot2c_f32_bf16 v203, s54, v29
    v_dot2c_f32_bf16 v200, v30, v30
    v_dot2c_f32_bf16 v202, s54, v30
    v_dot2c_f32_bf16 v201, v31, v31
    v_dot2c_f32_bf16 v203, s54, v31
    s_add_u32 s52, s52, s98
    s_mul_i32 s50, s52, 3
    s_lshl_b32 s51, s52, 2
    v_add_f32 v200, v200, v201
    v_add_f32 v202, v202, v203
    v_mov_b32 v201, v200
    v_mov_b32 v203, v202
    s_nop 0
    v_permlane32_swap_b32 v200, v201
    v_permlane32_swap_b32 v202, v203
    v_add_f32 v200, v200, v201
    v_add_f32 v202, v202, v203
    v_mul_f32 v202, 0x3b124925, v202
    v_mul_f32 v200, 0x3b124925, v200
    v_fma_f32 v200, -v202, v202, v200
    v_max_f32 v200, 0, v200
    v_add_f32 v200, 0x3727c5ac, v200
    v_rsq_f32 v13, v200
    s_nop 0
    v_mul_f32 v201, v202, v13
    v_sub_f32 v14, 0, v201
    v_lshrrev_b32 v64, 4, v0
    s_lshl_b32 s57, s3, 2
    v_add_u32 v64, s57, v64
    v_mul_u32_u24 v64, 912, v64
    v_and_b32 v65, 15, v0
    v_mul_u32_u24 v65, 56, v65
    v_add_u32 v64, v64, v65
    v_add_u32 v64, 147968, v64
    v_mov_b32 v65, 0
    v_mov_b32 v66, 0
    s_waitcnt vmcnt(5)
    ds_read_b64 v[48:49], v64 offset:0
    ds_read_b64 v[50:51], v64 offset:8
    ds_read_b64 v[52:53], v64 offset:16
    ds_read_b64 v[54:55], v64 offset:24
    ds_read_b64 v[56:57], v64 offset:32
    ds_read_b64 v[58:59], v64 offset:40
    ds_read_b64 v[60:61], v64 offset:48
    s_waitcnt lgkmcnt(0)
    v_dot2c_f32_bf16 v65, v48, v48
    v_dot2c_f32_bf16 v66, s54, v48
    v_dot2c_f32_bf16 v65, v49, v49
    v_dot2c_f32_bf16 v66, s54, v49
    v_dot2c_f32_bf16 v65, v50, v50
    v_dot2c_f32_bf16 v66, s54, v50
    v_dot2c_f32_bf16 v65, v51, v51
    v_dot2c_f32_bf16 v66, s54, v51
    v_dot2c_f32_bf16 v65, v52, v52
    v_dot2c_f32_bf16 v66, s54, v52
    v_dot2c_f32_bf16 v65, v53, v53
    v_dot2c_f32_bf16 v66, s54, v53
    v_dot2c_f32_bf16 v65, v54, v54
    v_dot2c_f32_bf16 v66, s54, v54
    v_dot2c_f32_bf16 v65, v55, v55
    v_dot2c_f32_bf16 v66, s54, v55
    v_dot2c_f32_bf16 v65, v56, v56
    v_dot2c_f32_bf16 v66, s54, v56
    v_dot2c_f32_bf16 v65, v57, v57
    v_dot2c_f32_bf16 v66, s54, v57
    v_dot2c_f32_bf16 v65, v58, v58
    v_dot2c_f32_bf16 v66, s54, v58
    v_dot2c_f32_bf16 v65, v59, v59
    v_dot2c_f32_bf16 v66, s54, v59
    v_dot2c_f32_bf16 v65, v60, v60
    v_dot2c_f32_bf16 v66, s54, v60
    v_dot2c_f32_bf16 v65, v61, v61
    v_dot2c_f32_bf16 v66, s54, v61
    s_nop 1
    v_add_f32_dpp v65, v65, v65 row_ror:8 row_mask:0xf bank_mask:0xf
    v_add_f32_dpp v66, v66, v66 row_ror:8 row_mask:0xf bank_mask:0xf
    s_nop 0
    v_add_f32_dpp v65, v65, v65 row_ror:4 row_mask:0xf bank_mask:0xf
    v_add_f32_dpp v66, v66, v66 row_ror:4 row_mask:0xf bank_mask:0xf
    s_nop 0
    v_add_f32_dpp v65, v65, v65 row_ror:2 row_mask:0xf bank_mask:0xf
    v_add_f32_dpp v66, v66, v66 row_ror:2 row_mask:0xf bank_mask:0xf
    s_nop 0
    v_add_f32_dpp v65, v65, v65 row_ror:1 row_mask:0xf bank_mask:0xf
    v_add_f32_dpp v66, v66, v66 row_ror:1 row_mask:0xf bank_mask:0xf
    v_mul_f32 v66, 0x3b124925, v66
    v_mul_f32 v65, 0x3b124925, v65
    v_fma_f32 v65, -v66, v66, v65
    v_max_f32 v65, 0, v65
    v_add_f32 v65, 0x3727c5ac, v65
    v_rsq_f32 v68, v65
    s_nop 0
    v_mul_f32 v67, v66, v68
    v_sub_f32 v70, 0, v67
    v_lshlrev_b32 v72, 16, v48
    v_and_b32 v73, s53, v48
    v_lshlrev_b32 v74, 16, v49
    v_and_b32 v75, s53, v49
    v_pk_fma_f32 v[72:73], v[72:73], v[68:69], v[70:71] op_sel_hi:[1,0,0]
    v_pk_fma_f32 v[74:75], v[74:75], v[68:69], v[70:71] op_sel_hi:[1,0,0]
    v_cvt_pk_bf16_f32 v48, v72, v73
    v_cvt_pk_bf16_f32 v49, v74, v75
    v_lshlrev_b32 v72, 16, v50
    v_and_b32 v73, s53, v50
    v_lshlrev_b32 v74, 16, v51
    v_and_b32 v75, s53, v51
    v_pk_fma_f32 v[72:73], v[72:73], v[68:69], v[70:71] op_sel_hi:[1,0,0]
    v_pk_fma_f32 v[74:75], v[74:75], v[68:69], v[70:71] op_sel_hi:[1,0,0]
    v_cvt_pk_bf16_f32 v50, v72, v73
    v_cvt_pk_bf16_f32 v51, v74, v75
    v_lshlrev_b32 v72, 16, v52
    v_and_b32 v73, s53, v52
    v_lshlrev_b32 v74, 16, v53
    v_and_b32 v75, s53, v53
    v_pk_fma_f32 v[72:73], v[72:73], v[68:69], v[70:71] op_sel_hi:[1,0,0]
    v_pk_fma_f32 v[74:75], v[74:75], v[68:69], v[70:71] op_sel_hi:[1,0,0]
    v_cvt_pk_bf16_f32 v52, v72, v73
    v_cvt_pk_bf16_f32 v53, v74, v75
    v_lshlrev_b32 v72, 16, v54
    v_and_b32 v73, s53, v54
    v_lshlrev_b32 v74, 16, v55
    v_and_b32 v75, s53, v55
    v_pk_fma_f32 v[72:73], v[72:73], v[68:69], v[70:71] op_sel_hi:[1,0,0]
    v_pk_fma_f32 v[74:75], v[74:75], v[68:69], v[70:71] op_sel_hi:[1,0,0]
    v_cvt_pk_bf16_f32 v54, v72, v73
    v_cvt_pk_bf16_f32 v55, v74, v75
    v_lshlrev_b32 v72, 16, v56
    v_and_b32 v73, s53, v56
    v_lshlrev_b32 v74, 16, v57
    v_and_b32 v75, s53, v57
    v_pk_fma_f32 v[72:73], v[72:73], v[68:69], v[70:71] op_sel_hi:[1,0,0]
    v_pk_fma_f32 v[74:75], v[74:75], v[68:69], v[70:71] op_sel_hi:[1,0,0]
    v_cvt_pk_bf16_f32 v56, v72, v73
    v_cvt_pk_bf16_f32 v57, v74, v75
    v_lshlrev_b32 v72, 16, v58
    v_and_b32 v73, s53, v58
    v_lshlrev_b32 v74, 16, v59
    v_and_b32 v75, s53, v59
    v_pk_fma_f32 v[72:73], v[72:73], v[68:69], v[70:71] op_sel_hi:[1,0,0]
    v_pk_fma_f32 v[74:75], v[74:75], v[68:69], v[70:71] op_sel_hi:[1,0,0]
    v_cvt_pk_bf16_f32 v58, v72, v73
    v_cvt_pk_bf16_f32 v59, v74, v75
    v_lshlrev_b32 v72, 16, v60
    v_and_b32 v73, s53, v60
    v_lshlrev_b32 v74, 16, v61
    v_and_b32 v75, s53, v61
    v_pk_fma_f32 v[72:73], v[72:73], v[68:69], v[70:71] op_sel_hi:[1,0,0]
    v_pk_fma_f32 v[74:75], v[74:75], v[68:69], v[70:71] op_sel_hi:[1,0,0]
    v_cvt_pk_bf16_f32 v60, v72, v73
    v_cvt_pk_bf16_f32 v61, v74, v75
    ds_write_b64 v64, v[48:49] offset:0
    ds_write_b64 v64, v[50:51] offset:8
    ds_write_b64 v64, v[52:53] offset:16
    ds_write_b64 v64, v[54:55] offset:24
    ds_write_b64 v64, v[56:57] offset:32
    ds_write_b64 v64, v[58:59] offset:40
    ds_write_b64 v64, v[60:61] offset:48
    v_and_b32 v240, 31, v0
    v_lshrrev_b32 v241, 5, v0
    v_lshlrev_b32 v241, 2, v241
    v_sub_u32 v240, v240, v241
    v_mov_b32 v242, 0xf149f2ca
    v_mov_b32 v243, 0
    v_subrev_u32 v241, 0, v240
    v_subrev_u32 v244, 1, v240
    v_cmp_gt_u32 vcc, 8, v241
    v_cmp_gt_u32 s[90:91], 8, v244
    s_nop 0
    v_cndmask_b32 v208, v242, v243, vcc
    v_cndmask_b32 v209, v242, v243, s[90:91]
    v_subrev_u32 v241, 2, v240
    v_subrev_u32 v244, 3, v240
    v_cmp_gt_u32 vcc, 8, v241
    v_cmp_gt_u32 s[90:91], 8, v244
    s_nop 0
    v_cndmask_b32 v210, v242, v243, vcc
    v_cndmask_b32 v211, v242, v243, s[90:91]
    v_subrev_u32 v241, 8, v240
    v_subrev_u32 v244, 9, v240
    v_cmp_gt_u32 vcc, 8, v241
    v_cmp_gt_u32 s[90:91], 8, v244
    s_nop 0
    v_cndmask_b32 v212, v242, v243, vcc
    v_cndmask_b32 v213, v242, v243, s[90:91]
    v_subrev_u32 v241, 10, v240
    v_subrev_u32 v244, 11, v240
    v_cmp_gt_u32 vcc, 8, v241
    v_cmp_gt_u32 s[90:91], 8, v244
    s_nop 0
    v_cndmask_b32 v214, v242, v243, vcc
    v_cndmask_b32 v215, v242, v243, s[90:91]
    v_subrev_u32 v241, 16, v240
    v_subrev_u32 v244, 17, v240
    v_cmp_gt_u32 vcc, 8, v241
    v_cmp_gt_u32 s[90:91], 8, v244
    s_nop 0
    v_cndmask_b32 v216, v242, v243, vcc
    v_cndmask_b32 v217, v242, v243, s[90:91]
    v_subrev_u32 v241, 18, v240
    v_subrev_u32 v244, 19, v240
    v_cmp_gt_u32 vcc, 8, v241
    v_cmp_gt_u32 s[90:91], 8, v244
    s_nop 0
    v_cndmask_b32 v218, v242, v243, vcc
    v_cndmask_b32 v219, v242, v243, s[90:91]
    v_subrev_u32 v241, 24, v240
    v_subrev_u32 v244, 25, v240
    v_cmp_gt_u32 vcc, 8, v241
    v_cmp_gt_u32 s[90:91], 8, v244
    s_nop 0
    v_cndmask_b32 v220, v242, v243, vcc
    v_cndmask_b32 v221, v242, v243, s[90:91]
    v_subrev_u32 v241, 26, v240
    v_subrev_u32 v244, 27, v240
    v_cmp_gt_u32 vcc, 8, v241
    v_cmp_gt_u32 s[90:91], 8, v244
    s_nop 0
    v_cndmask_b32 v222, v242, v243, vcc
    v_cndmask_b32 v223, v242, v243, s[90:91]
    s_cmp_eq_u32 s40, 0
    s_cselect_b32 s57, 2, 0
    s_cmp_lt_u32 s3, s57
    s_cselect_b32 s57, 100, 1
    v_add_u32 v240, s57, v240
    v_cmp_ge_i32 vcc, 0, v240
    s_nop 1
    v_cndmask_b32 v224, v242, v243, vcc
    v_cmp_ge_i32 vcc, 1, v240
    s_nop 1
    v_cndmask_b32 v225, v242, v243, vcc
    v_cmp_ge_i32 vcc, 2, v240
    s_nop 1
    v_cndmask_b32 v226, v242, v243, vcc
    v_cmp_ge_i32 vcc, 3, v240
    s_nop 1
    v_cndmask_b32 v227, v242, v243, vcc
    s_lshr_b32 s57, s3, 1
    v_lshrrev_b32 v240, 5, v0
    v_bfe_u32 v241, v0, 2, 2
    v_lshl_add_u32 v240, v240, 2, v241
    v_lshlrev_b32 v240, 7, v240
    v_bfe_u32 v241, v0, 4, 1
    v_and_b32 v242, 3, v0
    v_lshlrev_b32 v242, 3, v242
    v_lshl_add_u32 v241, v241, 5, v242
    v_bfe_u32 v242, v0, 3, 1
    v_xor_b32 v242, s57, v242
    v_lshlrev_b32 v242, 6, v242
    v_add3_u32 v240, v240, v241, v242
    v_add_u32 v244, s60, v240
    v_add_u32 v246, s61, v240
    v_xor_b32 v240, 64, v240
    v_add_u32 v245, s60, v240
    v_add_u32 v247, s61, v240
    v_and_b32 v240, 31, v0
    s_and_b32 s57, s3, 1
    s_lshl_b32 s58, s88, 6
    s_add_u32 s57, s57, s58
    v_lshl_add_u32 v240, v240, 1, s57
    v_mul_u32_u24 v240, 896, v240
    v_lshrrev_b32 v241, 5, v0
    v_lshl_add_u32 v240, v241, 3, v240
    s_lshr_b32 s57, s3, 1
    s_lshl_b32 s57, s57, 6
    s_lshl_b32 s58, s89, 7
    s_add_u32 s57, s57, s58
    v_add_u32 v248, s57, v240
    s_and_b32 s59, s3, 1
    s_lshl_b32 s58, s88, 6
    s_add_u32 s59, s59, s58
    v_lshrrev_b32 v240, 2, v0
    v_lshl_add_u32 v240, v240, 1, s59
    v_mul_u32_u24 v240, 896, v240
    v_and_b32 v241, 3, v0
    v_lshl_add_u32 v240, v241, 4, v240
    v_add_u32 v249, s57, v240
    s_mov_b32 s84, 0xbdd2d3e8
    s_mov_b32 s85, 0xbdd2d3e8
    s_lshr_b32 s57, s3, 1
    s_lshl_b32 s56, s40, 1
    s_add_u32 s56, s56, s57
    s_mul_i32 s56, s56, 144
    s_mul_i32 s58, s42, 36
    s_add_u32 s56, s56, s58
    s_lshl_b32 s58, s41, 3
    s_add_u32 s58, s58, 4
    s_add_u32 s56, s56, s58
    s_lshl_b32 s56, s56, 1
    s_and_b32 s58, s3, 1
    s_add_u32 s56, s56, s58
    s_lshl_b32 s56, s56, 10
    v_mov_b32 v250, 0xc0135761
    v_mov_b32 v251, 0xc0135761
    v_lshlrev_b32 v252, 4, v0
    s_lshl_b32 s58, s58, 10
    s_cmp_ge_u32 s44, 28
    s_cselect_b32 s58, 0x80000000, s58
    v_add_u32 v254, s58, v252
    s_lshr_b32 s57, s88, 1
    s_lshl_b32 s57, s57, 2
    s_add_u32 s57, s57, s3
    s_lshl_b32 s57, s57, 7
    v_and_b32 v253, 3, v0
    v_lshl_add_u32 v253, v253, 2, s57
    s_mov_b32 s49, 9437184
    s_mov_b32 s86, 0x3e8b97f6
    s_mov_b32 s87, 0x3e8b97f6
    v_and_b32 v237, 7, v0
    v_lshlrev_b32 v237, 6, v237
    v_lshrrev_b32 v238, 5, v0
    v_lshl_add_u32 v237, v238, 3, v237
    s_lshl_b32 s57, s3, 10
    s_add_u32 s58, s57, 154112
    s_add_u32 s57, s57, 147968
    v_add_u32 v234, s57, v237
    v_lshlrev_b32 v239, 3, v0
    v_add_u32 v235, s58, v239
    v_and_b32 v236, 31, v0
    v_lshlrev_b32 v236, 1, v236
    v_lshl_add_u32 v236, v238, 8, v236
    s_bitcmp1_b32 s3, 0
    s_cselect_b64 vcc, -1, 0
    s_cselect_b32 s57, 6144, 0
    v_cndmask_b32 v236, v236, v239, vcc
    s_lshr_b32 s58, s3, 1
    s_lshl_b32 s58, s58, 10
    s_add_u32 s57, s57, s58
    s_add_u32 s57, s57, 152064
    v_add_u32 v236, s57, v236
    s_and_b32 s57, s3, 1
    s_lshl_b32 s58, s57, 10
    s_lshl_b32 s57, s57, 9
    s_sub_u32 s59, 152576, s57
    s_add_u32 s90, s58, 147968
    s_add_u32 s57, s57, 158208
    s_add_u32 s58, s58, 154112
    s_cmp_lt_u32 s3, 2
    s_cselect_b32 s59, s59, s90
    s_cselect_b32 s57, s57, s58
    s_cselect_b32 s58, 2, 1
    s_lshl_b32 s58, s58, 9
    v_add_u32 v237, s59, v237
    v_add_u32 v238, s58, v237
    v_add_u32 v239, s57, v239
    v_add_u32 v240, s58, v239
    v_accvgpr_read_b32 v204, a0
    v_accvgpr_read_b32 v205, a1
    v_accvgpr_read_b32 v206, a2
    v_accvgpr_read_b32 v207, a3
    v_lshlrev_b32 v200, 16, v204
    v_lshlrev_b32 v201, 16, v205
    v_lshlrev_b32 v202, 16, v206
    v_lshlrev_b32 v203, 16, v207
    v_and_b32 v204, s53, v204
    v_and_b32 v205, s53, v205
    v_and_b32 v206, s53, v206
    v_and_b32 v207, s53, v207
    v_fma_f32 v200, v200, v13, v14
    v_fma_f32 v201, v201, v13, v14
    v_fma_f32 v202, v202, v13, v14
    v_fma_f32 v203, v203, v13, v14
    v_fma_f32 v204, v204, v13, v14
    v_fma_f32 v205, v205, v13, v14
    v_fma_f32 v206, v206, v13, v14
    v_fma_f32 v207, v207, v13, v14
    v_cvt_pk_bf16_f32 v192, v200, v204
    v_cvt_pk_bf16_f32 v193, v201, v205
    v_cvt_pk_bf16_f32 v194, v202, v206
    v_cvt_pk_bf16_f32 v195, v203, v207
    v_accvgpr_write_b32 a0, v192
    v_accvgpr_write_b32 a1, v193
    v_accvgpr_write_b32 a2, v194
    v_accvgpr_write_b32 a3, v195
    s_add_u32 m0, s55, 20608
    s_nop 0
    buffer_load_dwordx4 v8, s[8:11], s50 offen offset:0  lds
    buffer_load_dwordx4 v9, s[8:11], s50 offen offset:1024  lds
    buffer_load_dwordx4 v10, s[8:11], s50 offen offset:2048  lds
    buffer_load_dwordx4 v11, s[12:15], s51 offen offset:3072  lds
    s_add_u32 m0, s55, 24736
    s_nop 0
    buffer_load_dwordx4 v12, s[16:19], s51 offen  lds
    s_add_u32 s52, s52, s99
    s_cmp_ge_u32 s52, 401408
    s_cselect_b32 s52, s96, s52
    s_mul_i32 s50, s52, 3
    s_lshl_b32 s51, s52, 2
    s_lshr_b32 s57, s88, 1
    s_lshl_b32 s57, s57, 2
    s_add_u32 s57, s57, s3
    s_lshl_b32 s57, s57, 7
    s_lshl_b32 s58, s40, 2
    s_add_u32 s58, s58, s42
    s_lshl_b32 s58, s58, 5
    s_add_u32 s58, s58, s41
    s_lshl_b32 s58, s58, 2
    v_and_b32 v242, 3, v0
    v_lshl_add_u32 v242, v242, 2, s57
    v_writelane_b32 v242, s58, 4
    s_mov_b32 s57, 9437184
    buffer_load_dword v243, v242, s[20:23], s57 offen sc1
    s_lshl_b32 s57, s2, 2
    s_add_u32 s57, s57, s3
    s_mul_i32 s58, s57, 1664
    v_min_u32 v199, 25, v0
    v_lshlrev_b32 v199, 6, v199
    buffer_load_dword a254, v199, s[24:27], s58 offen
    s_lshl_b32 s58, s57, 9
    v_min_u32 v199, 448, v199
    buffer_load_dword a253, v199, s[28:31], s58 offen
    v_add_u32 v6, s47, v7
    v_add_u32 v241, s101, v6
    s_waitcnt vmcnt(8) lgkmcnt(0)
    s_barrier
    ds_read_b64_tr_b16 a[112:113], v1 offset:0
    ds_read_b64_tr_b16 a[114:115], v1 offset:512
    ds_read_b64_tr_b16 a[116:117], v1 offset:1024
    ds_read_b64_tr_b16 a[118:119], v1 offset:1536
    ds_read_b64_tr_b16 a[120:121], v1 offset:2048
    ds_read_b64_tr_b16 a[122:123], v1 offset:2560
    ds_read_b64_tr_b16 a[124:125], v2 offset:0
    ds_read_b64_tr_b16 a[126:127], v2 offset:512
    ds_read_b64_tr_b16 a[128:129], v2 offset:1024
    ds_read_b64_tr_b16 a[130:131], v2 offset:1536
    ds_read_b64_tr_b16 a[132:133], v2 offset:2048
    ds_read_b64_tr_b16 a[134:135], v2 offset:2560
    ds_read_b64_tr_b16 a[136:137], v3 offset:3072
    ds_read_b64_tr_b16 a[138:139], v3 offset:3584
    v_accvgpr_read_b32 v204, a4
    v_accvgpr_read_b32 v205, a5
    v_accvgpr_read_b32 v206, a6
    s_waitcnt lgkmcnt(12)
    v_mfma_f32_32x32x16_bf16 v[16:31], a[112:115], a[0:3], 0
    s_waitcnt lgkmcnt(6)
    ds_read_b64_tr_b16 a[140:141], v3 offset:3104
    ds_read_b64_tr_b16 a[142:143], v3 offset:3616
    v_accvgpr_read_b32 v207, a7
    v_lshlrev_b32 v200, 16, v204
    v_lshlrev_b32 v201, 16, v205
    v_mfma_f32_32x32x16_bf16 v[32:47], a[116:119], a[0:3], 0
    ds_read_b64_tr_b16 a[144:145], v4 offset:3072
    ds_read_b64_tr_b16 a[146:147], v4 offset:3584
    ds_read_b64_tr_b16 a[148:149], v4 offset:3104
    v_lshlrev_b32 v202, 16, v206
    v_lshlrev_b32 v203, 16, v207
    v_and_b32 v204, s53, v204
    v_mfma_f32_32x32x16_bf16 v[48:63], a[0:3], a[120:123], 0
    ds_read_b64_tr_b16 a[150:151], v4 offset:3616
    ds_read_b64_tr_b16 a[152:153], v5 offset:0
    ds_read_b64_tr_b16 a[154:155], v5 offset:512
    v_and_b32 v205, s53, v205
    v_and_b32 v206, s53, v206
    v_and_b32 v207, s53, v207
    v_mfma_f32_32x32x16_bf16 v[64:79], a[124:127], a[0:3], 0
    s_waitcnt lgkmcnt(8)
    ds_read_b128 a[156:159], v6 offset:0
    ds_read_b64_tr_b16 a[112:113], v1 offset:10304
    ds_read_b64_tr_b16 a[114:115], v1 offset:10816
    v_fma_f32 v200, v200, v13, v14
    v_fma_f32 v201, v201, v13, v14
    v_mfma_f32_32x32x16_bf16 v[80:95], a[128:131], a[0:3], 0
    s_add_u32 m0, s55, 41216
    ds_read_b64_tr_b16 a[116:117], v1 offset:11328
    ds_read_b64_tr_b16 a[118:119], v1 offset:11840
    buffer_load_dwordx4 v8, s[8:11], s50 offen offset:0  lds
    v_fma_f32 v202, v202, v13, v14
    v_fma_f32 v203, v203, v13, v14
    v_mfma_f32_32x32x16_bf16 v[96:111], a[0:3], a[132:135], 0
    ds_read_b64_tr_b16 a[120:121], v1 offset:12352
    v_fma_f32 v204, v204, v13, v14
    v_fma_f32 v205, v205, v13, v14
    v_fma_f32 v206, v206, v13, v14
    v_fma_f32 v207, v207, v13, v14
    v_cvt_pk_bf16_f32 v196, v200, v204
    v_mfma_f32_32x32x16_bf16 v[112:127], a[136:139], a[0:3], 0
    s_waitcnt lgkmcnt(8)
    ds_read_b64_tr_b16 a[122:123], v1 offset:12864
    ds_read_b64_tr_b16 a[124:125], v2 offset:10304
    ds_read_b64_tr_b16 a[126:127], v2 offset:10816
    buffer_load_dwordx4 v9, s[8:11], s50 offen offset:1024  lds
    v_cvt_pk_bf16_f32 v197, v201, v205
    v_mfma_f32_32x32x16_bf16 v[128:143], a[140:143], a[0:3], 0
    ds_read_b64_tr_b16 a[128:129], v2 offset:11328
    ds_read_b64_tr_b16 a[130:131], v2 offset:11840
    v_cvt_pk_bf16_f32 v198, v202, v206
    v_cvt_pk_bf16_f32 v199, v203, v207
    v_mfma_f32_32x32x16_bf16 v[144:159], a[144:147], a[0:3], 0
    ds_read_b64_tr_b16 a[132:133], v2 offset:12352
    buffer_load_dwordx4 v10, s[8:11], s50 offen offset:2048  lds
    v_mfma_f32_32x32x16_bf16 v[160:175], a[148:151], a[0:3], 0
    s_waitcnt lgkmcnt(7)
    ds_read_b64_tr_b16 a[134:135], v2 offset:12864
    ds_read_b64_tr_b16 a[136:137], v3 offset:13376
    ds_read_b64_tr_b16 a[138:139], v3 offset:13888
    v_mfma_f32_32x32x16_bf16 v[176:191], a[156:159], a[152:155], 0
    ds_read_b64_tr_b16 a[140:141], v3 offset:13408
    ds_read_b64_tr_b16 a[142:143], v3 offset:13920
    buffer_load_dwordx4 v11, s[12:15], s51 offen offset:3072  lds
    v_accvgpr_read_b32 v204, a8
    v_accvgpr_read_b32 v205, a9
    v_accvgpr_read_b32 v206, a10
    v_mfma_f32_32x32x16_bf16 v[16:31], a[112:115], v[196:199], v[16:31]
    ds_read_b64_tr_b16 a[144:145], v4 offset:13376
    ds_read_b64_tr_b16 a[146:147], v4 offset:13888
    v_accvgpr_read_b32 v207, a11
    v_lshlrev_b32 v200, 16, v204
    v_lshlrev_b32 v201, 16, v205
    v_lshlrev_b32 v202, 16, v206
    v_mfma_f32_32x32x16_bf16 v[32:47], a[116:119], v[196:199], v[32:47]
    s_waitcnt lgkmcnt(8)
    ds_read_b64_tr_b16 a[148:149], v4 offset:13408
    ds_read_b64_tr_b16 a[150:151], v4 offset:13920
    v_lshlrev_b32 v203, 16, v207
    v_and_b32 v204, s53, v204
    v_and_b32 v205, s53, v205
    v_mfma_f32_32x32x16_bf16 v[48:63], v[196:199], a[120:123], v[48:63]
    s_add_u32 m0, s55, 45344
    ds_read_b64_tr_b16 a[152:153], v5 offset:10304
    ds_read_b64_tr_b16 a[154:155], v5 offset:10816
    buffer_load_dwordx4 v12, s[16:19], s51 offen  lds
    v_and_b32 v206, s53, v206
    v_and_b32 v207, s53, v207
    v_mfma_f32_32x32x16_bf16 v[64:79], a[124:127], v[196:199], v[64:79]
    s_add_u32 s52, s52, s98
    ds_read_b128 a[156:159], v6 offset:32
    v_fma_f32 v200, v200, v13, v14
    v_fma_f32 v201, v201, v13, v14
    v_fma_f32 v202, v202, v13, v14
    v_fma_f32 v203, v203, v13, v14
    v_mfma_f32_32x32x16_bf16 v[80:95], a[128:131], v[196:199], v[80:95]
    s_waitcnt lgkmcnt(7)
    s_mul_i32 s50, s52, 3
    s_lshl_b32 s51, s52, 2
    s_add_u32 m0, s55, 61824
    v_fma_f32 v204, v204, v13, v14
    v_fma_f32 v205, v205, v13, v14
    v_mfma_f32_32x32x16_bf16 v[96:111], v[196:199], a[132:135], v[96:111]
    buffer_load_dwordx4 v8, s[8:11], s50 offen offset:0  lds
    v_fma_f32 v206, v206, v13, v14
    v_fma_f32 v207, v207, v13, v14
    v_cvt_pk_bf16_f32 v192, v200, v204
    v_cvt_pk_bf16_f32 v193, v201, v205
    v_cvt_pk_bf16_f32 v194, v202, v206
    v_mfma_f32_32x32x16_bf16 v[112:127], a[136:139], v[196:199], v[112:127]
    s_waitcnt vmcnt(9) lgkmcnt(0)
    s_barrier
    ds_read_b64_tr_b16 a[112:113], v1 offset:20608
    ds_read_b64_tr_b16 a[114:115], v1 offset:21120
    ds_read_b64_tr_b16 a[116:117], v1 offset:21632
    v_cvt_pk_bf16_f32 v195, v203, v207
    v_mfma_f32_32x32x16_bf16 v[128:143], a[140:143], v[196:199], v[128:143]
    ds_read_b64_tr_b16 a[118:119], v1 offset:22144
    ds_read_b64_tr_b16 a[120:121], v1 offset:22656
    ds_read_b64_tr_b16 a[122:123], v1 offset:23168
    buffer_load_dwordx4 v9, s[8:11], s50 offen offset:1024  lds
    v_mfma_f32_32x32x16_bf16 v[144:159], a[144:147], v[196:199], v[144:159]
    ds_read_b64_tr_b16 a[124:125], v2 offset:20608
    ds_read_b64_tr_b16 a[126:127], v2 offset:21120
    ds_read_b64_tr_b16 a[128:129], v2 offset:21632
    v_mfma_f32_32x32x16_bf16 v[160:175], a[148:151], v[196:199], v[160:175]
    ds_read_b64_tr_b16 a[130:131], v2 offset:22144
    ds_read_b64_tr_b16 a[132:133], v2 offset:22656
    ds_read_b64_tr_b16 a[134:135], v2 offset:23168
    buffer_load_dwordx4 v10, s[8:11], s50 offen offset:2048  lds
    v_mfma_f32_32x32x16_bf16 v[176:191], a[156:159], a[152:155], v[176:191]
    s_waitcnt lgkmcnt(6)
    ds_read_b64_tr_b16 a[136:137], v3 offset:23680
    ds_read_b64_tr_b16 a[138:139], v3 offset:24192
    v_accvgpr_read_b32 v204, a12
    v_accvgpr_read_b32 v205, a13
    v_accvgpr_read_b32 v206, a14
    v_mfma_f32_32x32x16_bf16 v[16:31], a[112:115], v[192:195], v[16:31]
    ds_read_b64_tr_b16 a[140:141], v3 offset:23712
    ds_read_b64_tr_b16 a[142:143], v3 offset:24224
    ds_read_b64_tr_b16 a[144:145], v4 offset:23680
    v_accvgpr_read_b32 v207, a15
    v_lshlrev_b32 v200, 16, v204
    v_lshlrev_b32 v201, 16, v205
    v_mfma_f32_32x32x16_bf16 v[32:47], a[116:119], v[192:195], v[32:47]
    ds_read_b64_tr_b16 a[146:147], v4 offset:24192
    ds_read_b64_tr_b16 a[148:149], v4 offset:23712
    ds_read_b64_tr_b16 a[150:151], v4 offset:24224
    v_lshlrev_b32 v202, 16, v206
    v_lshlrev_b32 v203, 16, v207
    v_and_b32 v204, s53, v204
    v_mfma_f32_32x32x16_bf16 v[48:63], v[192:195], a[120:123], v[48:63]
    s_waitcnt lgkmcnt(8)
    ds_read_b64_tr_b16 a[152:153], v5 offset:20608
    buffer_load_dwordx4 v11, s[12:15], s51 offen offset:3072  lds
    v_and_b32 v205, s53, v205
    v_and_b32 v206, s53, v206
    v_and_b32 v207, s53, v207
    v_mfma_f32_32x32x16_bf16 v[64:79], a[124:127], v[192:195], v[64:79]
    s_add_u32 m0, s55, 65952
    ds_read_b64_tr_b16 a[154:155], v5 offset:21120
    ds_read_b128 a[156:159], v241 offset:0
    ds_read_b64_tr_b16 a[112:113], v1 offset:30912
    v_fma_f32 v200, v200, v13, v14
    v_fma_f32 v201, v201, v13, v14
    v_mfma_f32_32x32x16_bf16 v[80:95], a[128:131], v[192:195], v[80:95]
    ds_read_b64_tr_b16 a[114:115], v1 offset:31424
    ds_read_b64_tr_b16 a[116:117], v1 offset:31936
    buffer_load_dwordx4 v12, s[16:19], s51 offen  lds
    v_fma_f32 v202, v202, v13, v14
    v_fma_f32 v203, v203, v13, v14
    v_fma_f32 v204, v204, v13, v14
    v_mfma_f32_32x32x16_bf16 v[96:111], v[192:195], a[132:135], v[96:111]
    s_waitcnt lgkmcnt(8)
    ds_read_b64_tr_b16 a[118:119], v1 offset:32448
    ds_read_b64_tr_b16 a[120:121], v1 offset:32960
    ds_read_b64_tr_b16 a[122:123], v1 offset:33472
    v_fma_f32 v205, v205, v13, v14
    v_fma_f32 v206, v206, v13, v14
    v_mfma_f32_32x32x16_bf16 v[112:127], a[136:139], v[192:195], v[112:127]
    s_add_u32 s52, s52, s99
    s_cmp_ge_u32 s52, 401408
    s_cselect_b32 s52, s96, s52
    ds_read_b64_tr_b16 a[124:125], v2 offset:30912
    v_fma_f32 v207, v207, v13, v14
    v_cvt_pk_bf16_f32 v196, v200, v204
    v_mfma_f32_32x32x16_bf16 v[128:143], a[140:143], v[192:195], v[128:143]
    s_mul_i32 s50, s52, 3
    ds_read_b64_tr_b16 a[126:127], v2 offset:31424
    ds_read_b64_tr_b16 a[128:129], v2 offset:31936
    v_cvt_pk_bf16_f32 v197, v201, v205
    v_cvt_pk_bf16_f32 v198, v202, v206
    v_cvt_pk_bf16_f32 v199, v203, v207
    v_mfma_f32_32x32x16_bf16 v[144:159], a[144:147], v[192:195], v[144:159]
    s_waitcnt lgkmcnt(7)
    s_lshl_b32 s51, s52, 2
    s_add_u32 m0, s55, 0
    ds_read_b64_tr_b16 a[130:131], v2 offset:32448
    ds_read_b64_tr_b16 a[132:133], v2 offset:32960
    buffer_load_dwordx4 v8, s[8:11], s50 offen offset:0  lds
    v_mfma_f32_32x32x16_bf16 v[160:175], a[148:151], v[192:195], v[160:175]
    ds_read_b64_tr_b16 a[134:135], v2 offset:33472
    ds_read_b64_tr_b16 a[136:137], v3 offset:33984
    ds_read_b64_tr_b16 a[138:139], v3 offset:34496
    v_mfma_f32_32x32x16_bf16 v[176:191], a[156:159], a[152:155], v[176:191]
    ds_read_b64_tr_b16 a[140:141], v3 offset:34016
    ds_read_b64_tr_b16 a[142:143], v3 offset:34528
    buffer_load_dwordx4 v9, s[8:11], s50 offen offset:1024  lds
    v_accvgpr_read_b32 v204, a16
    v_accvgpr_read_b32 v205, a17
    v_accvgpr_read_b32 v206, a18
    v_mfma_f32_32x32x16_bf16 v[16:31], a[112:115], v[196:199], v[16:31]
    s_waitcnt lgkmcnt(8)
    ds_read_b64_tr_b16 a[144:145], v4 offset:33984
    ds_read_b64_tr_b16 a[146:147], v4 offset:34496
    v_accvgpr_read_b32 v207, a19
    v_lshlrev_b32 v200, 16, v204
    v_lshlrev_b32 v201, 16, v205
    v_mfma_f32_32x32x16_bf16 v[32:47], a[116:119], v[196:199], v[32:47]
    ds_read_b64_tr_b16 a[148:149], v4 offset:34016
    ds_read_b64_tr_b16 a[150:151], v4 offset:34528
    buffer_load_dwordx4 v10, s[8:11], s50 offen offset:2048  lds
    v_lshlrev_b32 v202, 16, v206
    v_lshlrev_b32 v203, 16, v207
    v_and_b32 v204, s53, v204
    v_mfma_f32_32x32x16_bf16 v[48:63], v[196:199], a[120:123], v[48:63]
    ds_read_b64_tr_b16 a[152:153], v5 offset:30912
    ds_read_b64_tr_b16 a[154:155], v5 offset:31424
    v_and_b32 v205, s53, v205
    v_and_b32 v206, s53, v206
    v_and_b32 v207, s53, v207
    v_fma_f32 v200, v200, v13, v14
    v_mfma_f32_32x32x16_bf16 v[64:79], a[124:127], v[196:199], v[64:79]
    s_waitcnt lgkmcnt(8)
    ds_read_b128 a[156:159], v241 offset:32
    buffer_load_dwordx4 v11, s[12:15], s51 offen offset:3072  lds
    v_fma_f32 v201, v201, v13, v14
    v_fma_f32 v202, v202, v13, v14
    v_fma_f32 v203, v203, v13, v14
    v_mfma_f32_32x32x16_bf16 v[80:95], a[128:131], v[196:199], v[80:95]
    s_add_u32 m0, s55, 4128
    v_fma_f32 v204, v204, v13, v14
    v_fma_f32 v205, v205, v13, v14
    v_fma_f32 v206, v206, v13, v14
    v_fma_f32 v207, v207, v13, v14
    v_cvt_pk_bf16_f32 v192, v200, v204
    v_mfma_f32_32x32x16_bf16 v[96:111], v[196:199], a[132:135], v[96:111]
    buffer_load_dwordx4 v12, s[16:19], s51 offen  lds
    v_cvt_pk_bf16_f32 v193, v201, v205
    v_cvt_pk_bf16_f32 v194, v202, v206
    v_cvt_pk_bf16_f32 v195, v203, v207
    s_add_u32 s52, s52, s98
    s_mul_i32 s50, s52, 3
    v_mfma_f32_32x32x16_bf16 v[112:127], a[136:139], v[196:199], v[112:127]
    s_waitcnt lgkmcnt(7)
    s_waitcnt vmcnt(10) lgkmcnt(0)
    s_barrier
    v_readlane_b32 s69, v243, 0
    v_readlane_b32 s70, v243, 1
    v_readlane_b32 s71, v243, 2
    v_readlane_b32 s72, v243, 3
    v_readlane_b32 s73, v243, 4
    s_add_u32 s47, s47, 128
    s_cmp_eq_u32 s47, 896
    s_cselect_b32 s47, 0, s47
    v_add_u32 v6, s47, v7
    v_add_u32 v241, s101, v6
    v_mfma_f32_32x32x16_bf16 v[128:143], a[140:143], v[196:199], v[128:143]
    s_lshl_b32 s51, s52, 2
    s_add_u32 m0, s55, 20608
    ds_read_b64_tr_b16 a[112:113], v228 offset:0
    ds_read_b64_tr_b16 a[114:115], v228 offset:512
    ds_read_b64_tr_b16 a[116:117], v228 offset:1024
    buffer_load_dwordx4 v8, s[8:11], s50 offen offset:0  lds
    v_mfma_f32_32x32x16_bf16 v[144:159], a[144:147], v[196:199], v[144:159]
    ds_read_b64_tr_b16 a[118:119], v228 offset:1536
    ds_read_b64_tr_b16 a[120:121], v228 offset:2048
    ds_read_b64_tr_b16 a[122:123], v228 offset:2560
    v_mfma_f32_32x32x16_bf16 v[160:175], a[148:151], v[196:199], v[160:175]
    ds_read_b64_tr_b16 a[124:125], v229 offset:0
    ds_read_b64_tr_b16 a[126:127], v229 offset:512
    ds_read_b64_tr_b16 a[128:129], v229 offset:1024
    buffer_load_dwordx4 v9, s[8:11], s50 offen offset:1024  lds
    v_mfma_f32_32x32x16_bf16 v[176:191], a[156:159], a[152:155], v[176:191]
    s_waitcnt lgkmcnt(7)
    ds_read_b64_tr_b16 a[130:131], v229 offset:1536
    ds_read_b64_tr_b16 a[132:133], v229 offset:2048
    v_accvgpr_read_b32 v204, a20
    v_accvgpr_read_b32 v205, a21
    v_accvgpr_read_b32 v206, a22
    v_mfma_f32_32x32x16_bf16 v[16:31], a[112:115], v[192:195], v[16:31]
    s_waitcnt lgkmcnt(7)
    ds_read_b64_tr_b16 a[134:135], v229 offset:2560
    ds_read_b64_tr_b16 a[136:137], v230 offset:3072
    v_accvgpr_read_b32 v207, a23
    v_lshlrev_b32 v200, 16, v204
    v_lshlrev_b32 v201, 16, v205
    v_mfma_f32_32x32x16_bf16 v[32:47], a[116:119], v[192:195], v[32:47]
    s_waitcnt lgkmcnt(7)
    ds_read_b64_tr_b16 a[138:139], v230 offset:3584
    ds_read_b64_tr_b16 a[140:141], v230 offset:3104
    v_lshlrev_b32 v202, 16, v206
    v_lshlrev_b32 v203, 16, v207
    v_and_b32 v204, s53, v204
    v_mfma_f32_32x32x16_bf16 v[48:63], v[192:195], a[120:123], v[48:63]
    s_waitcnt lgkmcnt(7)
    ds_read_b64_tr_b16 a[142:143], v230 offset:3616
    ds_read_b64_tr_b16 a[144:145], v231 offset:3072
    v_and_b32 v205, s53, v205
    v_and_b32 v206, s53, v206
    v_and_b32 v207, s53, v207
    v_mfma_f32_32x32x16_bf16 v[64:79], a[124:127], v[192:195], v[64:79]
    s_waitcnt lgkmcnt(7)
    ds_read_b64_tr_b16 a[146:147], v231 offset:3584
    ds_read_b64_tr_b16 a[148:149], v231 offset:3104
    ds_read_b64_tr_b16 a[150:151], v231 offset:3616
    v_fma_f32 v200, v200, v13, v14
    v_fma_f32 v201, v201, v13, v14
    v_mfma_f32_32x32x16_bf16 v[80:95], a[128:131], v[192:195], v[80:95]
    s_waitcnt lgkmcnt(6)
    ds_read_b64_tr_b16 a[152:153], v232 offset:0
    ds_read_b64_tr_b16 a[154:155], v232 offset:512
    ds_read_b128 a[156:159], v6 offset:0
    v_fma_f32 v202, v202, v13, v14
    v_fma_f32 v203, v203, v13, v14
    v_mfma_f32_32x32x16_bf16 v[96:111], v[192:195], a[132:135], v[96:111]
    ds_read_b64_tr_b16 a[112:113], v228 offset:10304
    ds_read_b64_tr_b16 a[114:115], v228 offset:10816
    ds_read_b64_tr_b16 a[116:117], v228 offset:11328
    buffer_load_dwordx4 v10, s[8:11], s50 offen offset:2048  lds
    v_fma_f32 v204, v204, v13, v14
    v_fma_f32 v205, v205, v13, v14
    v_mfma_f32_32x32x16_bf16 v[112:127], a[136:139], v[192:195], v[112:127]
    s_waitcnt lgkmcnt(6)
    ds_read_b64_tr_b16 a[118:119], v228 offset:11840
    ds_read_b64_tr_b16 a[120:121], v228 offset:12352
    ds_read_b64_tr_b16 a[122:123], v228 offset:12864
    v_fma_f32 v206, v206, v13, v14
    v_fma_f32 v207, v207, v13, v14
    v_mfma_f32_32x32x16_bf16 v[128:143], a[140:143], v[192:195], v[128:143]
    ds_read_b64_tr_b16 a[124:125], v229 offset:10304
    ds_read_b64_tr_b16 a[126:127], v229 offset:10816
    ds_read_b64_tr_b16 a[128:129], v229 offset:11328
    buffer_load_dwordx4 v11, s[12:15], s51 offen offset:3072  lds
    v_cvt_pk_bf16_f32 v196, v200, v204
    v_cvt_pk_bf16_f32 v197, v201, v205
    v_mfma_f32_32x32x16_bf16 v[144:159], a[144:147], v[192:195], v[144:159]
    s_add_u32 m0, s55, 24736
    ds_read_b64_tr_b16 a[130:131], v229 offset:11840
    ds_read_b64_tr_b16 a[132:133], v229 offset:12352
    v_cvt_pk_bf16_f32 v198, v202, v206
    v_cvt_pk_bf16_f32 v199, v203, v207
    v_mfma_f32_32x32x16_bf16 v[160:175], a[148:151], v[192:195], v[160:175]
    s_waitcnt lgkmcnt(7)
    ds_read_b64_tr_b16 a[134:135], v229 offset:12864
    ds_read_b64_tr_b16 a[136:137], v230 offset:13376
    ds_read_b64_tr_b16 a[138:139], v230 offset:13888
    buffer_load_dwordx4 v12, s[16:19], s51 offen  lds
    s_add_u32 s52, s52, s99
    v_mfma_f32_32x32x16_bf16 v[176:191], a[156:159], a[152:155], v[176:191]
    ds_read_b64_tr_b16 a[140:141], v230 offset:13408
    ds_read_b64_tr_b16 a[142:143], v230 offset:13920
    ds_read_b64_tr_b16 a[144:145], v231 offset:13376
    v_accvgpr_read_b32 v204, a24
    v_accvgpr_read_b32 v205, a25
    v_accvgpr_read_b32 v206, a26
    v_mfma_f32_32x32x16_bf16 v[16:31], a[112:115], v[196:199], v[16:31]
    ds_read_b64_tr_b16 a[146:147], v231 offset:13888
    v_accvgpr_read_b32 v207, a27
    v_lshlrev_b32 v200, 16, v204
    v_lshlrev_b32 v201, 16, v205
    v_lshlrev_b32 v202, 16, v206
    v_lshlrev_b32 v203, 16, v207
    v_mfma_f32_32x32x16_bf16 v[32:47], a[116:119], v[196:199], v[32:47]
    s_waitcnt lgkmcnt(8)
    ds_read_b64_tr_b16 a[148:149], v231 offset:13408
    ds_read_b64_tr_b16 a[150:151], v231 offset:13920
    ds_read_b64_tr_b16 a[152:153], v232 offset:10304
    v_and_b32 v204, s53, v204
    v_and_b32 v205, s53, v205
    v_mfma_f32_32x32x16_bf16 v[48:63], v[196:199], a[120:123], v[48:63]
    s_cmp_ge_u32 s52, 401408
    s_cselect_b32 s52, s96, s52
    ds_read_b64_tr_b16 a[154:155], v232 offset:10816
    ds_read_b128 a[156:159], v6 offset:32
    v_and_b32 v206, s53, v206
    v_and_b32 v207, s53, v207
    v_mfma_f32_32x32x16_bf16 v[64:79], a[124:127], v[196:199], v[64:79]
    s_mul_i32 s50, s52, 3
    s_lshl_b32 s51, s52, 2
    v_fma_f32 v200, v200, v13, v14
    v_fma_f32 v201, v201, v13, v14
    v_fma_f32 v202, v202, v13, v14
    v_fma_f32 v203, v203, v13, v14
    v_mfma_f32_32x32x16_bf16 v[80:95], a[128:131], v[196:199], v[80:95]
    s_waitcnt lgkmcnt(7)
    v_fma_f32 v204, v204, v13, v14
    v_fma_f32 v205, v205, v13, v14
    v_fma_f32 v206, v206, v13, v14
    v_fma_f32 v207, v207, v13, v14
    v_cvt_pk_bf16_f32 v192, v200, v204
    v_mfma_f32_32x32x16_bf16 v[96:111], v[196:199], a[132:135], v[96:111]
    s_waitcnt vmcnt(10) lgkmcnt(0)
    s_barrier
    ds_read_b64_tr_b16 a[112:113], v228 offset:20608
    ds_read_b64_tr_b16 a[114:115], v228 offset:21120
    ds_read_b64_tr_b16 a[116:117], v228 offset:21632
    v_cvt_pk_bf16_f32 v193, v201, v205
    v_mfma_f32_32x32x16_bf16 v[112:127], a[136:139], v[196:199], v[112:127]
    s_add_u32 m0, s55, 41216
    ds_read_b64_tr_b16 a[118:119], v228 offset:22144
    ds_read_b64_tr_b16 a[120:121], v228 offset:22656
    ds_read_b64_tr_b16 a[122:123], v228 offset:23168
    buffer_load_dwordx4 v8, s[8:11], s50 offen offset:0  lds
    v_cvt_pk_bf16_f32 v194, v202, v206
    v_mfma_f32_32x32x16_bf16 v[128:143], a[140:143], v[196:199], v[128:143]
    ds_read_b64_tr_b16 a[124:125], v229 offset:20608
    ds_read_b64_tr_b16 a[126:127], v229 offset:21120
    ds_read_b64_tr_b16 a[128:129], v229 offset:21632
    v_cvt_pk_bf16_f32 v195, v203, v207
    v_mfma_f32_32x32x16_bf16 v[144:159], a[144:147], v[196:199], v[144:159]
    ds_read_b64_tr_b16 a[130:131], v229 offset:22144
    ds_read_b64_tr_b16 a[132:133], v229 offset:22656
    ds_read_b64_tr_b16 a[134:135], v229 offset:23168
    buffer_load_dwordx4 v9, s[8:11], s50 offen offset:1024  lds
    v_mfma_f32_32x32x16_bf16 v[160:175], a[148:151], v[196:199], v[160:175]
    ds_read_b64_tr_b16 a[136:137], v230 offset:23680
    ds_read_b64_tr_b16 a[138:139], v230 offset:24192
    v_mfma_f32_32x32x16_bf16 v[176:191], a[156:159], a[152:155], v[176:191]
    s_waitcnt lgkmcnt(8)
    ds_read_b64_tr_b16 a[140:141], v230 offset:23712
    buffer_load_dwordx4 v10, s[8:11], s50 offen offset:2048  lds
    v_accvgpr_read_b32 v204, a28
    v_accvgpr_read_b32 v205, a29
    v_accvgpr_read_b32 v206, a30
    v_mfma_f32_32x32x16_bf16 v[16:31], a[112:115], v[192:195], v[16:31]
    ds_read_b64_tr_b16 a[142:143], v230 offset:24224
    ds_read_b64_tr_b16 a[144:145], v231 offset:23680
    ds_read_b64_tr_b16 a[146:147], v231 offset:24192
    v_accvgpr_read_b32 v207, a31
    v_lshlrev_b32 v200, 16, v204
    v_lshlrev_b32 v201, 16, v205
    v_mfma_f32_32x32x16_bf16 v[32:47], a[116:119], v[192:195], v[32:47]
    ds_read_b64_tr_b16 a[148:149], v231 offset:23712
    ds_read_b64_tr_b16 a[150:151], v231 offset:24224
    buffer_load_dwordx4 v11, s[12:15], s51 offen offset:3072  lds
    v_lshlrev_b32 v202, 16, v206
    v_lshlrev_b32 v203, 16, v207
    v_and_b32 v204, s53, v204
    v_mfma_f32_32x32x16_bf16 v[48:63], v[192:195], a[120:123], v[48:63]
    s_waitcnt lgkmcnt(8)
    ds_read_b64_tr_b16 a[152:153], v232 offset:20608
    ds_read_b64_tr_b16 a[154:155], v232 offset:21120
    v_and_b32 v205, s53, v205
    v_and_b32 v206, s53, v206
    v_and_b32 v207, s53, v207
    v_mfma_f32_32x32x16_bf16 v[64:79], a[124:127], v[192:195], v[64:79]
    s_add_u32 m0, s55, 45344
    ds_read_b128 a[156:159], v241 offset:0
    ds_read_b64_tr_b16 a[112:113], v228 offset:30912
    buffer_load_dwordx4 v12, s[16:19], s51 offen  lds
    v_fma_f32 v200, v200, v13, v14
    v_fma_f32 v201, v201, v13, v14
    v_mfma_f32_32x32x16_bf16 v[80:95], a[128:131], v[192:195], v[80:95]
    s_add_u32 s52, s52, s98
    ds_read_b64_tr_b16 a[114:115], v228 offset:31424
    ds_read_b64_tr_b16 a[116:117], v228 offset:31936
    v_fma_f32 v202, v202, v13, v14
    v_fma_f32 v203, v203, v13, v14
    v_fma_f32 v204, v204, v13, v14
    v_mfma_f32_32x32x16_bf16 v[96:111], v[192:195], a[132:135], v[96:111]
    s_waitcnt lgkmcnt(8)
    ds_read_b64_tr_b16 a[118:119], v228 offset:32448
    ds_read_b64_tr_b16 a[120:121], v228 offset:32960
    ds_read_b64_tr_b16 a[122:123], v228 offset:33472
    v_fma_f32 v205, v205, v13, v14
    v_fma_f32 v206, v206, v13, v14
    v_mfma_f32_32x32x16_bf16 v[112:127], a[136:139], v[192:195], v[112:127]
    s_mul_i32 s50, s52, 3
    s_lshl_b32 s51, s52, 2
    ds_read_b64_tr_b16 a[124:125], v229 offset:30912
    ds_read_b64_tr_b16 a[126:127], v229 offset:31424
    v_fma_f32 v207, v207, v13, v14
    v_cvt_pk_bf16_f32 v196, v200, v204
    v_mfma_f32_32x32x16_bf16 v[128:143], a[140:143], v[192:195], v[128:143]
    s_add_u32 m0, s60, 0
    ds_read_b64_tr_b16 a[128:129], v229 offset:31936
    buffer_load_dwordx4 v15, s[24:27], s74 offen  lds
    v_cvt_pk_bf16_f32 v197, v201, v205
    v_cvt_pk_bf16_f32 v198, v202, v206
    v_cvt_pk_bf16_f32 v199, v203, v207
    v_mfma_f32_32x32x16_bf16 v[144:159], a[144:147], v[192:195], v[144:159]
    s_waitcnt lgkmcnt(7)
    ds_read_b64_tr_b16 a[130:131], v229 offset:32448
    ds_read_b64_tr_b16 a[132:133], v229 offset:32960
    ds_read_b64_tr_b16 a[134:135], v229 offset:33472
    v_mfma_f32_32x32x16_bf16 v[160:175], a[148:151], v[192:195], v[160:175]
    ds_read_b64_tr_b16 a[136:137], v230 offset:33984
    ds_read_b64_tr_b16 a[138:139], v230 offset:34496
    buffer_load_dwordx4 v233, s[24:27], s74 offen offset:1024  lds
    s_add_u32 m0, s60, 2048
    s_add_u32 s46, s74, 14336
    v_mfma_f32_32x32x16_bf16 v[176:191], a[156:159], a[152:155], v[176:191]
    ds_read_b64_tr_b16 a[140:141], v230 offset:34016
    ds_read_b64_tr_b16 a[142:143], v230 offset:34528
    v_accvgpr_read_b32 v204, a32
    v_accvgpr_read_b32 v205, a33
    v_accvgpr_read_b32 v206, a34
    v_accvgpr_read_b32 v207, a35
    v_mfma_f32_32x32x16_bf16 v[16:31], a[112:115], v[196:199], v[16:31]
    s_waitcnt lgkmcnt(8)
    ds_read_b64_tr_b16 a[144:145], v231 offset:33984
    buffer_load_dwordx4 v15, s[24:27], s46 offen  lds
    v_lshlrev_b32 v200, 16, v204
    v_lshlrev_b32 v201, 16, v205
    v_lshlrev_b32 v202, 16, v206
    v_mfma_f32_32x32x16_bf16 v[32:47], a[116:119], v[196:199], v[32:47]
    ds_read_b64_tr_b16 a[146:147], v231 offset:34496
    ds_read_b64_tr_b16 a[148:149], v231 offset:34016
    ds_read_b64_tr_b16 a[150:151], v231 offset:34528
    v_lshlrev_b32 v203, 16, v207
    v_and_b32 v204, s53, v204
    v_and_b32 v205, s53, v205
    v_mfma_f32_32x32x16_bf16 v[48:63], v[196:199], a[120:123], v[48:63]
    ds_read_b64_tr_b16 a[152:153], v232 offset:30912
    ds_read_b64_tr_b16 a[154:155], v232 offset:31424
    buffer_load_dwordx4 v233, s[24:27], s46 offen offset:1024  lds
    v_and_b32 v206, s53, v206
    v_and_b32 v207, s53, v207
    v_fma_f32 v200, v200, v13, v14
    v_mfma_f32_32x32x16_bf16 v[64:79], a[124:127], v[196:199], v[64:79]
    s_waitcnt lgkmcnt(8)
    ds_read_b128 a[156:159], v241 offset:32
    v_fma_f32 v201, v201, v13, v14
    v_fma_f32 v202, v202, v13, v14
    v_fma_f32 v203, v203, v13, v14
    v_fma_f32 v204, v204, v13, v14
    v_mfma_f32_32x32x16_bf16 v[80:95], a[128:131], v[196:199], v[80:95]
    s_add_u32 m0, s60, 4096
    s_add_u32 s46, s74, 28672
    buffer_load_dwordx4 v15, s[24:27], s46 offen  lds
    v_fma_f32 v205, v205, v13, v14
    v_fma_f32 v206, v206, v13, v14
    v_fma_f32 v207, v207, v13, v14
    v_mfma_f32_32x32x16_bf16 v[96:111], v[196:199], a[132:135], v[96:111]
    v_cvt_pk_bf16_f32 v192, v200, v204
    v_cvt_pk_bf16_f32 v193, v201, v205
    v_cvt_pk_bf16_f32 v194, v202, v206
    v_cvt_pk_bf16_f32 v195, v203, v207
    v_mfma_f32_32x32x16_bf16 v[112:127], a[136:139], v[196:199], v[112:127]
    s_waitcnt lgkmcnt(7)
    s_waitcnt vmcnt(15) lgkmcnt(0)
    s_barrier
    s_add_u32 s47, s47, 128
    s_cmp_eq_u32 s47, 896
    s_cselect_b32 s47, 0, s47
    v_add_u32 v6, s47, v7
    v_add_u32 v241, s101, v6
    v_mfma_f32_32x32x16_bf16 v[128:143], a[140:143], v[196:199], v[128:143]
    ds_read_b64_tr_b16 a[112:113], v1 offset:0
    ds_read_b64_tr_b16 a[114:115], v1 offset:512
    ds_read_b64_tr_b16 a[116:117], v1 offset:1024
    buffer_load_dwordx4 v233, s[24:27], s46 offen offset:1024  lds
    s_add_u32 m0, s55, 61824
    v_mfma_f32_32x32x16_bf16 v[144:159], a[144:147], v[196:199], v[144:159]
    ds_read_b64_tr_b16 a[118:119], v1 offset:1536
    ds_read_b64_tr_b16 a[120:121], v1 offset:2048
    ds_read_b64_tr_b16 a[122:123], v1 offset:2560
    v_mfma_f32_32x32x16_bf16 v[160:175], a[148:151], v[196:199], v[160:175]
    ds_read_b64_tr_b16 a[124:125], v2 offset:0
    ds_read_b64_tr_b16 a[126:127], v2 offset:512
    ds_read_b64_tr_b16 a[128:129], v2 offset:1024
    buffer_load_dwordx4 v8, s[8:11], s50 offen offset:0  lds
    v_mfma_f32_32x32x16_bf16 v[176:191], a[156:159], a[152:155], v[176:191]
    s_waitcnt lgkmcnt(7)
    ds_read_b64_tr_b16 a[130:131], v2 offset:1536
    ds_read_b64_tr_b16 a[132:133], v2 offset:2048
    v_accvgpr_read_b32 v204, a36
    v_accvgpr_read_b32 v205, a37
    v_accvgpr_read_b32 v206, a38
    v_mfma_f32_32x32x16_bf16 v[16:31], a[112:115], v[192:195], v[16:31]
    s_waitcnt lgkmcnt(7)
    ds_read_b64_tr_b16 a[134:135], v2 offset:2560
    ds_read_b64_tr_b16 a[136:137], v3 offset:3072
    v_accvgpr_read_b32 v207, a39
    v_lshlrev_b32 v200, 16, v204
    v_lshlrev_b32 v201, 16, v205
    v_mfma_f32_32x32x16_bf16 v[32:47], a[116:119], v[192:195], v[32:47]
    s_waitcnt lgkmcnt(7)
    ds_read_b64_tr_b16 a[138:139], v3 offset:3584
    ds_read_b64_tr_b16 a[140:141], v3 offset:3104
    v_lshlrev_b32 v202, 16, v206
    v_lshlrev_b32 v203, 16, v207
    v_and_b32 v204, s53, v204
    v_mfma_f32_32x32x16_bf16 v[48:63], v[192:195], a[120:123], v[48:63]
    s_waitcnt lgkmcnt(7)
    ds_read_b64_tr_b16 a[142:143], v3 offset:3616
    ds_read_b64_tr_b16 a[144:145], v4 offset:3072
    v_and_b32 v205, s53, v205
    v_and_b32 v206, s53, v206
    v_and_b32 v207, s53, v207
    v_mfma_f32_32x32x16_bf16 v[64:79], a[124:127], v[192:195], v[64:79]
    s_waitcnt lgkmcnt(7)
    ds_read_b64_tr_b16 a[146:147], v4 offset:3584
    ds_read_b64_tr_b16 a[148:149], v4 offset:3104
    ds_read_b64_tr_b16 a[150:151], v4 offset:3616
    v_fma_f32 v200, v200, v13, v14
    v_fma_f32 v201, v201, v13, v14
    v_mfma_f32_32x32x16_bf16 v[80:95], a[128:131], v[192:195], v[80:95]
    s_waitcnt lgkmcnt(6)
    ds_read_b64_tr_b16 a[152:153], v5 offset:0
    ds_read_b64_tr_b16 a[154:155], v5 offset:512
    ds_read_b128 a[156:159], v6 offset:0
    v_fma_f32 v202, v202, v13, v14
    v_fma_f32 v203, v203, v13, v14
    v_mfma_f32_32x32x16_bf16 v[96:111], v[192:195], a[132:135], v[96:111]
    ds_read_b64_tr_b16 a[112:113], v1 offset:10304
    ds_read_b64_tr_b16 a[114:115], v1 offset:10816
    ds_read_b64_tr_b16 a[116:117], v1 offset:11328
    buffer_load_dwordx4 v9, s[8:11], s50 offen offset:1024  lds
    v_fma_f32 v204, v204, v13, v14
    v_fma_f32 v205, v205, v13, v14
    v_mfma_f32_32x32x16_bf16 v[112:127], a[136:139], v[192:195], v[112:127]
    s_waitcnt lgkmcnt(6)
    ds_read_b64_tr_b16 a[118:119], v1 offset:11840
    ds_read_b64_tr_b16 a[120:121], v1 offset:12352
    ds_read_b64_tr_b16 a[122:123], v1 offset:12864
    v_fma_f32 v206, v206, v13, v14
    v_fma_f32 v207, v207, v13, v14
    v_mfma_f32_32x32x16_bf16 v[128:143], a[140:143], v[192:195], v[128:143]
    ds_read_b64_tr_b16 a[124:125], v2 offset:10304
    ds_read_b64_tr_b16 a[126:127], v2 offset:10816
    ds_read_b64_tr_b16 a[128:129], v2 offset:11328
    buffer_load_dwordx4 v10, s[8:11], s50 offen offset:2048  lds
    v_cvt_pk_bf16_f32 v196, v200, v204
    v_cvt_pk_bf16_f32 v197, v201, v205
    v_mfma_f32_32x32x16_bf16 v[144:159], a[144:147], v[192:195], v[144:159]
    ds_read_b64_tr_b16 a[130:131], v2 offset:11840
    ds_read_b64_tr_b16 a[132:133], v2 offset:12352
    v_cvt_pk_bf16_f32 v198, v202, v206
    v_cvt_pk_bf16_f32 v199, v203, v207
    v_mfma_f32_32x32x16_bf16 v[160:175], a[148:151], v[192:195], v[160:175]
    s_waitcnt lgkmcnt(7)
    ds_read_b64_tr_b16 a[134:135], v2 offset:12864
    ds_read_b64_tr_b16 a[136:137], v3 offset:13376
    ds_read_b64_tr_b16 a[138:139], v3 offset:13888
    buffer_load_dwordx4 v11, s[12:15], s51 offen offset:3072  lds
    s_add_u32 m0, s55, 65952
    v_mfma_f32_32x32x16_bf16 v[176:191], a[156:159], a[152:155], v[176:191]
    ds_read_b64_tr_b16 a[140:141], v3 offset:13408
    ds_read_b64_tr_b16 a[142:143], v3 offset:13920
    ds_read_b64_tr_b16 a[144:145], v4 offset:13376
    v_accvgpr_read_b32 v204, a40
    v_accvgpr_read_b32 v205, a41
    v_accvgpr_read_b32 v206, a42
    v_mfma_f32_32x32x16_bf16 v[16:31], a[112:115], v[196:199], v[16:31]
    ds_read_b64_tr_b16 a[146:147], v4 offset:13888
    buffer_load_dwordx4 v12, s[16:19], s51 offen  lds
    v_accvgpr_read_b32 v207, a43
    v_lshlrev_b32 v200, 16, v204
    v_lshlrev_b32 v201, 16, v205
    v_lshlrev_b32 v202, 16, v206
    v_mfma_f32_32x32x16_bf16 v[32:47], a[116:119], v[196:199], v[32:47]
    s_waitcnt lgkmcnt(8)
    ds_read_b64_tr_b16 a[148:149], v4 offset:13408
    ds_read_b64_tr_b16 a[150:151], v4 offset:13920
    v_lshlrev_b32 v203, 16, v207
    v_and_b32 v204, s53, v204
    v_and_b32 v205, s53, v205
    v_mfma_f32_32x32x16_bf16 v[48:63], v[196:199], a[120:123], v[48:63]
    s_add_u32 s52, s52, s99
    ds_read_b64_tr_b16 a[152:153], v5 offset:10304
    ds_read_b64_tr_b16 a[154:155], v5 offset:10816
    ds_read_b128 a[156:159], v6 offset:32
    v_and_b32 v206, s53, v206
    v_and_b32 v207, s53, v207
    v_mfma_f32_32x32x16_bf16 v[64:79], a[124:127], v[196:199], v[64:79]
    s_cmp_ge_u32 s52, 401408
    s_cselect_b32 s52, s96, s52
    s_mul_i32 s50, s52, 3
    s_lshl_b32 s51, s52, 2
    v_fma_f32 v200, v200, v13, v14
    v_fma_f32 v201, v201, v13, v14
    v_mfma_f32_32x32x16_bf16 v[80:95], a[128:131], v[196:199], v[80:95]
    s_waitcnt lgkmcnt(7)
    s_add_u32 m0, s60, 6144
    s_add_u32 s46, s74, 43008
    buffer_load_dwordx4 v15, s[24:27], s46 offen  lds
    v_fma_f32 v202, v202, v13, v14
    v_fma_f32 v203, v203, v13, v14
    v_mfma_f32_32x32x16_bf16 v[96:111], v[196:199], a[132:135], v[96:111]
    s_waitcnt vmcnt(17) lgkmcnt(0)
    s_barrier
    ds_read_b64_tr_b16 a[112:113], v1 offset:20608
    ds_read_b64_tr_b16 a[114:115], v1 offset:21120
    v_fma_f32 v204, v204, v13, v14
    v_fma_f32 v205, v205, v13, v14
    v_mfma_f32_32x32x16_bf16 v[112:127], a[136:139], v[196:199], v[112:127]
    ds_read_b64_tr_b16 a[116:117], v1 offset:21632
    ds_read_b64_tr_b16 a[118:119], v1 offset:22144
    ds_read_b64_tr_b16 a[120:121], v1 offset:22656
    buffer_load_dwordx4 v233, s[24:27], s46 offen offset:1024  lds
    v_fma_f32 v206, v206, v13, v14
    v_fma_f32 v207, v207, v13, v14
    v_mfma_f32_32x32x16_bf16 v[128:143], a[140:143], v[196:199], v[128:143]
    s_add_u32 m0, s55, 0
    ds_read_b64_tr_b16 a[122:123], v1 offset:23168
    ds_read_b64_tr_b16 a[124:125], v2 offset:20608
    ds_read_b64_tr_b16 a[126:127], v2 offset:21120
    v_cvt_pk_bf16_f32 v192, v200, v204
    v_cvt_pk_bf16_f32 v193, v201, v205
    v_mfma_f32_32x32x16_bf16 v[144:159], a[144:147], v[196:199], v[144:159]
    ds_read_b64_tr_b16 a[128:129], v2 offset:21632
    ds_read_b64_tr_b16 a[130:131], v2 offset:22144
    ds_read_b64_tr_b16 a[132:133], v2 offset:22656
    buffer_load_dwordx4 v8, s[8:11], s50 offen offset:0  lds
    v_cvt_pk_bf16_f32 v194, v202, v206
    v_cvt_pk_bf16_f32 v195, v203, v207
    v_mfma_f32_32x32x16_bf16 v[160:175], a[148:151], v[196:199], v[160:175]
    ds_read_b64_tr_b16 a[134:135], v2 offset:23168
    ds_read_b64_tr_b16 a[136:137], v3 offset:23680
    ds_read_b64_tr_b16 a[138:139], v3 offset:24192
    v_mfma_f32_32x32x16_bf16 v[176:191], a[156:159], a[152:155], v[176:191]
    s_waitcnt lgkmcnt(8)
    ds_read_b64_tr_b16 a[140:141], v3 offset:23712
    buffer_load_dwordx4 v9, s[8:11], s50 offen offset:1024  lds
    v_accvgpr_read_b32 v204, a44
    v_accvgpr_read_b32 v205, a45
    v_accvgpr_read_b32 v206, a46
    v_mfma_f32_32x32x16_bf16 v[16:31], a[112:115], v[192:195], v[16:31]
    ds_read_b64_tr_b16 a[142:143], v3 offset:24224
    ds_read_b64_tr_b16 a[144:145], v4 offset:23680
    ds_read_b64_tr_b16 a[146:147], v4 offset:24192
    v_accvgpr_read_b32 v207, a47
    v_lshlrev_b32 v200, 16, v204
    v_lshlrev_b32 v201, 16, v205
    v_mfma_f32_32x32x16_bf16 v[32:47], a[116:119], v[192:195], v[32:47]
    ds_read_b64_tr_b16 a[148:149], v4 offset:23712
    ds_read_b64_tr_b16 a[150:151], v4 offset:24224
    buffer_load_dwordx4 v10, s[8:11], s50 offen offset:2048  lds
    v_lshlrev_b32 v202, 16, v206
    v_lshlrev_b32 v203, 16, v207
    v_and_b32 v204, s53, v204
    v_mfma_f32_32x32x16_bf16 v[48:63], v[192:195], a[120:123], v[48:63]
    s_waitcnt lgkmcnt(8)
    ds_read_b64_tr_b16 a[152:153], v5 offset:20608
    ds_read_b64_tr_b16 a[154:155], v5 offset:21120
    v_and_b32 v205, s53, v205
    v_and_b32 v206, s53, v206
    v_and_b32 v207, s53, v207
    v_mfma_f32_32x32x16_bf16 v[64:79], a[124:127], v[192:195], v[64:79]
    ds_read_b128 a[156:159], v241 offset:0
    ds_read_b64_tr_b16 a[112:113], v1 offset:30912
    ds_read_b64_tr_b16 a[114:115], v1 offset:31424
    buffer_load_dwordx4 v11, s[12:15], s51 offen offset:3072  lds
    v_fma_f32 v200, v200, v13, v14
    v_fma_f32 v201, v201, v13, v14
    v_mfma_f32_32x32x16_bf16 v[80:95], a[128:131], v[192:195], v[80:95]
    s_add_u32 m0, s55, 4128
    ds_read_b64_tr_b16 a[116:117], v1 offset:31936
    v_fma_f32 v202, v202, v13, v14
    v_fma_f32 v203, v203, v13, v14
    v_fma_f32 v204, v204, v13, v14
    v_fma_f32 v205, v205, v13, v14
    v_mfma_f32_32x32x16_bf16 v[96:111], v[192:195], a[132:135], v[96:111]
    s_waitcnt lgkmcnt(8)
    ds_read_b64_tr_b16 a[118:119], v1 offset:32448
    ds_read_b64_tr_b16 a[120:121], v1 offset:32960
    buffer_load_dwordx4 v12, s[16:19], s51 offen  lds
    v_fma_f32 v206, v206, v13, v14
    v_fma_f32 v207, v207, v13, v14
    v_mfma_f32_32x32x16_bf16 v[112:127], a[136:139], v[192:195], v[112:127]
    s_add_u32 s52, s52, s98
    ds_read_b64_tr_b16 a[122:123], v1 offset:33472
    ds_read_b64_tr_b16 a[124:125], v2 offset:30912
    ds_read_b64_tr_b16 a[126:127], v2 offset:31424
    v_cvt_pk_bf16_f32 v196, v200, v204
    v_cvt_pk_bf16_f32 v197, v201, v205
    v_mfma_f32_32x32x16_bf16 v[128:143], a[140:143], v[192:195], v[128:143]
    s_mul_i32 s50, s52, 3
    s_lshl_b32 s51, s52, 2
    s_add_u32 m0, s60, 8192
    ds_read_b64_tr_b16 a[128:129], v2 offset:31936
    v_cvt_pk_bf16_f32 v198, v202, v206
    v_cvt_pk_bf16_f32 v199, v203, v207
    v_mfma_f32_32x32x16_bf16 v[144:159], a[144:147], v[192:195], v[144:159]
    s_waitcnt lgkmcnt(7)
    s_add_u32 s46, s74, 57344
    ds_read_b64_tr_b16 a[130:131], v2 offset:32448
    ds_read_b64_tr_b16 a[132:133], v2 offset:32960
    ds_read_b64_tr_b16 a[134:135], v2 offset:33472
    buffer_load_dwordx4 v15, s[24:27], s46 offen  lds
    v_mfma_f32_32x32x16_bf16 v[160:175], a[148:151], v[192:195], v[160:175]
    ds_read_b64_tr_b16 a[136:137], v3 offset:33984
    ds_read_b64_tr_b16 a[138:139], v3 offset:34496
    v_mfma_f32_32x32x16_bf16 v[176:191], a[156:159], a[152:155], v[176:191]
    ds_read_b64_tr_b16 a[140:141], v3 offset:34016
    ds_read_b64_tr_b16 a[142:143], v3 offset:34528
    buffer_load_dwordx4 v233, s[24:27], s46 offen offset:1024  lds
    v_accvgpr_read_b32 v204, a48
    v_accvgpr_read_b32 v205, a49
    v_accvgpr_read_b32 v206, a50
    v_mfma_f32_32x32x16_bf16 v[16:31], a[112:115], v[196:199], v[16:31]
    s_waitcnt lgkmcnt(8)
    ds_read_b64_tr_b16 a[144:145], v4 offset:33984
    ds_read_b64_tr_b16 a[146:147], v4 offset:34496
    v_accvgpr_read_b32 v207, a51
    v_lshlrev_b32 v200, 16, v204
    v_lshlrev_b32 v201, 16, v205
    v_mfma_f32_32x32x16_bf16 v[32:47], a[116:119], v[196:199], v[32:47]
    ds_read_b64_tr_b16 a[148:149], v4 offset:34016
    ds_read_b64_tr_b16 a[150:151], v4 offset:34528
    ds_read_b64_tr_b16 a[152:153], v5 offset:30912
    v_lshlrev_b32 v202, 16, v206
    v_lshlrev_b32 v203, 16, v207
    v_and_b32 v204, s53, v204
    v_mfma_f32_32x32x16_bf16 v[48:63], v[196:199], a[120:123], v[48:63]
    ds_read_b64_tr_b16 a[154:155], v5 offset:31424
    v_and_b32 v205, s53, v205
    v_and_b32 v206, s53, v206
    v_and_b32 v207, s53, v207
    v_fma_f32 v200, v200, v13, v14
    v_fma_f32 v201, v201, v13, v14
    v_mfma_f32_32x32x16_bf16 v[64:79], a[124:127], v[196:199], v[64:79]
    s_waitcnt lgkmcnt(8)
    ds_read_b128 a[156:159], v241 offset:32
    v_fma_f32 v202, v202, v13, v14
    v_fma_f32 v203, v203, v13, v14
    v_fma_f32 v204, v204, v13, v14
    v_fma_f32 v205, v205, v13, v14
    v_mfma_f32_32x32x16_bf16 v[80:95], a[128:131], v[196:199], v[80:95]
    s_add_u32 m0, s60, 10240
    s_nop 0
    buffer_load_dwordx4 v15, s[24:27], s75 offen  lds
    v_fma_f32 v206, v206, v13, v14
    v_fma_f32 v207, v207, v13, v14
    v_cvt_pk_bf16_f32 v192, v200, v204
    v_mfma_f32_32x32x16_bf16 v[96:111], v[196:199], a[132:135], v[96:111]
    v_cvt_pk_bf16_f32 v193, v201, v205
    v_cvt_pk_bf16_f32 v194, v202, v206
    v_cvt_pk_bf16_f32 v195, v203, v207
    v_mfma_f32_32x32x16_bf16 v[112:127], a[136:139], v[196:199], v[112:127]
    s_waitcnt lgkmcnt(7)
    s_waitcnt vmcnt(21) lgkmcnt(0)
    s_barrier
    s_add_u32 s47, s47, 128
    s_cmp_eq_u32 s47, 896
    s_cselect_b32 s47, 0, s47
    buffer_load_dwordx4 v233, s[24:27], s75 offen offset:1024  lds
    v_add_u32 v6, s47, v7
    v_add_u32 v241, s101, v6
    v_mfma_f32_32x32x16_bf16 v[128:143], a[140:143], v[196:199], v[128:143]
    s_add_u32 m0, s55, 20608
    ds_read_b64_tr_b16 a[112:113], v228 offset:0
    ds_read_b64_tr_b16 a[114:115], v228 offset:512
    ds_read_b64_tr_b16 a[116:117], v228 offset:1024
    v_mfma_f32_32x32x16_bf16 v[144:159], a[144:147], v[196:199], v[144:159]
    ds_read_b64_tr_b16 a[118:119], v228 offset:1536
    ds_read_b64_tr_b16 a[120:121], v228 offset:2048
    ds_read_b64_tr_b16 a[122:123], v228 offset:2560
    buffer_load_dwordx4 v8, s[8:11], s50 offen offset:0  lds
    v_mfma_f32_32x32x16_bf16 v[160:175], a[148:151], v[196:199], v[160:175]
    ds_read_b64_tr_b16 a[124:125], v229 offset:0
    ds_read_b64_tr_b16 a[126:127], v229 offset:512
    ds_read_b64_tr_b16 a[128:129], v229 offset:1024
    v_mfma_f32_32x32x16_bf16 v[176:191], a[156:159], a[152:155], v[176:191]
    s_waitcnt lgkmcnt(7)
    ds_read_b64_tr_b16 a[130:131], v229 offset:1536
    ds_read_b64_tr_b16 a[132:133], v229 offset:2048
    v_accvgpr_read_b32 v204, a52
    v_accvgpr_read_b32 v205, a53
    v_accvgpr_read_b32 v206, a54
    v_mfma_f32_32x32x16_bf16 v[16:31], a[112:115], v[192:195], v[16:31]
    s_waitcnt lgkmcnt(7)
    ds_read_b64_tr_b16 a[134:135], v229 offset:2560
    ds_read_b64_tr_b16 a[136:137], v230 offset:3072
    v_accvgpr_read_b32 v207, a55
    v_lshlrev_b32 v200, 16, v204
    v_lshlrev_b32 v201, 16, v205
    v_mfma_f32_32x32x16_bf16 v[32:47], a[116:119], v[192:195], v[32:47]
    s_waitcnt lgkmcnt(7)
    ds_read_b64_tr_b16 a[138:139], v230 offset:3584
    ds_read_b64_tr_b16 a[140:141], v230 offset:3104
    v_lshlrev_b32 v202, 16, v206
    v_lshlrev_b32 v203, 16, v207
    v_and_b32 v204, s53, v204
    v_mfma_f32_32x32x16_bf16 v[48:63], v[192:195], a[120:123], v[48:63]
    s_waitcnt lgkmcnt(7)
    ds_read_b64_tr_b16 a[142:143], v230 offset:3616
    ds_read_b64_tr_b16 a[144:145], v231 offset:3072
    v_and_b32 v205, s53, v205
    v_and_b32 v206, s53, v206
    v_and_b32 v207, s53, v207
    v_mfma_f32_32x32x16_bf16 v[64:79], a[124:127], v[192:195], v[64:79]
    s_waitcnt lgkmcnt(7)
    ds_read_b64_tr_b16 a[146:147], v231 offset:3584
    ds_read_b64_tr_b16 a[148:149], v231 offset:3104
    ds_read_b64_tr_b16 a[150:151], v231 offset:3616
    v_fma_f32 v200, v200, v13, v14
    v_fma_f32 v201, v201, v13, v14
    v_mfma_f32_32x32x16_bf16 v[80:95], a[128:131], v[192:195], v[80:95]
    s_waitcnt lgkmcnt(6)
    ds_read_b64_tr_b16 a[152:153], v232 offset:0
    ds_read_b64_tr_b16 a[154:155], v232 offset:512
    ds_read_b128 a[156:159], v6 offset:0
    v_fma_f32 v202, v202, v13, v14
    v_fma_f32 v203, v203, v13, v14
    v_mfma_f32_32x32x16_bf16 v[96:111], v[192:195], a[132:135], v[96:111]
    ds_read_b64_tr_b16 a[112:113], v228 offset:10304
    ds_read_b64_tr_b16 a[114:115], v228 offset:10816
    ds_read_b64_tr_b16 a[116:117], v228 offset:11328
    buffer_load_dwordx4 v9, s[8:11], s50 offen offset:1024  lds
    v_fma_f32 v204, v204, v13, v14
    v_fma_f32 v205, v205, v13, v14
    v_mfma_f32_32x32x16_bf16 v[112:127], a[136:139], v[192:195], v[112:127]
    s_waitcnt lgkmcnt(6)
    ds_read_b64_tr_b16 a[118:119], v228 offset:11840
    ds_read_b64_tr_b16 a[120:121], v228 offset:12352
    ds_read_b64_tr_b16 a[122:123], v228 offset:12864
    v_fma_f32 v206, v206, v13, v14
    v_fma_f32 v207, v207, v13, v14
    v_mfma_f32_32x32x16_bf16 v[128:143], a[140:143], v[192:195], v[128:143]
    ds_read_b64_tr_b16 a[124:125], v229 offset:10304
    ds_read_b64_tr_b16 a[126:127], v229 offset:10816
    ds_read_b64_tr_b16 a[128:129], v229 offset:11328
    buffer_load_dwordx4 v10, s[8:11], s50 offen offset:2048  lds
    v_cvt_pk_bf16_f32 v196, v200, v204
    v_cvt_pk_bf16_f32 v197, v201, v205
    v_mfma_f32_32x32x16_bf16 v[144:159], a[144:147], v[192:195], v[144:159]
    ds_read_b64_tr_b16 a[130:131], v229 offset:11840
    ds_read_b64_tr_b16 a[132:133], v229 offset:12352
    v_cvt_pk_bf16_f32 v198, v202, v206
    v_cvt_pk_bf16_f32 v199, v203, v207
    v_mfma_f32_32x32x16_bf16 v[160:175], a[148:151], v[192:195], v[160:175]
    s_waitcnt lgkmcnt(7)
    ds_read_b64_tr_b16 a[134:135], v229 offset:12864
    ds_read_b64_tr_b16 a[136:137], v230 offset:13376
    ds_read_b64_tr_b16 a[138:139], v230 offset:13888
    buffer_load_dwordx4 v11, s[12:15], s51 offen offset:3072  lds
    s_add_u32 m0, s55, 24736
    v_mfma_f32_32x32x16_bf16 v[176:191], a[156:159], a[152:155], v[176:191]
    ds_read_b64_tr_b16 a[140:141], v230 offset:13408
    ds_read_b64_tr_b16 a[142:143], v230 offset:13920
    ds_read_b64_tr_b16 a[144:145], v231 offset:13376
    v_accvgpr_read_b32 v204, a56
    v_accvgpr_read_b32 v205, a57
    v_accvgpr_read_b32 v206, a58
    v_mfma_f32_32x32x16_bf16 v[16:31], a[112:115], v[196:199], v[16:31]
    ds_read_b64_tr_b16 a[146:147], v231 offset:13888
    buffer_load_dwordx4 v12, s[16:19], s51 offen  lds
    v_accvgpr_read_b32 v207, a59
    v_lshlrev_b32 v200, 16, v204
    v_lshlrev_b32 v201, 16, v205
    v_lshlrev_b32 v202, 16, v206
    v_mfma_f32_32x32x16_bf16 v[32:47], a[116:119], v[196:199], v[32:47]
    s_waitcnt lgkmcnt(8)
    ds_read_b64_tr_b16 a[148:149], v231 offset:13408
    ds_read_b64_tr_b16 a[150:151], v231 offset:13920
    v_lshlrev_b32 v203, 16, v207
    v_and_b32 v204, s53, v204
    v_and_b32 v205, s53, v205
    v_mfma_f32_32x32x16_bf16 v[48:63], v[196:199], a[120:123], v[48:63]
    s_add_u32 s52, s52, s99
    ds_read_b64_tr_b16 a[152:153], v232 offset:10304
    ds_read_b64_tr_b16 a[154:155], v232 offset:10816
    ds_read_b128 a[156:159], v6 offset:32
    v_and_b32 v206, s53, v206
    v_and_b32 v207, s53, v207
    v_mfma_f32_32x32x16_bf16 v[64:79], a[124:127], v[196:199], v[64:79]
    s_cmp_ge_u32 s52, 401408
    s_cselect_b32 s52, s96, s52
    s_mul_i32 s50, s52, 3
    s_lshl_b32 s51, s52, 2
    v_fma_f32 v200, v200, v13, v14
    v_fma_f32 v201, v201, v13, v14
    v_mfma_f32_32x32x16_bf16 v[80:95], a[128:131], v[196:199], v[80:95]
    s_waitcnt lgkmcnt(7)
    s_add_u32 m0, s60, 12288
    s_add_u32 s46, s75, 14336
    buffer_load_dwordx4 v15, s[24:27], s46 offen  lds
    v_fma_f32 v202, v202, v13, v14
    v_fma_f32 v203, v203, v13, v14
    v_mfma_f32_32x32x16_bf16 v[96:111], v[196:199], a[132:135], v[96:111]
    s_waitcnt vmcnt(17) lgkmcnt(0)
    s_barrier
    ds_read_b64_tr_b16 a[112:113], v228 offset:20608
    ds_read_b64_tr_b16 a[114:115], v228 offset:21120
    v_fma_f32 v204, v204, v13, v14
    v_fma_f32 v205, v205, v13, v14
    v_mfma_f32_32x32x16_bf16 v[112:127], a[136:139], v[196:199], v[112:127]
    ds_read_b64_tr_b16 a[116:117], v228 offset:21632
    ds_read_b64_tr_b16 a[118:119], v228 offset:22144
    ds_read_b64_tr_b16 a[120:121], v228 offset:22656
    buffer_load_dwordx4 v233, s[24:27], s46 offen offset:1024  lds
    v_fma_f32 v206, v206, v13, v14
    v_fma_f32 v207, v207, v13, v14
    v_mfma_f32_32x32x16_bf16 v[128:143], a[140:143], v[196:199], v[128:143]
    s_add_u32 m0, s55, 41216
    ds_read_b64_tr_b16 a[122:123], v228 offset:23168
    ds_read_b64_tr_b16 a[124:125], v229 offset:20608
    ds_read_b64_tr_b16 a[126:127], v229 offset:21120
    v_cvt_pk_bf16_f32 v192, v200, v204
    v_cvt_pk_bf16_f32 v193, v201, v205
    v_mfma_f32_32x32x16_bf16 v[144:159], a[144:147], v[196:199], v[144:159]
    ds_read_b64_tr_b16 a[128:129], v229 offset:21632
    ds_read_b64_tr_b16 a[130:131], v229 offset:22144
    ds_read_b64_tr_b16 a[132:133], v229 offset:22656
    buffer_load_dwordx4 v8, s[8:11], s50 offen offset:0  lds
    v_cvt_pk_bf16_f32 v194, v202, v206
    v_cvt_pk_bf16_f32 v195, v203, v207
    v_mfma_f32_32x32x16_bf16 v[160:175], a[148:151], v[196:199], v[160:175]
    ds_read_b64_tr_b16 a[134:135], v229 offset:23168
    ds_read_b64_tr_b16 a[136:137], v230 offset:23680
    ds_read_b64_tr_b16 a[138:139], v230 offset:24192
    v_mfma_f32_32x32x16_bf16 v[176:191], a[156:159], a[152:155], v[176:191]
    s_waitcnt lgkmcnt(8)
    ds_read_b64_tr_b16 a[140:141], v230 offset:23712
    buffer_load_dwordx4 v9, s[8:11], s50 offen offset:1024  lds
    v_accvgpr_read_b32 v204, a60
    v_accvgpr_read_b32 v205, a61
    v_accvgpr_read_b32 v206, a62
    v_mfma_f32_32x32x16_bf16 v[16:31], a[112:115], v[192:195], v[16:31]
    ds_read_b64_tr_b16 a[142:143], v230 offset:24224
    ds_read_b64_tr_b16 a[144:145], v231 offset:23680
    ds_read_b64_tr_b16 a[146:147], v231 offset:24192
    v_accvgpr_read_b32 v207, a63
    v_lshlrev_b32 v200, 16, v204
    v_lshlrev_b32 v201, 16, v205
    v_mfma_f32_32x32x16_bf16 v[32:47], a[116:119], v[192:195], v[32:47]
    ds_read_b64_tr_b16 a[148:149], v231 offset:23712
    ds_read_b64_tr_b16 a[150:151], v231 offset:24224
    buffer_load_dwordx4 v10, s[8:11], s50 offen offset:2048  lds
    v_lshlrev_b32 v202, 16, v206
    v_lshlrev_b32 v203, 16, v207
    v_and_b32 v204, s53, v204
    v_mfma_f32_32x32x16_bf16 v[48:63], v[192:195], a[120:123], v[48:63]
    s_waitcnt lgkmcnt(8)
    ds_read_b64_tr_b16 a[152:153], v232 offset:20608
    ds_read_b64_tr_b16 a[154:155], v232 offset:21120
    v_and_b32 v205, s53, v205
    v_and_b32 v206, s53, v206
    v_and_b32 v207, s53, v207
    v_mfma_f32_32x32x16_bf16 v[64:79], a[124:127], v[192:195], v[64:79]
    ds_read_b128 a[156:159], v241 offset:0
    ds_read_b64_tr_b16 a[112:113], v228 offset:30912
    ds_read_b64_tr_b16 a[114:115], v228 offset:31424
    buffer_load_dwordx4 v11, s[12:15], s51 offen offset:3072  lds
    v_fma_f32 v200, v200, v13, v14
    v_fma_f32 v201, v201, v13, v14
    v_mfma_f32_32x32x16_bf16 v[80:95], a[128:131], v[192:195], v[80:95]
    s_add_u32 m0, s55, 45344
    ds_read_b64_tr_b16 a[116:117], v228 offset:31936
    v_fma_f32 v202, v202, v13, v14
    v_fma_f32 v203, v203, v13, v14
    v_fma_f32 v204, v204, v13, v14
    v_fma_f32 v205, v205, v13, v14
    v_mfma_f32_32x32x16_bf16 v[96:111], v[192:195], a[132:135], v[96:111]
    s_waitcnt lgkmcnt(8)
    ds_read_b64_tr_b16 a[118:119], v228 offset:32448
    ds_read_b64_tr_b16 a[120:121], v228 offset:32960
    buffer_load_dwordx4 v12, s[16:19], s51 offen  lds
    v_fma_f32 v206, v206, v13, v14
    v_fma_f32 v207, v207, v13, v14
    v_mfma_f32_32x32x16_bf16 v[112:127], a[136:139], v[192:195], v[112:127]
    s_add_u32 s52, s52, s98
    ds_read_b64_tr_b16 a[122:123], v228 offset:33472
    ds_read_b64_tr_b16 a[124:125], v229 offset:30912
    ds_read_b64_tr_b16 a[126:127], v229 offset:31424
    v_cvt_pk_bf16_f32 v196, v200, v204
    v_cvt_pk_bf16_f32 v197, v201, v205
    v_mfma_f32_32x32x16_bf16 v[128:143], a[140:143], v[192:195], v[128:143]
    s_mul_i32 s50, s52, 3
    s_lshl_b32 s51, s52, 2
    s_add_u32 m0, s60, 14336
    ds_read_b64_tr_b16 a[128:129], v229 offset:31936
    v_cvt_pk_bf16_f32 v198, v202, v206
    v_cvt_pk_bf16_f32 v199, v203, v207
    v_mfma_f32_32x32x16_bf16 v[144:159], a[144:147], v[192:195], v[144:159]
    s_waitcnt lgkmcnt(7)
    s_add_u32 s46, s75, 28672
    ds_read_b64_tr_b16 a[130:131], v229 offset:32448
    ds_read_b64_tr_b16 a[132:133], v229 offset:32960
    ds_read_b64_tr_b16 a[134:135], v229 offset:33472
    buffer_load_dwordx4 v15, s[24:27], s46 offen  lds
    v_mfma_f32_32x32x16_bf16 v[160:175], a[148:151], v[192:195], v[160:175]
    ds_read_b64_tr_b16 a[136:137], v230 offset:33984
    ds_read_b64_tr_b16 a[138:139], v230 offset:34496
    v_mfma_f32_32x32x16_bf16 v[176:191], a[156:159], a[152:155], v[176:191]
    ds_read_b64_tr_b16 a[140:141], v230 offset:34016
    ds_read_b64_tr_b16 a[142:143], v230 offset:34528
    buffer_load_dwordx4 v233, s[24:27], s46 offen offset:1024  lds
    v_accvgpr_read_b32 v204, a64
    v_accvgpr_read_b32 v205, a65
    v_accvgpr_read_b32 v206, a66
    v_mfma_f32_32x32x16_bf16 v[16:31], a[112:115], v[196:199], v[16:31]
    s_waitcnt lgkmcnt(8)
    ds_read_b64_tr_b16 a[144:145], v231 offset:33984
    ds_read_b64_tr_b16 a[146:147], v231 offset:34496
    v_accvgpr_read_b32 v207, a67
    v_lshlrev_b32 v200, 16, v204
    v_lshlrev_b32 v201, 16, v205
    v_mfma_f32_32x32x16_bf16 v[32:47], a[116:119], v[196:199], v[32:47]
    ds_read_b64_tr_b16 a[148:149], v231 offset:34016
    ds_read_b64_tr_b16 a[150:151], v231 offset:34528
    ds_read_b64_tr_b16 a[152:153], v232 offset:30912
    v_lshlrev_b32 v202, 16, v206
    v_lshlrev_b32 v203, 16, v207
    v_and_b32 v204, s53, v204
    v_mfma_f32_32x32x16_bf16 v[48:63], v[196:199], a[120:123], v[48:63]
    ds_read_b64_tr_b16 a[154:155], v232 offset:31424
    v_and_b32 v205, s53, v205
    v_and_b32 v206, s53, v206
    v_and_b32 v207, s53, v207
    v_fma_f32 v200, v200, v13, v14
    v_fma_f32 v201, v201, v13, v14
    v_mfma_f32_32x32x16_bf16 v[64:79], a[124:127], v[196:199], v[64:79]
    s_waitcnt lgkmcnt(8)
    ds_read_b128 a[156:159], v241 offset:32
    ds_read_b64_tr_b16 a[160:161], v244 offset:0
    ds_read_b64_tr_b16 a[162:163], v244 offset:1024
    v_fma_f32 v202, v202, v13, v14
    v_fma_f32 v203, v203, v13, v14
    v_mfma_f32_32x32x16_bf16 v[80:95], a[128:131], v[196:199], v[80:95]
    ds_read_b64_tr_b16 a[164:165], v245 offset:0
    ds_read_b64_tr_b16 a[166:167], v245 offset:1024
    v_fma_f32 v204, v204, v13, v14
    v_fma_f32 v205, v205, v13, v14
    v_fma_f32 v206, v206, v13, v14
    v_fma_f32 v207, v207, v13, v14
    v_mfma_f32_32x32x16_bf16 v[96:111], v[196:199], a[132:135], v[96:111]
    v_cvt_pk_bf16_f32 v192, v200, v204
    v_cvt_pk_bf16_f32 v193, v201, v205
    v_cvt_pk_bf16_f32 v194, v202, v206
    v_cvt_pk_bf16_f32 v195, v203, v207
    v_mfma_f32_32x32x16_bf16 v[112:127], a[136:139], v[196:199], v[112:127]
    s_waitcnt lgkmcnt(7)
    s_waitcnt vmcnt(18) lgkmcnt(0)
    s_barrier
    s_add_u32 s47, s47, 128
    s_cmp_eq_u32 s47, 896
    s_cselect_b32 s47, 0, s47
    v_add_u32 v6, s47, v7
    v_add_u32 v241, s101, v6
    v_mfma_f32_32x32x16_bf16 v[128:143], a[140:143], v[196:199], v[128:143]
    s_mov_b32 s57, 28672
    ds_read_b64_tr_b16 a[112:113], v1 offset:0
    ds_read_b64_tr_b16 a[114:115], v1 offset:512
    ds_read_b64_tr_b16 a[116:117], v1 offset:1024
    buffer_load_dwordx4 a[48:51], v249, s[4:7], 0 offen
    v_mfma_f32_32x32x16_bf16 v[144:159], a[144:147], v[196:199], v[144:159]
    ds_read_b64_tr_b16 a[118:119], v1 offset:1536
    ds_read_b64_tr_b16 a[120:121], v1 offset:2048
    ds_read_b64_tr_b16 a[122:123], v1 offset:2560
    v_mfma_f32_32x32x16_bf16 v[160:175], a[148:151], v[196:199], v[160:175]
    ds_read_b64_tr_b16 a[124:125], v2 offset:0
    ds_read_b64_tr_b16 a[126:127], v2 offset:512
    ds_read_b64_tr_b16 a[128:129], v2 offset:1024
    buffer_load_dwordx4 a[52:55], v249, s[4:7], s57 offen
    s_add_u32 m0, s55, 61824
    v_mfma_f32_32x32x16_bf16 v[176:191], a[156:159], a[152:155], v[176:191]
    s_waitcnt lgkmcnt(7)
    ds_read_b64_tr_b16 a[130:131], v2 offset:1536
    ds_read_b64_tr_b16 a[132:133], v2 offset:2048
    v_accvgpr_read_b32 v204, a68
    v_accvgpr_read_b32 v205, a69
    v_accvgpr_read_b32 v206, a70
    v_mfma_f32_32x32x16_bf16 v[16:31], a[112:115], v[192:195], v[16:31]
    s_waitcnt lgkmcnt(7)
    ds_read_b64_tr_b16 a[134:135], v2 offset:2560
    ds_read_b64_tr_b16 a[136:137], v3 offset:3072
    buffer_load_dwordx4 v8, s[8:11], s50 offen offset:0  lds
    v_accvgpr_read_b32 v207, a71
    v_lshlrev_b32 v200, 16, v204
    v_lshlrev_b32 v201, 16, v205
    v_mfma_f32_32x32x16_bf16 v[32:47], a[116:119], v[192:195], v[32:47]
    s_waitcnt lgkmcnt(7)
    ds_read_b64_tr_b16 a[138:139], v3 offset:3584
    ds_read_b64_tr_b16 a[140:141], v3 offset:3104
    v_lshlrev_b32 v202, 16, v206
    v_lshlrev_b32 v203, 16, v207
    v_and_b32 v204, s53, v204
    v_mfma_f32_32x32x16_bf16 v[48:63], v[192:195], a[120:123], v[48:63]
    s_waitcnt lgkmcnt(7)
    ds_read_b64_tr_b16 a[142:143], v3 offset:3616
    ds_read_b64_tr_b16 a[144:145], v4 offset:3072
    buffer_load_dwordx4 v9, s[8:11], s50 offen offset:1024  lds
    v_and_b32 v205, s53, v205
    v_and_b32 v206, s53, v206
    v_and_b32 v207, s53, v207
    v_mfma_f32_32x32x16_bf16 v[64:79], a[124:127], v[192:195], v[64:79]
    s_waitcnt lgkmcnt(7)
    ds_read_b64_tr_b16 a[146:147], v4 offset:3584
    ds_read_b64_tr_b16 a[148:149], v4 offset:3104
    ds_read_b64_tr_b16 a[150:151], v4 offset:3616
    v_fma_f32 v200, v200, v13, v14
    v_fma_f32 v201, v201, v13, v14
    v_mfma_f32_32x32x16_bf16 v[80:95], a[128:131], v[192:195], v[80:95]
    s_waitcnt lgkmcnt(6)
    ds_read_b64_tr_b16 a[152:153], v5 offset:0
    ds_read_b64_tr_b16 a[154:155], v5 offset:512
    ds_read_b128 a[156:159], v6 offset:0
    buffer_load_dwordx4 v10, s[8:11], s50 offen offset:2048  lds
    v_fma_f32 v202, v202, v13, v14
    v_fma_f32 v203, v203, v13, v14
    v_mfma_f32_32x32x16_bf16 v[96:111], v[192:195], a[132:135], v[96:111]
    ds_read_b64_tr_b16 a[112:113], v1 offset:10304
    ds_read_b64_tr_b16 a[114:115], v1 offset:10816
    ds_read_b64_tr_b16 a[116:117], v1 offset:11328
    v_fma_f32 v204, v204, v13, v14
    v_fma_f32 v205, v205, v13, v14
    v_fma_f32 v206, v206, v13, v14
    v_mfma_f32_32x32x16_bf16 v[112:127], a[136:139], v[192:195], v[112:127]
    s_waitcnt lgkmcnt(6)
    ds_read_b64_tr_b16 a[118:119], v1 offset:11840
    ds_read_b64_tr_b16 a[120:121], v1 offset:12352
    ds_read_b64_tr_b16 a[122:123], v1 offset:12864
    buffer_load_dwordx4 v11, s[12:15], s51 offen offset:3072  lds
    v_fma_f32 v207, v207, v13, v14
    v_cvt_pk_bf16_f32 v196, v200, v204
    v_mfma_f32_32x32x16_bf16 v[128:143], a[140:143], v[192:195], v[128:143]
    s_add_u32 m0, s55, 65952
    ds_read_b64_tr_b16 a[124:125], v2 offset:10304
    ds_read_b64_tr_b16 a[126:127], v2 offset:10816
    ds_read_b64_tr_b16 a[128:129], v2 offset:11328
    v_cvt_pk_bf16_f32 v197, v201, v205
    v_cvt_pk_bf16_f32 v198, v202, v206
    v_mfma_f32_32x32x16_bf16 v[144:159], a[144:147], v[192:195], v[144:159]
    ds_read_b64_tr_b16 a[130:131], v2 offset:11840
    ds_read_b64_tr_b16 a[132:133], v2 offset:12352
    buffer_load_dwordx4 v12, s[16:19], s51 offen  lds
    v_cvt_pk_bf16_f32 v199, v203, v207
    s_add_u32 s52, s52, s99
    s_cmp_ge_u32 s52, 401408
    s_cselect_b32 s52, s96, s52
    v_mfma_f32_32x32x16_bf16 v[160:175], a[148:151], v[192:195], v[160:175]
    s_waitcnt lgkmcnt(7)
    s_mul_i32 s50, s52, 3
    s_lshl_b32 s51, s52, 2
    ds_read_b64_tr_b16 a[134:135], v2 offset:12864
    ds_read_b64_tr_b16 a[136:137], v3 offset:13376
    ds_read_b64_tr_b16 a[138:139], v3 offset:13888
    v_mfma_f32_32x32x16_bf16 v[176:191], a[156:159], a[152:155], v[176:191]
    ds_read_b64_tr_b16 a[140:141], v3 offset:13408
    ds_read_b64_tr_b16 a[142:143], v3 offset:13920
    ds_read_b64_tr_b16 a[144:145], v4 offset:13376
    v_accvgpr_read_b32 v204, a72
    v_accvgpr_read_b32 v205, a73
    v_accvgpr_read_b32 v206, a74
    v_mfma_f32_32x32x16_bf16 v[16:31], a[112:115], v[196:199], v[16:31]
    ds_read_b64_tr_b16 a[146:147], v4 offset:13888
    v_accvgpr_read_b32 v207, a75
    v_lshlrev_b32 v200, 16, v204
    v_lshlrev_b32 v201, 16, v205
    v_lshlrev_b32 v202, 16, v206
    v_lshlrev_b32 v203, 16, v207
    v_mfma_f32_32x32x16_bf16 v[32:47], a[116:119], v[196:199], v[32:47]
    s_waitcnt lgkmcnt(8)
    ds_read_b64_tr_b16 a[148:149], v4 offset:13408
    ds_read_b64_tr_b16 a[150:151], v4 offset:13920
    ds_read_b64_tr_b16 a[152:153], v5 offset:10304
    v_and_b32 v204, s53, v204
    v_and_b32 v205, s53, v205
    v_mfma_f32_32x32x16_bf16 v[48:63], v[196:199], a[120:123], v[48:63]
    s_add_u32 m0, s60, 0
    ds_read_b64_tr_b16 a[154:155], v5 offset:10816
    ds_read_b128 a[156:159], v6 offset:32
    v_and_b32 v206, s53, v206
    v_and_b32 v207, s53, v207
    v_fma_f32 v200, v200, v13, v14
    v_mfma_f32_32x32x16_bf16 v[64:79], a[124:127], v[196:199], v[64:79]
    s_add_u32 s46, s75, 43008
    buffer_load_dwordx4 v15, s[24:27], s46 offen  lds
    v_fma_f32 v201, v201, v13, v14
    v_fma_f32 v202, v202, v13, v14
    v_fma_f32 v203, v203, v13, v14
    v_fma_f32 v204, v204, v13, v14
    v_mfma_f32_32x32x16_bf16 v[80:95], a[128:131], v[196:199], v[80:95]
    s_waitcnt lgkmcnt(7)
    v_fma_f32 v205, v205, v13, v14
    v_fma_f32 v206, v206, v13, v14
    v_fma_f32 v207, v207, v13, v14
    v_cvt_pk_bf16_f32 v192, v200, v204
    v_cvt_pk_bf16_f32 v193, v201, v205
    v_mfma_f32_32x32x16_bf16 v[96:111], v[196:199], a[132:135], v[96:111]
    s_waitcnt vmcnt(17) lgkmcnt(0)
    s_barrier
    ds_read_b64_tr_b16 a[112:113], v1 offset:20608
    ds_read_b64_tr_b16 a[114:115], v1 offset:21120
    ds_read_b64_tr_b16 a[116:117], v1 offset:21632
    buffer_load_dwordx4 v233, s[24:27], s46 offen offset:1024  lds
    v_cvt_pk_bf16_f32 v194, v202, v206
    v_mfma_f32_32x32x16_bf16 v[112:127], a[136:139], v[196:199], v[112:127]
    s_add_u32 m0, s55, 0
    ds_read_b64_tr_b16 a[118:119], v1 offset:22144
    ds_read_b64_tr_b16 a[120:121], v1 offset:22656
    ds_read_b64_tr_b16 a[122:123], v1 offset:23168
    v_cvt_pk_bf16_f32 v195, v203, v207
    v_mfma_f32_32x32x16_bf16 v[128:143], a[140:143], v[196:199], v[128:143]
    ds_read_b64_tr_b16 a[124:125], v2 offset:20608
    ds_read_b64_tr_b16 a[126:127], v2 offset:21120
    ds_read_b64_tr_b16 a[128:129], v2 offset:21632
    buffer_load_dwordx4 v8, s[8:11], s50 offen offset:0  lds
    v_mfma_f32_32x32x16_bf16 v[144:159], a[144:147], v[196:199], v[144:159]
    ds_read_b64_tr_b16 a[130:131], v2 offset:22144
    ds_read_b64_tr_b16 a[132:133], v2 offset:22656
    ds_read_b64_tr_b16 a[134:135], v2 offset:23168
    v_mfma_f32_32x32x16_bf16 v[160:175], a[148:151], v[196:199], v[160:175]
    ds_read_b64_tr_b16 a[136:137], v3 offset:23680
    ds_read_b64_tr_b16 a[138:139], v3 offset:24192
    buffer_load_dwordx4 v9, s[8:11], s50 offen offset:1024  lds
    v_mfma_f32_32x32x16_bf16 v[176:191], a[156:159], a[152:155], v[176:191]
    s_waitcnt lgkmcnt(8)
    ds_read_b64_tr_b16 a[140:141], v3 offset:23712
    ds_read_b64_tr_b16 a[142:143], v3 offset:24224
    v_accvgpr_read_b32 v204, a76
    v_accvgpr_read_b32 v205, a77
    v_accvgpr_read_b32 v206, a78
    v_mfma_f32_32x32x16_bf16 v[16:31], a[112:115], v[192:195], v[16:31]
    ds_read_b64_tr_b16 a[144:145], v4 offset:23680
    ds_read_b64_tr_b16 a[146:147], v4 offset:24192
    buffer_load_dwordx4 v10, s[8:11], s50 offen offset:2048  lds
    v_accvgpr_read_b32 v207, a79
    v_lshlrev_b32 v200, 16, v204
    v_lshlrev_b32 v201, 16, v205
    v_mfma_f32_32x32x16_bf16 v[32:47], a[116:119], v[192:195], v[32:47]
    ds_read_b64_tr_b16 a[148:149], v4 offset:23712
    ds_read_b64_tr_b16 a[150:151], v4 offset:24224
    v_lshlrev_b32 v202, 16, v206
    v_lshlrev_b32 v203, 16, v207
    v_and_b32 v204, s53, v204
    v_and_b32 v205, s53, v205
    v_mfma_f32_32x32x16_bf16 v[48:63], v[192:195], a[120:123], v[48:63]
    s_waitcnt lgkmcnt(8)
    ds_read_b64_tr_b16 a[152:153], v5 offset:20608
    ds_read_b64_tr_b16 a[154:155], v5 offset:21120
    buffer_load_dwordx4 v11, s[12:15], s51 offen offset:3072  lds
    v_and_b32 v206, s53, v206
    v_and_b32 v207, s53, v207
    v_mfma_f32_32x32x16_bf16 v[64:79], a[124:127], v[192:195], v[64:79]
    s_add_u32 m0, s55, 4128
    ds_read_b128 a[156:159], v241 offset:0
    ds_read_b64_tr_b16 a[112:113], v1 offset:30912
    ds_read_b64_tr_b16 a[114:115], v1 offset:31424
    v_fma_f32 v200, v200, v13, v14
    v_fma_f32 v201, v201, v13, v14
    v_mfma_f32_32x32x16_bf16 v[80:95], a[128:131], v[192:195], v[80:95]
    ds_read_b64_tr_b16 a[116:117], v1 offset:31936
    buffer_load_dwordx4 v12, s[16:19], s51 offen  lds
    v_fma_f32 v202, v202, v13, v14
    v_fma_f32 v203, v203, v13, v14
    v_fma_f32 v204, v204, v13, v14
    v_fma_f32 v205, v205, v13, v14
    v_mfma_f32_32x32x16_bf16 v[96:111], v[192:195], a[132:135], v[96:111]
    s_waitcnt lgkmcnt(8)
    ds_read_b64_tr_b16 a[118:119], v1 offset:32448
    ds_read_b64_tr_b16 a[120:121], v1 offset:32960
    ds_read_b64_tr_b16 a[122:123], v1 offset:33472
    v_fma_f32 v206, v206, v13, v14
    v_fma_f32 v207, v207, v13, v14
    v_mfma_f32_32x32x16_bf16 v[112:127], a[136:139], v[192:195], v[112:127]
    s_add_u32 s52, s52, s98
    s_mul_i32 s50, s52, 3
    ds_read_b64_tr_b16 a[124:125], v2 offset:30912
    ds_read_b64_tr_b16 a[126:127], v2 offset:31424
    v_cvt_pk_bf16_f32 v196, v200, v204
    v_cvt_pk_bf16_f32 v197, v201, v205
    v_mfma_f32_32x32x16_bf16 v[128:143], a[140:143], v[192:195], v[128:143]
    s_lshl_b32 s51, s52, 2
    ds_read_b64_tr_b16 a[128:129], v2 offset:31936
    v_cvt_pk_bf16_f32 v198, v202, v206
    v_cvt_pk_bf16_f32 v199, v203, v207
    v_mfma_f32_32x32x16_bf16 v[144:159], a[144:147], v[192:195], v[144:159]
    s_waitcnt lgkmcnt(7)
    ds_read_b64_tr_b16 a[130:131], v2 offset:32448
    ds_read_b64_tr_b16 a[132:133], v2 offset:32960
    ds_read_b64_tr_b16 a[134:135], v2 offset:33472
    v_mfma_f32_32x32x16_bf16 v[160:175], a[148:151], v[192:195], v[160:175]
    ds_read_b64_tr_b16 a[136:137], v3 offset:33984
    ds_read_b64_tr_b16 a[138:139], v3 offset:34496
    ds_read_b64_tr_b16 a[168:169], v244 offset:2048
    v_mfma_f32_32x32x16_bf16 v[176:191], a[156:159], a[152:155], v[176:191]
    ds_read_b64_tr_b16 a[140:141], v3 offset:34016
    v_accvgpr_read_b32 v204, a80
    v_accvgpr_read_b32 v205, a81
    v_accvgpr_read_b32 v206, a82
    v_accvgpr_read_b32 v207, a83
    v_lshlrev_b32 v200, 16, v204
    v_mfma_f32_32x32x16_bf16 v[16:31], a[112:115], v[196:199], v[16:31]
    s_waitcnt lgkmcnt(8)
    ds_read_b64_tr_b16 a[142:143], v3 offset:34528
    ds_read_b64_tr_b16 a[144:145], v4 offset:33984
    v_lshlrev_b32 v201, 16, v205
    v_lshlrev_b32 v202, 16, v206
    v_lshlrev_b32 v203, 16, v207
    v_mfma_f32_32x32x16_bf16 v[32:47], a[116:119], v[196:199], v[32:47]
    ds_read_b64_tr_b16 a[146:147], v4 offset:34496
    ds_read_b64_tr_b16 a[148:149], v4 offset:34016
    ds_read_b64_tr_b16 a[150:151], v4 offset:34528
    v_and_b32 v204, s53, v204
    v_and_b32 v205, s53, v205
    v_and_b32 v206, s53, v206
    v_mfma_f32_32x32x16_bf16 v[48:63], v[196:199], a[120:123], v[48:63]
    ds_read_b64_tr_b16 a[152:153], v5 offset:30912
    v_and_b32 v207, s53, v207
    v_fma_f32 v200, v200, v13, v14
    v_fma_f32 v201, v201, v13, v14
    v_fma_f32 v202, v202, v13, v14
    v_fma_f32 v203, v203, v13, v14
    v_mfma_f32_32x32x16_bf16 v[64:79], a[124:127], v[196:199], v[64:79]
    s_waitcnt lgkmcnt(8)
    ds_read_b64_tr_b16 a[154:155], v5 offset:31424
    ds_read_b128 a[156:159], v241 offset:32
    ds_read_b64_tr_b16 a[170:171], v244 offset:3072
    v_fma_f32 v204, v204, v13, v14
    v_fma_f32 v205, v205, v13, v14
    v_mfma_f32_32x32x16_bf16 v[80:95], a[128:131], v[196:199], v[80:95]
    ds_read_b64_tr_b16 a[172:173], v245 offset:2048
    ds_read_b64_tr_b16 a[174:175], v245 offset:3072
    v_fma_f32 v206, v206, v13, v14
    v_fma_f32 v207, v207, v13, v14
    v_cvt_pk_bf16_f32 v192, v200, v204
    v_cvt_pk_bf16_f32 v193, v201, v205
    v_mfma_f32_32x32x16_bf16 v[96:111], v[196:199], a[132:135], v[96:111]
    v_cvt_pk_bf16_f32 v194, v202, v206
    v_cvt_pk_bf16_f32 v195, v203, v207
    v_mfma_f32_32x32x16_bf16 v[112:127], a[136:139], v[196:199], v[112:127]
    s_waitcnt lgkmcnt(6)
    s_waitcnt vmcnt(16) lgkmcnt(0)
    s_barrier
    s_add_u32 s47, s47, 128
    s_cmp_eq_u32 s47, 896
    s_cselect_b32 s47, 0, s47
    v_add_u32 v6, s47, v7
    v_add_u32 v241, s101, v6
    v_mfma_f32_32x32x16_bf16 v[128:143], a[140:143], v[196:199], v[128:143]
    s_add_u32 m0, s55, 20608
    ds_read_b64_tr_b16 a[112:113], v228 offset:0
    ds_read_b64_tr_b16 a[114:115], v228 offset:512
    ds_read_b64_tr_b16 a[116:117], v228 offset:1024
    buffer_load_dwordx4 v8, s[8:11], s50 offen offset:0  lds
    v_mfma_f32_32x32x16_bf16 v[144:159], a[144:147], v[196:199], v[144:159]
    ds_read_b64_tr_b16 a[118:119], v228 offset:1536
    ds_read_b64_tr_b16 a[120:121], v228 offset:2048
    ds_read_b64_tr_b16 a[122:123], v228 offset:2560
    v_mfma_f32_32x32x16_bf16 v[160:175], a[148:151], v[196:199], v[160:175]
    ds_read_b64_tr_b16 a[124:125], v229 offset:0
    ds_read_b64_tr_b16 a[126:127], v229 offset:512
    ds_read_b64_tr_b16 a[128:129], v229 offset:1024
    buffer_load_dwordx4 v9, s[8:11], s50 offen offset:1024  lds
    v_mfma_f32_32x32x16_bf16 v[176:191], a[156:159], a[152:155], v[176:191]
    s_waitcnt lgkmcnt(7)
    ds_read_b64_tr_b16 a[130:131], v229 offset:1536
    ds_read_b64_tr_b16 a[132:133], v229 offset:2048
    v_accvgpr_read_b32 v204, a84
    v_accvgpr_read_b32 v205, a85
    v_accvgpr_read_b32 v206, a86
    v_mfma_f32_32x32x16_bf16 v[16:31], a[112:115], v[192:195], v[16:31]
    s_waitcnt lgkmcnt(7)
    ds_read_b64_tr_b16 a[134:135], v229 offset:2560
    ds_read_b64_tr_b16 a[136:137], v230 offset:3072
    buffer_load_dwordx4 v10, s[8:11], s50 offen offset:2048  lds
    v_accvgpr_read_b32 v207, a87
    v_lshlrev_b32 v200, 16, v204
    v_lshlrev_b32 v201, 16, v205
    v_mfma_f32_32x32x16_bf16 v[32:47], a[116:119], v[192:195], v[32:47]
    s_waitcnt lgkmcnt(7)
    ds_read_b64_tr_b16 a[138:139], v230 offset:3584
    ds_read_b64_tr_b16 a[140:141], v230 offset:3104
    v_lshlrev_b32 v202, 16, v206
    v_lshlrev_b32 v203, 16, v207
    v_and_b32 v204, s53, v204
    v_mfma_f32_32x32x16_bf16 v[48:63], v[192:195], a[120:123], v[48:63]
    s_waitcnt lgkmcnt(7)
    ds_read_b64_tr_b16 a[142:143], v230 offset:3616
    ds_read_b64_tr_b16 a[144:145], v231 offset:3072
    buffer_load_dwordx4 v11, s[12:15], s51 offen offset:3072  lds
    v_and_b32 v205, s53, v205
    v_and_b32 v206, s53, v206
    v_and_b32 v207, s53, v207
    v_mfma_f32_32x32x16_bf16 v[64:79], a[124:127], v[192:195], v[64:79]
    s_waitcnt lgkmcnt(7)
    ds_read_b64_tr_b16 a[146:147], v231 offset:3584
    ds_read_b64_tr_b16 a[148:149], v231 offset:3104
    ds_read_b64_tr_b16 a[150:151], v231 offset:3616
    v_fma_f32 v200, v200, v13, v14
    v_fma_f32 v201, v201, v13, v14
    v_mfma_f32_32x32x16_bf16 v[80:95], a[128:131], v[192:195], v[80:95]
    s_waitcnt lgkmcnt(6)
    ds_read_b64_tr_b16 a[152:153], v232 offset:0
    ds_read_b64_tr_b16 a[154:155], v232 offset:512
    ds_read_b128 a[156:159], v6 offset:0
    v_fma_f32 v202, v202, v13, v14
    v_fma_f32 v203, v203, v13, v14
    v_mfma_f32_32x32x16_bf16 v[96:111], v[192:195], a[132:135], v[96:111]
    s_add_u32 m0, s55, 24736
    ds_read_b64_tr_b16 a[112:113], v228 offset:10304
    ds_read_b64_tr_b16 a[114:115], v228 offset:10816
    ds_read_b64_tr_b16 a[116:117], v228 offset:11328
    buffer_load_dwordx4 v12, s[16:19], s51 offen  lds
    v_fma_f32 v204, v204, v13, v14
    v_fma_f32 v205, v205, v13, v14
    v_mfma_f32_32x32x16_bf16 v[112:127], a[136:139], v[192:195], v[112:127]
    s_waitcnt lgkmcnt(6)
    ds_read_b64_tr_b16 a[118:119], v228 offset:11840
    ds_read_b64_tr_b16 a[120:121], v228 offset:12352
    ds_read_b64_tr_b16 a[122:123], v228 offset:12864
    v_fma_f32 v206, v206, v13, v14
    v_fma_f32 v207, v207, v13, v14
    v_mfma_f32_32x32x16_bf16 v[128:143], a[140:143], v[192:195], v[128:143]
    s_add_u32 s52, s52, s99
    ds_read_b64_tr_b16 a[124:125], v229 offset:10304
    ds_read_b64_tr_b16 a[126:127], v229 offset:10816
    ds_read_b64_tr_b16 a[128:129], v229 offset:11328
    v_cvt_pk_bf16_f32 v196, v200, v204
    v_cvt_pk_bf16_f32 v197, v201, v205
    v_mfma_f32_32x32x16_bf16 v[144:159], a[144:147], v[192:195], v[144:159]
    s_cmp_ge_u32 s52, 401408
    s_cselect_b32 s52, s96, s52
    ds_read_b64_tr_b16 a[130:131], v229 offset:11840
    ds_read_b64_tr_b16 a[132:133], v229 offset:12352
    v_cvt_pk_bf16_f32 v198, v202, v206
    v_cvt_pk_bf16_f32 v199, v203, v207
    v_mfma_f32_32x32x16_bf16 v[160:175], a[148:151], v[192:195], v[160:175]
    s_waitcnt lgkmcnt(7)
    s_mul_i32 s50, s52, 3
    s_lshl_b32 s51, s52, 2
    ds_read_b64_tr_b16 a[134:135], v229 offset:12864
    ds_read_b64_tr_b16 a[136:137], v230 offset:13376
    ds_read_b64_tr_b16 a[138:139], v230 offset:13888
    v_mfma_f32_32x32x16_bf16 v[176:191], a[156:159], a[152:155], v[176:191]
    ds_read_b64_tr_b16 a[140:141], v230 offset:13408
    ds_read_b64_tr_b16 a[142:143], v230 offset:13920
    ds_read_b64_tr_b16 a[144:145], v231 offset:13376
    v_accvgpr_read_b32 v204, a88
    v_accvgpr_read_b32 v205, a89
    v_accvgpr_read_b32 v206, a90
    v_mfma_f32_32x32x16_bf16 v[16:31], a[112:115], v[196:199], v[16:31]
    ds_read_b64_tr_b16 a[146:147], v231 offset:13888
    v_accvgpr_read_b32 v207, a91
    v_lshlrev_b32 v200, 16, v204
    v_lshlrev_b32 v201, 16, v205
    v_lshlrev_b32 v202, 16, v206
    v_lshlrev_b32 v203, 16, v207
    v_mfma_f32_32x32x16_bf16 v[32:47], a[116:119], v[196:199], v[32:47]
    s_waitcnt lgkmcnt(8)
    ds_read_b64_tr_b16 a[148:149], v231 offset:13408
    ds_read_b64_tr_b16 a[150:151], v231 offset:13920
    ds_read_b64_tr_b16 a[152:153], v232 offset:10304
    v_and_b32 v204, s53, v204
    v_and_b32 v205, s53, v205
    v_mfma_f32_32x32x16_bf16 v[48:63], v[196:199], a[120:123], v[48:63]
    s_add_u32 m0, s60, 2048
    ds_read_b64_tr_b16 a[154:155], v232 offset:10816
    ds_read_b128 a[156:159], v6 offset:32
    v_and_b32 v206, s53, v206
    v_and_b32 v207, s53, v207
    v_fma_f32 v200, v200, v13, v14
    v_mfma_f32_32x32x16_bf16 v[64:79], a[124:127], v[196:199], v[64:79]
    s_add_u32 s46, s75, 57344
    buffer_load_dwordx4 v15, s[24:27], s46 offen  lds
    v_fma_f32 v201, v201, v13, v14
    v_fma_f32 v202, v202, v13, v14
    v_fma_f32 v203, v203, v13, v14
    v_fma_f32 v204, v204, v13, v14
    v_mfma_f32_32x32x16_bf16 v[80:95], a[128:131], v[196:199], v[80:95]
    s_waitcnt lgkmcnt(7)
    v_fma_f32 v205, v205, v13, v14
    v_fma_f32 v206, v206, v13, v14
    v_fma_f32 v207, v207, v13, v14
    v_cvt_pk_bf16_f32 v192, v200, v204
    v_cvt_pk_bf16_f32 v193, v201, v205
    v_mfma_f32_32x32x16_bf16 v[96:111], v[196:199], a[132:135], v[96:111]
    s_waitcnt vmcnt(13) lgkmcnt(0)
    s_barrier
    ds_read_b64_tr_b16 a[112:113], v228 offset:20608
    ds_read_b64_tr_b16 a[114:115], v228 offset:21120
    ds_read_b64_tr_b16 a[116:117], v228 offset:21632
    v_cvt_pk_bf16_f32 v194, v202, v206
    v_mfma_f32_32x32x16_bf16 v[112:127], a[136:139], v[196:199], v[112:127]
    ds_read_b64_tr_b16 a[118:119], v228 offset:22144
    ds_read_b64_tr_b16 a[120:121], v228 offset:22656
    ds_read_b64_tr_b16 a[122:123], v228 offset:23168
    buffer_load_dwordx4 v233, s[24:27], s46 offen offset:1024  lds
    v_cvt_pk_bf16_f32 v195, v203, v207
    v_mfma_f32_32x32x16_bf16 v[128:143], a[140:143], v[196:199], v[128:143]
    ds_read_b64_tr_b16 a[124:125], v229 offset:20608
    ds_read_b64_tr_b16 a[126:127], v229 offset:21120
    ds_read_b64_tr_b16 a[128:129], v229 offset:21632
    v_mfma_f32_32x32x16_bf16 v[144:159], a[144:147], v[196:199], v[144:159]
    ds_read_b64_tr_b16 a[130:131], v229 offset:22144
    ds_read_b64_tr_b16 a[132:133], v229 offset:22656
    ds_read_b64_tr_b16 a[134:135], v229 offset:23168
    v_mfma_f32_32x32x16_bf16 v[160:175], a[148:151], v[196:199], v[160:175]
    ds_read_b64_tr_b16 a[136:137], v230 offset:23680
    ds_read_b64_tr_b16 a[138:139], v230 offset:24192
    v_mfma_f32_32x32x16_bf16 v[176:191], a[156:159], a[152:155], v[176:191]
    s_waitcnt lgkmcnt(8)
    ds_read_b64_tr_b16 a[140:141], v230 offset:23712
    ds_read_b64_tr_b16 a[142:143], v230 offset:24224
    v_accvgpr_read_b32 v204, a92
    v_accvgpr_read_b32 v205, a93
    v_accvgpr_read_b32 v206, a94
    v_mfma_f32_32x32x16_bf16 v[16:31], a[112:115], v[192:195], v[16:31]
    ds_read_b64_tr_b16 a[144:145], v231 offset:23680
    ds_read_b64_tr_b16 a[146:147], v231 offset:24192
    ds_read_b64_tr_b16 a[148:149], v231 offset:23712
    v_accvgpr_read_b32 v207, a95
    v_lshlrev_b32 v200, 16, v204
    v_lshlrev_b32 v201, 16, v205
    v_mfma_f32_32x32x16_bf16 v[32:47], a[116:119], v[192:195], v[32:47]
    ds_read_b64_tr_b16 a[150:151], v231 offset:24224
    v_lshlrev_b32 v202, 16, v206
    v_lshlrev_b32 v203, 16, v207
    v_and_b32 v204, s53, v204
    v_and_b32 v205, s53, v205
    v_and_b32 v206, s53, v206
    v_mfma_f32_32x32x16_bf16 v[48:63], v[192:195], a[120:123], v[48:63]
    s_waitcnt lgkmcnt(8)
    ds_read_b64_tr_b16 a[152:153], v232 offset:20608
    ds_read_b64_tr_b16 a[154:155], v232 offset:21120
    ds_read_b128 a[156:159], v241 offset:0
    v_and_b32 v207, s53, v207
    v_fma_f32 v200, v200, v13, v14
    v_mfma_f32_32x32x16_bf16 v[64:79], a[124:127], v[192:195], v[64:79]
    ds_read_b64_tr_b16 a[112:113], v228 offset:30912
    ds_read_b64_tr_b16 a[114:115], v228 offset:31424
    ds_read_b64_tr_b16 a[176:177], v244 offset:4096
    v_fma_f32 v201, v201, v13, v14
    v_fma_f32 v202, v202, v13, v14
    v_fma_f32 v203, v203, v13, v14
    v_mfma_f32_32x32x16_bf16 v[80:95], a[128:131], v[192:195], v[80:95]
    v_fma_f32 v204, v204, v13, v14
    v_fma_f32 v205, v205, v13, v14
    v_fma_f32 v206, v206, v13, v14
    v_fma_f32 v207, v207, v13, v14
    v_cvt_pk_bf16_f32 v196, v200, v204
    v_cvt_pk_bf16_f32 v197, v201, v205
    v_mfma_f32_32x32x16_bf16 v[96:111], v[192:195], a[132:135], v[96:111]
    s_waitcnt lgkmcnt(8)
    ds_read_b64_tr_b16 a[116:117], v228 offset:31936
    ds_read_b64_tr_b16 a[118:119], v228 offset:32448
    ds_read_b64_tr_b16 a[120:121], v228 offset:32960
    v_cvt_pk_bf16_f32 v198, v202, v206
    v_cvt_pk_bf16_f32 v199, v203, v207
    v_mfma_f32_32x32x16_bf16 v[112:127], a[136:139], v[192:195], v[112:127]
    ds_read_b64_tr_b16 a[122:123], v228 offset:33472
    ds_read_b64_tr_b16 a[124:125], v229 offset:30912
    ds_read_b64_tr_b16 a[126:127], v229 offset:31424
    v_mfma_f32_32x32x16_bf16 v[128:143], a[140:143], v[192:195], v[128:143]
    v_mfma_f32_32x32x16_bf16 v[144:159], a[144:147], v[192:195], v[144:159]
    s_waitcnt lgkmcnt(7)
    ds_read_b64_tr_b16 a[128:129], v229 offset:31936
    ds_read_b64_tr_b16 a[130:131], v229 offset:32448
    ds_read_b64_tr_b16 a[132:133], v229 offset:32960
    v_mfma_f32_32x32x16_bf16 v[160:175], a[148:151], v[192:195], v[160:175]
    ds_read_b64_tr_b16 a[134:135], v229 offset:33472
    ds_read_b64_tr_b16 a[136:137], v230 offset:33984
    ds_read_b64_tr_b16 a[138:139], v230 offset:34496
    v_mfma_f32_32x32x16_bf16 v[176:191], a[156:159], a[152:155], v[176:191]
    ds_read_b64_tr_b16 a[140:141], v230 offset:34016
    v_accvgpr_read_b32 v204, a96
    v_accvgpr_read_b32 v205, a97
    v_accvgpr_read_b32 v206, a98
    v_accvgpr_read_b32 v207, a99
    v_lshlrev_b32 v200, 16, v204
    v_mfma_f32_32x32x16_bf16 v[16:31], a[112:115], v[196:199], v[16:31]
    s_waitcnt lgkmcnt(7)
    ds_read_b64_tr_b16 a[142:143], v230 offset:34528
    ds_read_b64_tr_b16 a[144:145], v231 offset:33984
    v_lshlrev_b32 v201, 16, v205
    v_lshlrev_b32 v202, 16, v206
    v_lshlrev_b32 v203, 16, v207
    v_mfma_f32_32x32x16_bf16 v[32:47], a[116:119], v[196:199], v[32:47]
    ds_read_b64_tr_b16 a[146:147], v231 offset:34496
    ds_read_b64_tr_b16 a[148:149], v231 offset:34016
    ds_read_b64_tr_b16 a[150:151], v231 offset:34528
    v_and_b32 v204, s53, v204
    v_and_b32 v205, s53, v205
    v_and_b32 v206, s53, v206
    v_mfma_f32_32x32x16_bf16 v[48:63], v[196:199], a[120:123], v[48:63]
    ds_read_b64_tr_b16 a[152:153], v232 offset:30912
    ds_read_b64_tr_b16 a[154:155], v232 offset:31424
    v_and_b32 v207, s53, v207
    v_fma_f32 v200, v200, v13, v14
    v_fma_f32 v201, v201, v13, v14
    v_fma_f32 v202, v202, v13, v14
    v_mfma_f32_32x32x16_bf16 v[64:79], a[124:127], v[196:199], v[64:79]
    s_waitcnt lgkmcnt(8)
    ds_read_b128 a[156:159], v241 offset:32
    ds_read_b64_tr_b16 a[178:179], v244 offset:5120
    ds_read_b64_tr_b16 a[180:181], v245 offset:4096
    v_fma_f32 v203, v203, v13, v14
    v_fma_f32 v204, v204, v13, v14
    v_mfma_f32_32x32x16_bf16 v[80:95], a[128:131], v[196:199], v[80:95]
    ds_read_b64_tr_b16 a[182:183], v245 offset:5120
    v_fma_f32 v205, v205, v13, v14
    v_fma_f32 v206, v206, v13, v14
    v_fma_f32 v207, v207, v13, v14
    v_cvt_pk_bf16_f32 v192, v200, v204
    v_cvt_pk_bf16_f32 v193, v201, v205
    v_mfma_f32_32x32x16_bf16 v[96:111], v[196:199], a[132:135], v[96:111]
    v_cvt_pk_bf16_f32 v194, v202, v206
    v_cvt_pk_bf16_f32 v195, v203, v207
    v_mfma_f32_32x32x16_bf16 v[112:127], a[136:139], v[196:199], v[112:127]
    s_waitcnt lgkmcnt(6)
    s_waitcnt vmcnt(7) lgkmcnt(0)
    s_barrier
    s_add_u32 s47, s47, 128
    s_cmp_eq_u32 s47, 896
    s_cselect_b32 s47, 0, s47
    v_add_u32 v6, s47, v7
    v_add_u32 v241, s101, v6
    v_mfma_f32_32x32x16_bf16 v[128:143], a[140:143], v[196:199], v[128:143]
    s_add_u32 m0, s60, 4096
    ds_read_b64_tr_b16 a[112:113], v1 offset:0
    ds_read_b64_tr_b16 a[114:115], v1 offset:512
    ds_read_b64_tr_b16 a[116:117], v1 offset:1024
    buffer_load_dwordx4 v15, s[24:27], s76 offen  lds
    v_mfma_f32_32x32x16_bf16 v[144:159], a[144:147], v[196:199], v[144:159]
    ds_read_b64_tr_b16 a[118:119], v1 offset:1536
    ds_read_b64_tr_b16 a[120:121], v1 offset:2048
    ds_read_b64_tr_b16 a[122:123], v1 offset:2560
    v_mfma_f32_32x32x16_bf16 v[160:175], a[148:151], v[196:199], v[160:175]
    ds_read_b64_tr_b16 a[124:125], v2 offset:0
    ds_read_b64_tr_b16 a[126:127], v2 offset:512
    ds_read_b64_tr_b16 a[128:129], v2 offset:1024
    buffer_load_dwordx4 v233, s[24:27], s76 offen offset:1024  lds
    v_mfma_f32_32x32x16_bf16 v[176:191], a[156:159], a[152:155], v[176:191]
    s_waitcnt lgkmcnt(7)
    ds_read_b64_tr_b16 a[130:131], v2 offset:1536
    ds_read_b64_tr_b16 a[132:133], v2 offset:2048
    v_accvgpr_read_b32 v204, a100
    v_accvgpr_read_b32 v205, a101
    v_accvgpr_read_b32 v206, a102
    v_mfma_f32_32x32x16_bf16 v[16:31], a[112:115], v[192:195], v[16:31]
    s_waitcnt lgkmcnt(7)
    ds_read_b64_tr_b16 a[134:135], v2 offset:2560
    ds_read_b64_tr_b16 a[136:137], v3 offset:3072
    v_accvgpr_read_b32 v207, a103
    v_lshlrev_b32 v200, 16, v204
    v_lshlrev_b32 v201, 16, v205
    v_mfma_f32_32x32x16_bf16 v[32:47], a[116:119], v[192:195], v[32:47]
    s_waitcnt lgkmcnt(7)
    ds_read_b64_tr_b16 a[138:139], v3 offset:3584
    ds_read_b64_tr_b16 a[140:141], v3 offset:3104
    v_lshlrev_b32 v202, 16, v206
    v_lshlrev_b32 v203, 16, v207
    v_and_b32 v204, s53, v204
    v_mfma_f32_32x32x16_bf16 v[48:63], v[192:195], a[120:123], v[48:63]
    s_waitcnt lgkmcnt(7)
    ds_read_b64_tr_b16 a[142:143], v3 offset:3616
    ds_read_b64_tr_b16 a[144:145], v4 offset:3072
    v_and_b32 v205, s53, v205
    v_and_b32 v206, s53, v206
    v_and_b32 v207, s53, v207
    v_mfma_f32_32x32x16_bf16 v[64:79], a[124:127], v[192:195], v[64:79]
    s_waitcnt lgkmcnt(7)
    ds_read_b64_tr_b16 a[146:147], v4 offset:3584
    ds_read_b64_tr_b16 a[148:149], v4 offset:3104
    ds_read_b64_tr_b16 a[150:151], v4 offset:3616
    v_fma_f32 v200, v200, v13, v14
    v_fma_f32 v201, v201, v13, v14
    v_mfma_f32_32x32x16_bf16 v[80:95], a[128:131], v[192:195], v[80:95]
    s_waitcnt lgkmcnt(6)
    ds_read_b64_tr_b16 a[152:153], v5 offset:0
    ds_read_b64_tr_b16 a[154:155], v5 offset:512
    ds_read_b128 a[156:159], v6 offset:0
    v_fma_f32 v202, v202, v13, v14
    v_fma_f32 v203, v203, v13, v14
    v_mfma_f32_32x32x16_bf16 v[96:111], v[192:195], a[132:135], v[96:111]
    ds_read_b64_tr_b16 a[112:113], v1 offset:10304
    ds_read_b64_tr_b16 a[114:115], v1 offset:10816
    ds_read_b64_tr_b16 a[116:117], v1 offset:11328
    v_fma_f32 v204, v204, v13, v14
    v_fma_f32 v205, v205, v13, v14
    v_fma_f32 v206, v206, v13, v14
    v_mfma_f32_32x32x16_bf16 v[112:127], a[136:139], v[192:195], v[112:127]
    s_waitcnt lgkmcnt(6)
    ds_read_b64_tr_b16 a[118:119], v1 offset:11840
    ds_read_b64_tr_b16 a[120:121], v1 offset:12352
    ds_read_b64_tr_b16 a[122:123], v1 offset:12864
    v_fma_f32 v207, v207, v13, v14
    v_cvt_pk_bf16_f32 v196, v200, v204
    v_mfma_f32_32x32x16_bf16 v[128:143], a[140:143], v[192:195], v[128:143]
    ds_read_b64_tr_b16 a[124:125], v2 offset:10304
    ds_read_b64_tr_b16 a[126:127], v2 offset:10816
    ds_read_b64_tr_b16 a[128:129], v2 offset:11328
    v_cvt_pk_bf16_f32 v197, v201, v205
    v_cvt_pk_bf16_f32 v198, v202, v206
    v_cvt_pk_bf16_f32 v199, v203, v207
    v_mfma_f32_32x32x16_bf16 v[144:159], a[144:147], v[192:195], v[144:159]
    ds_read_b64_tr_b16 a[130:131], v2 offset:11840
    ds_read_b64_tr_b16 a[132:133], v2 offset:12352
    v_mfma_f32_32x32x16_bf16 v[160:175], a[148:151], v[192:195], v[160:175]
    s_waitcnt lgkmcnt(7)
    ds_read_b64_tr_b16 a[134:135], v2 offset:12864
    ds_read_b64_tr_b16 a[136:137], v3 offset:13376
    ds_read_b64_tr_b16 a[138:139], v3 offset:13888
    v_mfma_f32_32x32x16_bf16 v[176:191], a[156:159], a[152:155], v[176:191]
    ds_read_b64_tr_b16 a[140:141], v3 offset:13408
    ds_read_b64_tr_b16 a[142:143], v3 offset:13920
    ds_read_b64_tr_b16 a[144:145], v4 offset:13376
    v_accvgpr_read_b32 v204, a104
    v_accvgpr_read_b32 v205, a105
    v_accvgpr_read_b32 v206, a106
    v_mfma_f32_32x32x16_bf16 v[16:31], a[112:115], v[196:199], v[16:31]
    ds_read_b64_tr_b16 a[146:147], v4 offset:13888
    v_accvgpr_read_b32 v207, a107
    v_lshlrev_b32 v200, 16, v204
    v_lshlrev_b32 v201, 16, v205
    v_lshlrev_b32 v202, 16, v206
    v_lshlrev_b32 v203, 16, v207
    v_mfma_f32_32x32x16_bf16 v[32:47], a[116:119], v[196:199], v[32:47]
    s_waitcnt lgkmcnt(8)
    ds_read_b64_tr_b16 a[148:149], v4 offset:13408
    ds_read_b64_tr_b16 a[150:151], v4 offset:13920
    ds_read_b64_tr_b16 a[152:153], v5 offset:10304
    v_and_b32 v204, s53, v204
    v_and_b32 v205, s53, v205
    v_mfma_f32_32x32x16_bf16 v[48:63], v[196:199], a[120:123], v[48:63]
    ds_read_b64_tr_b16 a[154:155], v5 offset:10816
    ds_read_b128 a[156:159], v6 offset:32
    ds_read_b64_tr_b16 a[184:185], v244 offset:6144
    v_and_b32 v206, s53, v206
    v_and_b32 v207, s53, v207
    v_fma_f32 v200, v200, v13, v14
    v_mfma_f32_32x32x16_bf16 v[64:79], a[124:127], v[196:199], v[64:79]
    v_fma_f32 v201, v201, v13, v14
    v_fma_f32 v202, v202, v13, v14
    v_fma_f32 v203, v203, v13, v14
    v_fma_f32 v204, v204, v13, v14
    v_fma_f32 v205, v205, v13, v14
    v_fma_f32 v206, v206, v13, v14
    v_mfma_f32_32x32x16_bf16 v[80:95], a[128:131], v[196:199], v[80:95]
    s_waitcnt lgkmcnt(8)
    ds_read_b64_tr_b16 a[186:187], v244 offset:7168
    ds_read_b64_tr_b16 a[188:189], v245 offset:6144
    ds_read_b64_tr_b16 a[190:191], v245 offset:7168
    v_fma_f32 v207, v207, v13, v14
    v_cvt_pk_bf16_f32 v192, v200, v204
    v_mfma_f32_32x32x16_bf16 v[96:111], v[196:199], a[132:135], v[96:111]
    s_waitcnt vmcnt(4) lgkmcnt(0)
    s_barrier
    ds_read_b64_tr_b16 a[112:113], v1 offset:20608
    ds_read_b64_tr_b16 a[114:115], v1 offset:21120
    ds_read_b64_tr_b16 a[116:117], v1 offset:21632
    v_cvt_pk_bf16_f32 v193, v201, v205
    v_mfma_f32_32x32x16_bf16 v[112:127], a[136:139], v[196:199], v[112:127]
    s_add_u32 m0, s60, 6144
    s_add_u32 s46, s76, 14336
    ds_read_b64_tr_b16 a[118:119], v1 offset:22144
    ds_read_b64_tr_b16 a[120:121], v1 offset:22656
    ds_read_b64_tr_b16 a[122:123], v1 offset:23168
    v_cvt_pk_bf16_f32 v194, v202, v206
    v_mfma_f32_32x32x16_bf16 v[128:143], a[140:143], v[196:199], v[128:143]
    ds_read_b64_tr_b16 a[124:125], v2 offset:20608
    ds_read_b64_tr_b16 a[126:127], v2 offset:21120
    ds_read_b64_tr_b16 a[128:129], v2 offset:21632
    buffer_load_dwordx4 v15, s[24:27], s46 offen  lds
    v_cvt_pk_bf16_f32 v195, v203, v207
    v_mfma_f32_32x32x16_bf16 v[144:159], a[144:147], v[196:199], v[144:159]
    ds_read_b64_tr_b16 a[130:131], v2 offset:22144
    ds_read_b64_tr_b16 a[132:133], v2 offset:22656
    ds_read_b64_tr_b16 a[134:135], v2 offset:23168
    v_mfma_f32_32x32x16_bf16 v[160:175], a[148:151], v[196:199], v[160:175]
    ds_read_b64_tr_b16 a[136:137], v3 offset:23680
    ds_read_b64_tr_b16 a[138:139], v3 offset:24192
    buffer_load_dwordx4 v233, s[24:27], s46 offen offset:1024  lds
    v_mfma_f32_32x32x16_bf16 v[176:191], a[156:159], a[152:155], v[176:191]
    s_waitcnt lgkmcnt(8)
    ds_read_b64_tr_b16 a[140:141], v3 offset:23712
    ds_read_b64_tr_b16 a[142:143], v3 offset:24224
    v_accvgpr_read_b32 v204, a108
    v_accvgpr_read_b32 v205, a109
    v_accvgpr_read_b32 v206, a110
    v_mfma_f32_32x32x16_bf16 v[16:31], a[112:115], v[192:195], v[16:31]
    ds_read_b64_tr_b16 a[144:145], v4 offset:23680
    ds_read_b64_tr_b16 a[146:147], v4 offset:24192
    ds_read_b64_tr_b16 a[148:149], v4 offset:23712
    v_accvgpr_read_b32 v207, a111
    v_lshlrev_b32 v200, 16, v204
    v_lshlrev_b32 v201, 16, v205
    v_mfma_f32_32x32x16_bf16 v[32:47], a[116:119], v[192:195], v[32:47]
    ds_read_b64_tr_b16 a[150:151], v4 offset:24224
    v_lshlrev_b32 v202, 16, v206
    v_lshlrev_b32 v203, 16, v207
    v_and_b32 v204, s53, v204
    v_and_b32 v205, s53, v205
    v_and_b32 v206, s53, v206
    v_mfma_f32_32x32x16_bf16 v[48:63], v[192:195], a[120:123], v[48:63]
    s_waitcnt lgkmcnt(8)
    ds_read_b64_tr_b16 a[152:153], v5 offset:20608
    ds_read_b64_tr_b16 a[154:155], v5 offset:21120
    ds_read_b128 a[156:159], v241 offset:0
    v_and_b32 v207, s53, v207
    v_fma_f32 v200, v200, v13, v14
    v_mfma_f32_32x32x16_bf16 v[64:79], a[124:127], v[192:195], v[64:79]
    ds_read_b64_tr_b16 a[112:113], v1 offset:30912
    ds_read_b64_tr_b16 a[114:115], v1 offset:31424
    ds_read_b64_tr_b16 a[192:193], v244 offset:8192
    v_fma_f32 v201, v201, v13, v14
    v_fma_f32 v202, v202, v13, v14
    v_fma_f32 v203, v203, v13, v14
    v_mfma_f32_32x32x16_bf16 v[80:95], a[128:131], v[192:195], v[80:95]
    v_fma_f32 v204, v204, v13, v14
    v_fma_f32 v205, v205, v13, v14
    v_fma_f32 v206, v206, v13, v14
    v_fma_f32 v207, v207, v13, v14
    v_cvt_pk_bf16_f32 v196, v200, v204
    v_cvt_pk_bf16_f32 v197, v201, v205
    v_mfma_f32_32x32x16_bf16 v[96:111], v[192:195], a[132:135], v[96:111]
    s_waitcnt lgkmcnt(8)
    ds_read_b64_tr_b16 a[116:117], v1 offset:31936
    ds_read_b64_tr_b16 a[118:119], v1 offset:32448
    ds_read_b64_tr_b16 a[120:121], v1 offset:32960
    v_cvt_pk_bf16_f32 v198, v202, v206
    v_cvt_pk_bf16_f32 v199, v203, v207
    v_mfma_f32_32x32x16_bf16 v[112:127], a[136:139], v[192:195], v[112:127]
    ds_read_b64_tr_b16 a[122:123], v1 offset:33472
    ds_read_b64_tr_b16 a[124:125], v2 offset:30912
    ds_read_b64_tr_b16 a[126:127], v2 offset:31424
    v_mfma_f32_32x32x16_bf16 v[128:143], a[140:143], v[192:195], v[128:143]
    v_mfma_f32_32x32x16_bf16 v[144:159], a[144:147], v[192:195], v[144:159]
    s_waitcnt lgkmcnt(7)
    ds_read_b64_tr_b16 a[128:129], v2 offset:31936
    ds_read_b64_tr_b16 a[130:131], v2 offset:32448
    ds_read_b64_tr_b16 a[132:133], v2 offset:32960
    v_mfma_f32_32x32x16_bf16 v[160:175], a[148:151], v[192:195], v[160:175]
    ds_read_b64_tr_b16 a[134:135], v2 offset:33472
    ds_read_b64_tr_b16 a[136:137], v3 offset:33984
    ds_read_b64_tr_b16 a[138:139], v3 offset:34496
    v_mfma_f32_32x32x16_bf16 v[176:191], a[156:159], a[152:155], v[176:191]
    ds_read_b64_tr_b16 a[140:141], v3 offset:34016
    v_mfma_f32_32x32x16_bf16 v[16:31], a[112:115], v[196:199], v[16:31]
    s_waitcnt lgkmcnt(7)
    ds_read_b64_tr_b16 a[142:143], v3 offset:34528
    ds_read_b64_tr_b16 a[144:145], v4 offset:33984
    ds_read_b64_tr_b16 a[146:147], v4 offset:34496
    v_mfma_f32_32x32x16_bf16 v[32:47], a[116:119], v[196:199], v[32:47]
    ds_read_b64_tr_b16 a[148:149], v4 offset:34016
    ds_read_b64_tr_b16 a[150:151], v4 offset:34528
    ds_read_b64_tr_b16 a[152:153], v5 offset:30912
    v_mfma_f32_32x32x16_bf16 v[48:63], v[196:199], a[120:123], v[48:63]
    ds_read_b64_tr_b16 a[154:155], v5 offset:31424
    v_mfma_f32_32x32x16_bf16 v[64:79], a[124:127], v[196:199], v[64:79]
    s_waitcnt lgkmcnt(8)
    ds_read_b128 a[156:159], v241 offset:32
    ds_read_b64_tr_b16 a[194:195], v244 offset:9216
    ds_read_b64_tr_b16 a[196:197], v245 offset:8192
    v_mfma_f32_32x32x16_bf16 v[80:95], a[128:131], v[196:199], v[80:95]
    ds_read_b64_tr_b16 a[198:199], v245 offset:9216
    v_mfma_f32_32x32x16_bf16 v[96:111], v[196:199], a[132:135], v[96:111]
    v_mfma_f32_32x32x16_bf16 v[112:127], a[136:139], v[196:199], v[112:127]
    s_waitcnt lgkmcnt(6)
    s_waitcnt lgkmcnt(0)
    s_barrier
    s_add_u32 m0, s60, 8192
    s_add_u32 s46, s76, 28672
    v_mfma_f32_32x32x16_bf16 v[128:143], a[140:143], v[196:199], v[128:143]
    buffer_load_dwordx4 v15, s[24:27], s46 offen  lds
    v_mfma_f32_32x32x16_bf16 v[144:159], a[144:147], v[196:199], v[144:159]
    v_mfma_f32_32x32x16_bf16 v[160:175], a[148:151], v[196:199], v[160:175]
    buffer_load_dwordx4 v233, s[24:27], s46 offen offset:1024  lds
    v_mfma_f32_32x32x16_bf16 v[176:191], a[156:159], a[152:155], v[176:191]
    ds_read_b64_tr_b16 a[200:201], v244 offset:10240
    ds_read_b64_tr_b16 a[202:203], v244 offset:11264
    ds_read_b64_tr_b16 a[204:205], v245 offset:10240
    ds_read_b64_tr_b16 a[206:207], v245 offset:11264
    s_waitcnt lgkmcnt(0)
    s_add_u32 m0, s60, 10240
    s_add_u32 s46, s76, 43008
    buffer_load_dwordx4 v15, s[24:27], s46 offen  lds
    buffer_load_dwordx4 v233, s[24:27], s46 offen offset:1024  lds
    s_add_u32 m0, s61, 0
    s_add_u32 s46, s76, 57344
    buffer_load_dwordx4 v15, s[24:27], s46 offen  lds
    v_mov_b32 v1, v233
    v_cvt_pk_bf16_f32 v32, v32, v33
    v_cvt_pk_bf16_f32 v33, v34, v35
    v_cvt_pk_bf16_f32 v34, v36, v37
    v_cvt_pk_bf16_f32 v35, v38, v39
    v_cvt_pk_bf16_f32 v36, v40, v41
    v_cvt_pk_bf16_f32 v37, v42, v43
    v_cvt_pk_bf16_f32 v38, v44, v45
    v_cvt_pk_bf16_f32 v39, v46, v47
    buffer_load_dwordx4 v1, s[24:27], s46 offen offset:1024  lds
    v_cvt_pk_bf16_f32 v80, v80, v81
    v_cvt_pk_bf16_f32 v81, v82, v83
    v_cvt_pk_bf16_f32 v82, v84, v85
    v_cvt_pk_bf16_f32 v83, v86, v87
    v_cvt_pk_bf16_f32 v84, v88, v89
    v_cvt_pk_bf16_f32 v85, v90, v91
    v_cvt_pk_bf16_f32 v86, v92, v93
    v_cvt_pk_bf16_f32 v87, v94, v95
    s_add_u32 m0, s61, 2048
    s_nop 0
    buffer_load_dwordx4 v15, s[24:27], s77 offen  lds
    s_mov_b32 exec_lo, 0xff000000
    s_mov_b32 exec_hi, 0xff000000
    ds_write_b64 v234, v[32:33] offset:0
    ds_write_b64 v234, v[34:35] offset:16
    ds_write_b64 v234, v[36:37] offset:32
    ds_write_b64 v234, v[38:39] offset:48
    ds_write_b64 v234, v[80:81] offset:512
    ds_write_b64 v234, v[82:83] offset:528
    ds_write_b64 v234, v[84:85] offset:544
    ds_write_b64 v234, v[86:87] offset:560
    s_mov_b64 exec, -1
    v_cvt_pk_bf16_f32 v48, v48, v49
    v_cvt_pk_bf16_f32 v49, v50, v51
    v_cvt_pk_bf16_f32 v50, v52, v53
    v_cvt_pk_bf16_f32 v51, v54, v55
    v_cvt_pk_bf16_f32 v52, v56, v57
    v_cvt_pk_bf16_f32 v53, v58, v59
    v_cvt_pk_bf16_f32 v54, v60, v61
    v_cvt_pk_bf16_f32 v55, v62, v63
    buffer_load_dwordx4 v1, s[24:27], s77 offen offset:1024  lds
    v_cvt_pk_bf16_f32 v96, v96, v97
    v_cvt_pk_bf16_f32 v97, v98, v99
    v_cvt_pk_bf16_f32 v98, v100, v101
    v_cvt_pk_bf16_f32 v99, v102, v103
    v_cvt_pk_bf16_f32 v100, v104, v105
    v_cvt_pk_bf16_f32 v101, v106, v107
    v_cvt_pk_bf16_f32 v102, v108, v109
    v_cvt_pk_bf16_f32 v103, v110, v111
    s_add_u32 m0, s61, 4096
    s_add_u32 s46, s77, 14336
    buffer_load_dwordx4 v15, s[24:27], s46 offen  lds
    v_cvt_pk_bf16_f32 v176, v184, v185
    v_cvt_pk_bf16_f32 v177, v186, v187
    v_cvt_pk_bf16_f32 v178, v188, v189
    v_cvt_pk_bf16_f32 v179, v190, v191
    ds_write_b64 v235, v[54:55] offset:0
    ds_write_b64 v235, v[102:103] offset:512
    s_bitcmp1_b32 s3, 0
    s_cbranch_scc1 L_halo_v
    ds_write_b16 v236, v176 offset:0
    ds_write_b16_d16_hi v236, v176 offset:64
    ds_write_b16 v236, v177 offset:128
    ds_write_b16_d16_hi v236, v177 offset:192
    ds_write_b16 v236, v178 offset:512
    ds_write_b16_d16_hi v236, v178 offset:576
    ds_write_b16 v236, v179 offset:640
    ds_write_b16_d16_hi v236, v179 offset:704
    s_branch L_halo_done
L_halo_v:
    ds_write_b64 v236, v[178:179] offset:0
    ds_write_b64 v236, v[176:177] offset:512
L_halo_done:
    v_cvt_pk_bf16_f32 v16, v16, v17
    v_cvt_pk_bf16_f32 v17, v18, v19
    v_cvt_pk_bf16_f32 v18, v20, v21
    v_cvt_pk_bf16_f32 v19, v22, v23
    v_cvt_pk_bf16_f32 v20, v24, v25
    v_cvt_pk_bf16_f32 v21, v26, v27
    v_cvt_pk_bf16_f32 v22, v28, v29
    v_cvt_pk_bf16_f32 v23, v30, v31
    buffer_load_dwordx4 v1, s[24:27], s46 offen offset:1024  lds
    v_cvt_pk_bf16_f32 v64, v64, v65
    v_cvt_pk_bf16_f32 v65, v66, v67
    v_cvt_pk_bf16_f32 v66, v68, v69
    v_cvt_pk_bf16_f32 v67, v70, v71
    v_cvt_pk_bf16_f32 v68, v72, v73
    v_cvt_pk_bf16_f32 v69, v74, v75
    v_cvt_pk_bf16_f32 v70, v76, v77
    v_cvt_pk_bf16_f32 v71, v78, v79
    s_add_u32 m0, s61, 6144
    s_add_u32 s46, s77, 28672
    buffer_load_dwordx4 v15, s[24:27], s46 offen  lds
    s_mov_b32 exec_lo, 0
    v_mov_b32 v22, 0
    v_mov_b32 v23, 0
    v_mov_b32 v70, 0
    v_mov_b32 v71, 0
    s_mov_b32 exec_lo, -1
    v_mov_b32 v44, 0
    v_mov_b32 v45, 0
    v_mov_b32 v92, 0
    v_mov_b32 v93, 0
    s_waitcnt lgkmcnt(0)
    s_barrier
    ds_read_b64 v[24:25], v237 offset:0
    ds_read_b64 v[26:27], v237 offset:16
    ds_read_b64 v[28:29], v237 offset:32
    ds_read_b64 v[30:31], v237 offset:48
    ds_read_b64 v[56:57], v239
    ds_read_b64 v[72:73], v238 offset:0
    ds_read_b64 v[74:75], v238 offset:16
    ds_read_b64 v[76:77], v238 offset:32
    ds_read_b64 v[78:79], v238 offset:48
    ds_read_b64 v[104:105], v240
    v_mfma_f32_32x32x16_bf16 v[228:243], v[32:35], v[16:19], v[208:223]
    v_mfma_f32_32x32x16_bf16 v[228:243], v[36:39], v[20:23], v[228:243]
    v_mfma_f32_32x32x16_bf16 v[176:191], v[80:83], v[64:67], v[208:223]
    v_mfma_f32_32x32x16_bf16 v[176:191], v[84:87], v[68:71], v[176:191]
    v_pk_mul_f32 v[200:201], v[112:113], v[112:113]
    v_pk_mul_f32 v[202:203], v[114:115], v[114:115]
    v_pk_mul_f32 v[204:205], v[116:117], v[116:117]
    v_pk_mul_f32 v[206:207], v[118:119], v[118:119]
    v_pk_fma_f32 v[200:201], v[200:201], s[84:85], v[250:251]
    v_pk_fma_f32 v[202:203], v[202:203], s[84:85], v[250:251]
    v_pk_fma_f32 v[204:205], v[204:205], s[84:85], v[250:251]
    v_pk_fma_f32 v[206:207], v[206:207], s[84:85], v[250:251]
    buffer_load_dwordx4 v1, s[24:27], s46 offen offset:1024  lds
    v_pk_mul_f32 v[200:201], v[200:201], v[112:113]
    v_pk_mul_f32 v[202:203], v[202:203], v[114:115]
    v_pk_mul_f32 v[204:205], v[204:205], v[116:117]
    v_pk_mul_f32 v[206:207], v[206:207], v[118:119]
    v_exp_f32 v200, v200
    v_exp_f32 v201, v201
    v_exp_f32 v202, v202
    v_exp_f32 v203, v203
    ds_read_b64_tr_b16 a[208:209], v244 offset:12288
    ds_read_b64_tr_b16 a[210:211], v244 offset:13312
    ds_read_b64_tr_b16 a[212:213], v245 offset:12288
    ds_read_b64_tr_b16 a[214:215], v245 offset:13312
    v_exp_f32 v204, v204
    v_exp_f32 v205, v205
    v_exp_f32 v206, v206
    v_exp_f32 v207, v207
    v_pk_mul_f32 v[120:121], v[120:121], v[112:113]
    v_pk_mul_f32 v[122:123], v[122:123], v[114:115]
    v_pk_mul_f32 v[124:125], v[124:125], v[116:117]
    v_pk_mul_f32 v[126:127], v[126:127], v[118:119]
    s_add_u32 m0, s61, 8192
    s_add_u32 s46, s77, 43008
    buffer_load_dwordx4 v15, s[24:27], s46 offen  lds
    v_pk_add_f32 v[200:201], v[200:201], 1.0 op_sel_hi:[1,0]
    v_pk_add_f32 v[202:203], v[202:203], 1.0 op_sel_hi:[1,0]
    v_pk_add_f32 v[204:205], v[204:205], 1.0 op_sel_hi:[1,0]
    v_pk_add_f32 v[206:207], v[206:207], 1.0 op_sel_hi:[1,0]
    v_rcp_f32 v200, v200
    v_rcp_f32 v201, v201
    v_rcp_f32 v202, v202
    v_rcp_f32 v203, v203
    buffer_load_dwordx4 v1, s[24:27], s46 offen offset:1024  lds
    v_rcp_f32 v204, v204
    v_rcp_f32 v205, v205
    v_rcp_f32 v206, v206
    v_rcp_f32 v207, v207
    v_pk_mul_f32 v[120:121], v[120:121], v[200:201]
    v_pk_mul_f32 v[122:123], v[122:123], v[202:203]
    v_pk_mul_f32 v[124:125], v[124:125], v[204:205]
    v_pk_mul_f32 v[126:127], v[126:127], v[206:207]
    ds_read_b64_tr_b16 a[216:217], v244 offset:14336
    ds_read_b64_tr_b16 a[218:219], v244 offset:15360
    ds_read_b64_tr_b16 a[220:221], v245 offset:14336
    ds_read_b64_tr_b16 a[222:223], v245 offset:15360
    v_cvt_pk_bf16_f32 v112, v120, v121
    v_cvt_pk_bf16_f32 v113, v122, v123
    v_cvt_pk_bf16_f32 v114, v124, v125
    v_cvt_pk_bf16_f32 v115, v126, v127
    s_add_u32 s57, s56, 0
    buffer_store_dwordx4 v[112:115], v252, s[20:23], s57 offen offset:0 sc1
    v_pk_mul_f32 v[200:201], v[128:129], v[128:129]
    v_pk_mul_f32 v[202:203], v[130:131], v[130:131]
    v_pk_mul_f32 v[204:205], v[132:133], v[132:133]
    v_pk_mul_f32 v[206:207], v[134:135], v[134:135]
    v_pk_fma_f32 v[200:201], v[200:201], s[84:85], v[250:251]
    v_pk_fma_f32 v[202:203], v[202:203], s[84:85], v[250:251]
    v_pk_fma_f32 v[204:205], v[204:205], s[84:85], v[250:251]
    v_pk_fma_f32 v[206:207], v[206:207], s[84:85], v[250:251]
    s_add_u32 m0, s61, 10240
    s_add_u32 s46, s77, 57344
    buffer_load_dwordx4 v15, s[24:27], s46 offen  lds
    v_pk_mul_f32 v[200:201], v[200:201], v[128:129]
    v_pk_mul_f32 v[202:203], v[202:203], v[130:131]
    v_pk_mul_f32 v[204:205], v[204:205], v[132:133]
    v_pk_mul_f32 v[206:207], v[206:207], v[134:135]
    v_exp_f32 v200, v200
    v_exp_f32 v201, v201
    v_exp_f32 v202, v202
    v_exp_f32 v203, v203
    buffer_load_dwordx4 v1, s[24:27], s46 offen offset:1024  lds
    v_exp_f32 v204, v204
    v_exp_f32 v205, v205
    v_exp_f32 v206, v206
    v_exp_f32 v207, v207
    v_pk_mul_f32 v[136:137], v[136:137], v[128:129]
    v_pk_mul_f32 v[138:139], v[138:139], v[130:131]
    v_pk_mul_f32 v[140:141], v[140:141], v[132:133]
    v_pk_mul_f32 v[142:143], v[142:143], v[134:135]
    ds_read_b64_tr_b16 a[224:225], v244 offset:0
    ds_read_b64_tr_b16 a[226:227], v244 offset:1024
    ds_read_b64_tr_b16 a[228:229], v245 offset:0
    ds_read_b64_tr_b16 a[230:231], v245 offset:1024
    v_pk_add_f32 v[200:201], v[200:201], 1.0 op_sel_hi:[1,0]
    v_pk_add_f32 v[202:203], v[202:203], 1.0 op_sel_hi:[1,0]
    v_pk_add_f32 v[204:205], v[204:205], 1.0 op_sel_hi:[1,0]
    v_pk_add_f32 v[206:207], v[206:207], 1.0 op_sel_hi:[1,0]
    v_rcp_f32 v200, v200
    v_rcp_f32 v201, v201
    v_rcp_f32 v202, v202
    v_rcp_f32 v203, v203
    s_add_u32 m0, s61, 12288
    s_nop 0
    buffer_load_dwordx4 v15, s[24:27], s64 offen  lds
    v_rcp_f32 v204, v204
    v_rcp_f32 v205, v205
    v_rcp_f32 v206, v206
    v_rcp_f32 v207, v207
    v_pk_mul_f32 v[136:137], v[136:137], v[200:201]
    v_pk_mul_f32 v[138:139], v[138:139], v[202:203]
    v_pk_mul_f32 v[140:141], v[140:141], v[204:205]
    v_pk_mul_f32 v[142:143], v[142:143], v[206:207]
    buffer_load_dwordx4 v1, s[24:27], s64 offen offset:1024  lds
    v_cvt_pk_bf16_f32 v128, v136, v137
    v_cvt_pk_bf16_f32 v129, v138, v139
    v_cvt_pk_bf16_f32 v130, v140, v141
    v_cvt_pk_bf16_f32 v131, v142, v143
    buffer_store_dwordx4 v[128:131], v252, s[20:23], s57 offen offset:2048 sc1
    s_waitcnt lgkmcnt(12)
    v_mfma_f32_32x32x16_bf16 v[112:127], v[24:27], v[16:19], v[212:227]
    v_mfma_f32_32x32x16_bf16 v[112:127], v[28:31], v[20:23], v[112:127]
    v_mfma_f32_32x32x16_bf16 v[128:143], v[72:75], v[64:67], v[212:227]
    v_mfma_f32_32x32x16_bf16 v[128:143], v[76:79], v[68:71], v[128:143]
    v_pk_mul_f32 v[200:201], v[144:145], v[144:145]
    v_pk_mul_f32 v[202:203], v[146:147], v[146:147]
    v_pk_mul_f32 v[204:205], v[148:149], v[148:149]
    v_pk_mul_f32 v[206:207], v[150:151], v[150:151]
    v_pk_fma_f32 v[200:201], v[200:201], s[84:85], v[250:251]
    v_pk_fma_f32 v[202:203], v[202:203], s[84:85], v[250:251]
    v_pk_fma_f32 v[204:205], v[204:205], s[84:85], v[250:251]
    v_pk_fma_f32 v[206:207], v[206:207], s[84:85], v[250:251]
    s_waitcnt vmcnt(24)
    ds_read_b64_tr_b16 a[232:233], v244 offset:2048
    ds_read_b64_tr_b16 a[234:235], v244 offset:3072
    ds_read_b64_tr_b16 a[236:237], v245 offset:2048
    ds_read_b64_tr_b16 a[238:239], v245 offset:3072
    v_pk_mul_f32 v[200:201], v[200:201], v[144:145]
    v_pk_mul_f32 v[202:203], v[202:203], v[146:147]
    v_pk_mul_f32 v[204:205], v[204:205], v[148:149]
    v_pk_mul_f32 v[206:207], v[206:207], v[150:151]
    v_exp_f32 v200, v200
    v_exp_f32 v201, v201
    v_exp_f32 v202, v202
    v_exp_f32 v203, v203
    s_add_u32 m0, s61, 14336
    s_add_u32 s46, s64, 14336
    buffer_load_dwordx4 v15, s[24:27], s46 offen  lds
    v_exp_f32 v204, v204
    v_exp_f32 v205, v205
    v_exp_f32 v206, v206
    v_exp_f32 v207, v207
    v_pk_mul_f32 v[152:153], v[152:153], v[144:145]
    v_pk_mul_f32 v[154:155], v[154:155], v[146:147]
    v_pk_mul_f32 v[156:157], v[156:157], v[148:149]
    v_pk_mul_f32 v[158:159], v[158:159], v[150:151]
    buffer_load_dwordx4 v1, s[24:27], s46 offen offset:1024  lds
    v_pk_add_f32 v[200:201], v[200:201], 1.0 op_sel_hi:[1,0]
    v_pk_add_f32 v[202:203], v[202:203], 1.0 op_sel_hi:[1,0]
    v_pk_add_f32 v[204:205], v[204:205], 1.0 op_sel_hi:[1,0]
    v_pk_add_f32 v[206:207], v[206:207], 1.0 op_sel_hi:[1,0]
    v_rcp_f32 v200, v200
    v_rcp_f32 v201, v201
    v_rcp_f32 v202, v202
    v_rcp_f32 v203, v203
    s_waitcnt vmcnt(24)
    ds_read_b64_tr_b16 a[240:241], v244 offset:4096
    ds_read_b64_tr_b16 a[242:243], v244 offset:5120
    ds_read_b64_tr_b16 a[244:245], v245 offset:4096
    ds_read_b64_tr_b16 a[246:247], v245 offset:5120
    v_rcp_f32 v204, v204
    v_rcp_f32 v205, v205
    v_rcp_f32 v206, v206
    v_rcp_f32 v207, v207
    v_pk_mul_f32 v[152:153], v[152:153], v[200:201]
    v_pk_mul_f32 v[154:155], v[154:155], v[202:203]
    v_pk_mul_f32 v[156:157], v[156:157], v[204:205]
    v_pk_mul_f32 v[158:159], v[158:159], v[206:207]
    s_add_u32 m0, s61, 16384
    s_add_u32 s46, s64, 28672
    buffer_load_dwordx4 v15, s[24:27], s46 offen  lds
    v_cvt_pk_bf16_f32 v144, v152, v153
    v_cvt_pk_bf16_f32 v145, v154, v155
    v_cvt_pk_bf16_f32 v146, v156, v157
    v_cvt_pk_bf16_f32 v147, v158, v159
    s_add_u32 s57, s56, 4096
    buffer_store_dwordx4 v[144:147], v252, s[20:23], s57 offen offset:0 sc1
    v_max3_f32 v200, v228, v229, v230
    v_max3_f32 v201, v231, v232, v233
    v_max3_f32 v200, v200, v234, v235
    v_max3_f32 v201, v201, v236, v237
    v_max3_f32 v200, v200, v238, v239
    v_max3_f32 v201, v201, v240, v241
    v_max3_f32 v200, v200, v242, v243
    v_max3_f32 v201, v201, v124, v125
    v_max3_f32 v200, v200, v126, v127
    v_max_f32 v200, v200, v201
    buffer_load_dwordx4 v1, s[24:27], s46 offen offset:1024  lds
    v_mov_b32 v201, v200
    s_nop 1
    v_permlane32_swap_b32 v200, v201
    v_max_f32 v200, v200, v201
    v_mul_f32 v200, 0xbe8b97f6, v200
    v_pk_fma_f32 v[228:229], v[228:229], s[86:87], v[200:201] op_sel_hi:[1,1,0]
    v_pk_fma_f32 v[230:231], v[230:231], s[86:87], v[200:201] op_sel_hi:[1,1,0]
    v_pk_fma_f32 v[232:233], v[232:233], s[86:87], v[200:201] op_sel_hi:[1,1,0]
    v_pk_fma_f32 v[234:235], v[234:235], s[86:87], v[200:201] op_sel_hi:[1,1,0]
    v_pk_fma_f32 v[236:237], v[236:237], s[86:87], v[200:201] op_sel_hi:[1,1,0]
    v_pk_fma_f32 v[238:239], v[238:239], s[86:87], v[200:201] op_sel_hi:[1,1,0]
    v_pk_fma_f32 v[240:241], v[240:241], s[86:87], v[200:201] op_sel_hi:[1,1,0]
    v_pk_fma_f32 v[242:243], v[242:243], s[86:87], v[200:201] op_sel_hi:[1,1,0]
    v_pk_fma_f32 v[124:125], v[124:125], s[86:87], v[200:201] op_sel_hi:[1,1,0]
    v_pk_fma_f32 v[126:127], v[126:127], s[86:87], v[200:201] op_sel_hi:[1,1,0]
    s_waitcnt vmcnt(25)
    ds_read_b64_tr_b16 a[248:249], v244 offset:6144
    ds_read_b64_tr_b16 a[250:251], v244 offset:7168
    ds_read_b64_tr_b16 a[252:253], v245 offset:6144
    ds_read_b64_tr_b16 a[254:255], v245 offset:7168
    v_exp_f32 v228, v228
    v_exp_f32 v229, v229
    v_exp_f32 v230, v230
    v_exp_f32 v231, v231
    v_exp_f32 v232, v232
    s_add_u32 m0, s61, 18432
    s_add_u32 s46, s64, 43008
    buffer_load_dwordx4 v15, s[24:27], s46 offen  lds
    v_exp_f32 v233, v233
    v_exp_f32 v234, v234
    v_exp_f32 v235, v235
    v_exp_f32 v236, v236
    v_exp_f32 v237, v237
    buffer_load_dwordx4 v1, s[24:27], s46 offen offset:1024  lds
    v_exp_f32 v238, v238
    v_exp_f32 v239, v239
    v_exp_f32 v240, v240
    v_exp_f32 v241, v241
    v_exp_f32 v242, v242
    s_waitcnt vmcnt(25)
    ds_read_b64_tr_b16 a[0:1], v244 offset:8192
    ds_read_b64_tr_b16 a[2:3], v244 offset:9216
    ds_read_b64_tr_b16 a[4:5], v245 offset:8192
    ds_read_b64_tr_b16 a[6:7], v245 offset:9216
    v_exp_f32 v243, v243
    v_exp_f32 v124, v124
    v_exp_f32 v125, v125
    v_exp_f32 v126, v126
    v_exp_f32 v127, v127
    s_waitcnt lgkmcnt(15)
    s_add_u32 m0, s60, 12288
    s_nop 0
    buffer_load_dwordx4 v15, s[28:31], s66 offen  lds
    v_pk_add_f32 v[202:203], v[228:229], v[230:231]
    v_pk_add_f32 v[204:205], v[232:233], v[234:235]
    v_pk_add_f32 v[202:203], v[202:203], v[236:237]
    v_pk_add_f32 v[204:205], v[204:205], v[238:239]
    v_pk_add_f32 v[202:203], v[202:203], v[240:241]
    v_pk_add_f32 v[204:205], v[204:205], v[242:243]
    v_pk_add_f32 v[202:203], v[202:203], v[124:125]
    v_pk_add_f32 v[204:205], v[204:205], v[126:127]
    buffer_load_dwordx4 v1, s[28:31], s66 offen offset:1024  lds
    v_cvt_pk_bf16_f32 v228, v228, v229
    v_cvt_pk_bf16_f32 v229, v230, v231
    v_cvt_pk_bf16_f32 v230, v232, v233
    v_cvt_pk_bf16_f32 v231, v234, v235
    v_cvt_pk_bf16_f32 v232, v236, v237
    v_cvt_pk_bf16_f32 v233, v238, v239
    v_cvt_pk_bf16_f32 v234, v240, v241
    v_cvt_pk_bf16_f32 v235, v242, v243
    v_cvt_pk_bf16_f32 v46, v124, v125
    v_cvt_pk_bf16_f32 v47, v126, v127
    v_pk_add_f32 v[202:203], v[202:203], v[204:205]
    v_add_f32 v202, v202, v203
    v_mfma_f32_32x32x16_bf16 v[112:127], v[48:51], v[228:231], 0
    v_mov_b32 v203, v202
    v_mfma_f32_32x32x16_bf16 v[112:127], v[52:55], v[232:235], v[112:127]
    s_nop 0
    v_permlane32_swap_b32 v202, v203
    v_mfma_f32_32x32x16_bf16 v[112:127], v[54:57], v[44:47], v[112:127]
    v_add_f32 v202, v202, v203
    v_rcp_f32 v192, v202
    v_mov_b32 v14, s69
    v_writelane_b32 v14, s70, 1
    v_writelane_b32 v14, s71, 2
    v_writelane_b32 v14, s72, 3
    v_xor_b32 v249, 0x400, v254
    s_mov_b32 s50, s49
    v_max3_f32 v200, v176, v177, v178
    v_max3_f32 v201, v179, v180, v181
    v_max3_f32 v200, v200, v182, v183
    v_max3_f32 v201, v201, v184, v185
    v_max3_f32 v200, v200, v186, v187
    v_max3_f32 v201, v201, v188, v189
    v_max3_f32 v200, v200, v190, v191
    v_max3_f32 v201, v201, v140, v141
    v_max3_f32 v200, v200, v142, v143
    v_max_f32 v200, v200, v201
    s_waitcnt vmcnt(25)
    ds_read_b64_tr_b16 a[8:9], v244 offset:10240
    ds_read_b64_tr_b16 a[10:11], v244 offset:11264
    ds_read_b64_tr_b16 a[12:13], v245 offset:10240
    ds_read_b64_tr_b16 a[14:15], v245 offset:11264
    v_mov_b32 v201, v200
    s_nop 1
    v_permlane32_swap_b32 v200, v201
    v_max_f32 v200, v200, v201
    v_mul_f32 v200, 0xbe8b97f6, v200
    v_pk_fma_f32 v[176:177], v[176:177], s[86:87], v[200:201] op_sel_hi:[1,1,0]
    v_pk_fma_f32 v[178:179], v[178:179], s[86:87], v[200:201] op_sel_hi:[1,1,0]
    v_pk_fma_f32 v[180:181], v[180:181], s[86:87], v[200:201] op_sel_hi:[1,1,0]
    v_pk_fma_f32 v[182:183], v[182:183], s[86:87], v[200:201] op_sel_hi:[1,1,0]
    v_pk_fma_f32 v[184:185], v[184:185], s[86:87], v[200:201] op_sel_hi:[1,1,0]
    v_pk_fma_f32 v[186:187], v[186:187], s[86:87], v[200:201] op_sel_hi:[1,1,0]
    v_pk_fma_f32 v[188:189], v[188:189], s[86:87], v[200:201] op_sel_hi:[1,1,0]
    v_pk_fma_f32 v[190:191], v[190:191], s[86:87], v[200:201] op_sel_hi:[1,1,0]
    v_pk_fma_f32 v[140:141], v[140:141], s[86:87], v[200:201] op_sel_hi:[1,1,0]
    v_pk_fma_f32 v[142:143], v[142:143], s[86:87], v[200:201] op_sel_hi:[1,1,0]
    s_add_u32 m0, s60, 14336
    s_add_u32 s46, s66, 14336
    buffer_load_dwordx4 v15, s[28:31], s46 offen  lds
    v_exp_f32 v176, v176
    v_exp_f32 v177, v177
    v_exp_f32 v178, v178
    v_exp_f32 v179, v179
    v_exp_f32 v180, v180
    buffer_load_dwordx4 v1, s[28:31], s46 offen offset:1024  lds
    v_exp_f32 v181, v181
    v_exp_f32 v182, v182
    v_exp_f32 v183, v183
    v_exp_f32 v184, v184
    v_exp_f32 v185, v185
    s_waitcnt vmcnt(25)
    ds_read_b64_tr_b16 a[16:17], v246 offset:0
    ds_read_b64_tr_b16 a[18:19], v246 offset:1024
    ds_read_b64_tr_b16 a[20:21], v247 offset:0
    ds_read_b64_tr_b16 a[22:23], v247 offset:1024
    v_exp_f32 v186, v186
    v_exp_f32 v187, v187
    v_exp_f32 v188, v188
    v_exp_f32 v189, v189
    v_exp_f32 v190, v190
    s_add_u32 m0, s60, 0
    s_add_u32 s46, s66, 25088
    buffer_load_dwordx4 v15, s[28:31], s46 offen  lds
    v_exp_f32 v191, v191
    v_exp_f32 v140, v140
    v_exp_f32 v141, v141
    v_exp_f32 v142, v142
    v_exp_f32 v143, v143
    buffer_load_dwordx4 v1, s[28:31], s46 offen offset:1024  lds
    v_pk_add_f32 v[202:203], v[176:177], v[178:179]
    v_pk_add_f32 v[204:205], v[180:181], v[182:183]
    v_pk_add_f32 v[202:203], v[202:203], v[184:185]
    v_pk_add_f32 v[204:205], v[204:205], v[186:187]
    v_pk_add_f32 v[202:203], v[202:203], v[188:189]
    v_pk_add_f32 v[204:205], v[204:205], v[190:191]
    v_pk_add_f32 v[202:203], v[202:203], v[140:141]
    v_pk_add_f32 v[204:205], v[204:205], v[142:143]
    s_waitcnt vmcnt(25)
    ds_read_b64_tr_b16 a[24:25], v246 offset:2048
    ds_read_b64_tr_b16 a[26:27], v246 offset:3072
    ds_read_b64_tr_b16 a[28:29], v247 offset:2048
    ds_read_b64_tr_b16 a[30:31], v247 offset:3072
    v_cvt_pk_bf16_f32 v176, v176, v177
    v_cvt_pk_bf16_f32 v177, v178, v179
    v_cvt_pk_bf16_f32 v178, v180, v181
    v_cvt_pk_bf16_f32 v179, v182, v183
    v_cvt_pk_bf16_f32 v180, v184, v185
    v_cvt_pk_bf16_f32 v181, v186, v187
    v_cvt_pk_bf16_f32 v182, v188, v189
    v_cvt_pk_bf16_f32 v183, v190, v191
    v_cvt_pk_bf16_f32 v94, v140, v141
    v_cvt_pk_bf16_f32 v95, v142, v143
    v_pk_add_f32 v[202:203], v[202:203], v[204:205]
    v_add_f32 v202, v202, v203
    v_mfma_f32_32x32x16_bf16 v[128:143], v[96:99], v[176:179], 0
    v_mov_b32 v203, v202
    v_mfma_f32_32x32x16_bf16 v[128:143], v[100:103], v[180:183], v[128:143]
    s_nop 0
    v_permlane32_swap_b32 v202, v203
    v_mfma_f32_32x32x16_bf16 v[128:143], v[102:105], v[92:95], v[128:143]
    v_add_f32 v202, v202, v203
    v_rcp_f32 v194, v202
    buffer_load_dword v13, v253, s[20:23], s50 offen sc1
    v_pk_mul_f32 v[112:113], v[112:113], v[192:193] op_sel_hi:[1,0]
    v_pk_mul_f32 v[114:115], v[114:115], v[192:193] op_sel_hi:[1,0]
    v_pk_mul_f32 v[116:117], v[116:117], v[192:193] op_sel_hi:[1,0]
    v_pk_mul_f32 v[118:119], v[118:119], v[192:193] op_sel_hi:[1,0]
    v_pk_mul_f32 v[120:121], v[120:121], v[192:193] op_sel_hi:[1,0]
    v_pk_mul_f32 v[122:123], v[122:123], v[192:193] op_sel_hi:[1,0]
    v_pk_mul_f32 v[124:125], v[124:125], v[192:193] op_sel_hi:[1,0]
    v_pk_mul_f32 v[126:127], v[126:127], v[192:193] op_sel_hi:[1,0]
    s_waitcnt lgkmcnt(15)
    s_add_u32 m0, s60, 2048
    s_add_u32 s46, s66, 39424
    buffer_load_dwordx4 v15, s[28:31], s46 offen  lds
    v_cvt_pk_bf16_f32 v16, v112, v113
    v_cvt_pk_bf16_f32 v17, v114, v115
    v_cvt_pk_bf16_f32 v18, v116, v117
    v_cvt_pk_bf16_f32 v19, v118, v119
    v_cvt_pk_bf16_f32 v20, v120, v121
    v_cvt_pk_bf16_f32 v21, v122, v123
    v_cvt_pk_bf16_f32 v22, v124, v125
    v_cvt_pk_bf16_f32 v23, v126, v127
    s_mov_b32 exec_lo, 0
    v_mov_b32 v22, 0
    v_mov_b32 v23, 0
    s_mov_b32 exec_lo, -1
    s_add_u32 s57, s56, 8192
    buffer_store_dwordx4 v[16:19], v252, s[20:23], s57 offen offset:0 sc1
    buffer_store_dwordx4 v[20:23], v252, s[20:23], s57 offen offset:2048 sc1
    s_add_u32 s57, s56, 4096
    v_pk_mul_f32 v[200:201], v[160:161], v[160:161]
    v_pk_mul_f32 v[202:203], v[162:163], v[162:163]
    v_pk_mul_f32 v[204:205], v[164:165], v[164:165]
    v_pk_mul_f32 v[206:207], v[166:167], v[166:167]
    v_pk_fma_f32 v[200:201], v[200:201], s[84:85], v[250:251]
    v_pk_fma_f32 v[202:203], v[202:203], s[84:85], v[250:251]
    v_pk_fma_f32 v[204:205], v[204:205], s[84:85], v[250:251]
    v_pk_fma_f32 v[206:207], v[206:207], s[84:85], v[250:251]
    buffer_load_dwordx4 v1, s[28:31], s46 offen offset:1024  lds
    v_pk_mul_f32 v[200:201], v[200:201], v[160:161]
    v_pk_mul_f32 v[202:203], v[202:203], v[162:163]
    v_pk_mul_f32 v[204:205], v[204:205], v[164:165]
    v_pk_mul_f32 v[206:207], v[206:207], v[166:167]
    v_exp_f32 v200, v200
    v_exp_f32 v201, v201
    v_exp_f32 v202, v202
    v_exp_f32 v203, v203
    s_waitcnt vmcnt(28)
    ds_read_b64_tr_b16 a[32:33], v246 offset:4096
    ds_read_b64_tr_b16 a[34:35], v246 offset:5120
    ds_read_b64_tr_b16 a[36:37], v247 offset:4096
    ds_read_b64_tr_b16 a[38:39], v247 offset:5120
    v_exp_f32 v204, v204
    v_exp_f32 v205, v205
    v_exp_f32 v206, v206
    v_exp_f32 v207, v207
    v_pk_mul_f32 v[168:169], v[168:169], v[160:161]
    v_pk_mul_f32 v[170:171], v[170:171], v[162:163]
    v_pk_mul_f32 v[172:173], v[172:173], v[164:165]
    v_pk_mul_f32 v[174:175], v[174:175], v[166:167]
    s_add_u32 m0, s60, 4096
    s_nop 0
    buffer_load_dwordx4 v15, s[24:27], s65 offen  lds
    v_pk_add_f32 v[200:201], v[200:201], 1.0 op_sel_hi:[1,0]
    v_pk_add_f32 v[202:203], v[202:203], 1.0 op_sel_hi:[1,0]
    v_pk_add_f32 v[204:205], v[204:205], 1.0 op_sel_hi:[1,0]
    v_pk_add_f32 v[206:207], v[206:207], 1.0 op_sel_hi:[1,0]
    v_rcp_f32 v200, v200
    v_rcp_f32 v201, v201
    v_rcp_f32 v202, v202
    v_rcp_f32 v203, v203
    buffer_load_dwordx4 v1, s[24:27], s65 offen offset:1024  lds
    v_rcp_f32 v204, v204
    v_rcp_f32 v205, v205
    v_rcp_f32 v206, v206
    v_rcp_f32 v207, v207
    v_pk_mul_f32 v[168:169], v[168:169], v[200:201]
    v_pk_mul_f32 v[170:171], v[170:171], v[202:203]
    v_pk_mul_f32 v[172:173], v[172:173], v[204:205]
    v_pk_mul_f32 v[174:175], v[174:175], v[206:207]
    s_waitcnt vmcnt(28)
    ds_read_b64_tr_b16 a[40:41], v246 offset:6144
    ds_read_b64_tr_b16 a[42:43], v246 offset:7168
    ds_read_b64_tr_b16 a[44:45], v247 offset:6144
    ds_read_b64_tr_b16 a[46:47], v247 offset:7168
    v_cvt_pk_bf16_f32 v160, v168, v169
    v_cvt_pk_bf16_f32 v161, v170, v171
    v_cvt_pk_bf16_f32 v162, v172, v173
    v_cvt_pk_bf16_f32 v163, v174, v175
    buffer_store_dwordx4 v[160:163], v252, s[20:23], s57 offen offset:2048 sc1
    s_cmp_ge_u32 s44, 28
    s_cbranch_scc1 L_pollFB_ok
    s_waitcnt vmcnt(7)
    s_mov_b32 s91, 0
    v_cmp_ne_u32 vcc, v13, v14
    s_and_b32 s57, vcc_lo, 3
    s_cmp_eq_u32 s57, 3
    s_cbranch_scc1 L_pollFB_ok
L_pollFB:
    s_sleep 1
    buffer_load_dword v13, v253, s[20:23], s50 offen sc1
    s_add_u32 s91, s91, 1
    s_waitcnt vmcnt(0)
    v_cmp_ne_u32 vcc, v13, v14
    s_and_b32 s57, vcc_lo, 3
    s_cmp_eq_u32 s57, 3
    s_cbranch_scc1 L_pollFB_ok
    s_and_b32 s57, s91, 63
    s_cmp_lg_u32 s57, 0
    s_cbranch_scc1 L_pollFB
    v_lshrrev_b32 v13, 7, v253
    v_lshlrev_b32 v13, 2, v13
    buffer_load_dword v13, v13, s[36:39], 0 offen sc1
    s_waitcnt vmcnt(0)
    v_readfirstlane_b32 vcc_lo, v13
    s_and_b32 s57, vcc_lo, 3
    s_cmp_eq_u32 s57, 3
    s_cbranch_scc1 L_pollFB_ok
    s_cmp_lt_u32 s91, 0x40000
    s_cbranch_scc1 L_pollFB
L_pollFB_ok:
    s_and_b32 s90, vcc_lo, 15
    s_cmp_eq_u32 s90, 15
    s_cselect_b32 s51, 0x40000000, s49
    v_pk_mul_f32 v[128:129], v[128:129], v[194:195] op_sel_hi:[1,0]
    v_pk_mul_f32 v[130:131], v[130:131], v[194:195] op_sel_hi:[1,0]
    v_pk_mul_f32 v[132:133], v[132:133], v[194:195] op_sel_hi:[1,0]
    v_pk_mul_f32 v[134:135], v[134:135], v[194:195] op_sel_hi:[1,0]
    v_pk_mul_f32 v[136:137], v[136:137], v[194:195] op_sel_hi:[1,0]
    v_pk_mul_f32 v[138:139], v[138:139], v[194:195] op_sel_hi:[1,0]
    v_pk_mul_f32 v[140:141], v[140:141], v[194:195] op_sel_hi:[1,0]
    v_pk_mul_f32 v[142:143], v[142:143], v[194:195] op_sel_hi:[1,0]
    buffer_load_dwordx4 a[56:59], v254, s[20:23], s78 offen offset:0 sc1
    v_cvt_pk_bf16_f32 v64, v128, v129
    v_cvt_pk_bf16_f32 v65, v130, v131
    v_cvt_pk_bf16_f32 v66, v132, v133
    v_cvt_pk_bf16_f32 v67, v134, v135
    v_cvt_pk_bf16_f32 v68, v136, v137
    v_cvt_pk_bf16_f32 v69, v138, v139
    v_cvt_pk_bf16_f32 v70, v140, v141
    v_cvt_pk_bf16_f32 v71, v142, v143
    s_mov_b32 exec_lo, 0
    v_mov_b32 v70, 0
    v_mov_b32 v71, 0
    s_mov_b32 exec_lo, -1
    s_add_u32 s57, s56, 12288
    buffer_store_dwordx4 v[64:67], v252, s[20:23], s57 offen offset:0 sc1
    buffer_store_dwordx4 v[68:71], v252, s[20:23], s57 offen offset:2048 sc1
    s_cmp_ge_u32 s44, 28
    s_cbranch_scc1 L_nophase2
    buffer_load_dwordx4 a[60:63], v249, s[20:23], s78 offen offset:0 sc1
    buffer_load_dwordx4 a[64:67], v254, s[20:23], s78 offen offset:2048 sc1
    buffer_load_dwordx4 a[68:71], v249, s[20:23], s78 offen offset:2048 sc1
    s_add_u32 s68, s78, 4096
    buffer_load_dwordx4 a[72:75], v254, s[20:23], s68 offen offset:0 sc1
    buffer_load_dwordx4 a[76:79], v249, s[20:23], s68 offen offset:0 sc1
    buffer_load_dwordx4 a[80:83], v254, s[20:23], s68 offen offset:2048 sc1
    buffer_load_dwordx4 a[84:87], v249, s[20:23], s68 offen offset:2048 sc1
    s_add_u32 m0, s60, 6144
    s_add_u32 s46, s65, 14336
    buffer_load_dwordx4 v15, s[24:27], s46 offen  lds
    buffer_load_dwordx4 v1, s[24:27], s46 offen offset:1024  lds
    s_waitcnt lgkmcnt(15)
    s_add_u32 m0, s60, 8192
    s_add_u32 s46, s65, 28672
    buffer_load_dwordx4 v15, s[24:27], s46 offen  lds
    buffer_load_dwordx4 v1, s[24:27], s46 offen offset:1024  lds
    s_add_u32 m0, s60, 10240
    s_add_u32 s46, s65, 43008
    buffer_load_dwordx4 v15, s[24:27], s46 offen  lds
    buffer_load_dwordx4 v1, s[24:27], s46 offen offset:1024  lds
L_join:
    s_cmp_lt_u32 s41, 2
    s_cbranch_scc1 L_pubdone
    s_waitcnt vmcnt(13)
    s_barrier
    s_cmp_lg_u32 s3, 0
    s_cbranch_scc1 L_noflag_B
    s_lshl_b32 s57, s40, 2
    s_add_u32 s57, s57, s42
    s_lshl_b32 s58, s57, 5
    s_add_u32 s58, s58, s41
    s_lshl_b32 s58, s58, 2
    s_add_u32 s58, s58, 9437184
    s_add_u32 s59, s73, 1
    s_mov_b64 exec, 1
    v_mov_b32 v5, s59
    v_mov_b32 v6, 0
    buffer_store_dword v5, v6, s[20:23], s58 offen sc1
    s_lshl_b32 s57, s57, 2
    s_lshl_b32 s58, 1, s41
    v_mov_b32 v7, s58
    buffer_atomic_or v7, v6, s[36:39], s57 offen sc1
    s_mov_b64 exec, -1
L_noflag_B:
L_pubdone:
    s_waitcnt vmcnt(6)
    v_mfma_f32_32x32x16_bf16 v[32:47], a[160:163], a[60:63], 0
    s_waitcnt lgkmcnt(12)
    s_add_u32 m0, s61, 0
    s_nop 0
    buffer_load_dwordx4 v15, s[28:31], s67 offen  lds
    v_mfma_f32_32x32x16_bf16 v[48:63], a[164:167], a[56:59], 0
    s_add_u32 s68, s78, 8192
    buffer_load_dwordx4 a[88:91], v254, s[20:23], s68 offen offset:0 sc1
    v_mfma_f32_32x32x16_bf16 v[64:79], a[164:167], a[60:63], 0
    buffer_load_dwordx4 a[92:95], v249, s[20:23], s68 offen offset:0 sc1
    buffer_load_dwordx4 a[96:99], v254, s[20:23], s79 offen offset:0 sc1
    v_mfma_f32_32x32x16_bf16 v[16:31], a[160:163], a[56:59], 0
    buffer_load_dwordx4 a[100:103], v249, s[20:23], s79 offen offset:0 sc1
    s_waitcnt vmcnt(9)
    v_mfma_f32_32x32x16_bf16 v[32:47], a[168:171], a[68:71], v[32:47]
    buffer_load_dwordx4 v1, s[28:31], s67 offen offset:1024  lds
    v_mfma_f32_32x32x16_bf16 v[48:63], a[172:175], a[64:67], v[48:63]
    buffer_load_dwordx4 a[104:107], v254, s[20:23], s79 offen offset:2048 sc1
    buffer_load_dwordx4 a[108:111], v249, s[20:23], s79 offen offset:2048 sc1
    v_mfma_f32_32x32x16_bf16 v[64:79], a[172:175], a[68:71], v[64:79]
    s_add_u32 s68, s79, 4096
    buffer_load_dwordx4 a[112:115], v254, s[20:23], s68 offen offset:0 sc1
    v_mfma_f32_32x32x16_bf16 v[16:31], a[168:171], a[64:67], v[16:31]
    buffer_load_dwordx4 a[116:119], v249, s[20:23], s68 offen offset:0 sc1
    s_waitcnt vmcnt(12)
    v_mfma_f32_32x32x16_bf16 v[32:47], a[176:179], a[76:79], v[32:47]
    s_waitcnt lgkmcnt(8)
    s_add_u32 m0, s61, 2048
    s_add_u32 s46, s67, 14336
    v_mfma_f32_32x32x16_bf16 v[48:63], a[180:183], a[72:75], v[48:63]
    buffer_load_dwordx4 v15, s[28:31], s46 offen  lds
    buffer_load_dwordx4 a[120:123], v254, s[20:23], s68 offen offset:2048 sc1
    buffer_load_dwordx4 a[124:127], v249, s[20:23], s68 offen offset:2048 sc1
    v_mfma_f32_32x32x16_bf16 v[64:79], a[180:183], a[76:79], v[64:79]
    s_add_u32 s68, s79, 8192
    buffer_load_dwordx4 a[128:131], v254, s[20:23], s68 offen offset:0 sc1
    v_mfma_f32_32x32x16_bf16 v[16:31], a[176:179], a[72:75], v[16:31]
    buffer_load_dwordx4 a[132:135], v249, s[20:23], s68 offen offset:0 sc1
    s_waitcnt vmcnt(15)
    v_mfma_f32_32x32x16_bf16 v[32:47], a[184:187], a[84:87], v[32:47]
    buffer_load_dwordx4 v1, s[28:31], s46 offen offset:1024  lds
    v_mfma_f32_32x32x16_bf16 v[48:63], a[188:191], a[80:83], v[48:63]
    buffer_load_dwordx4 a[136:139], v254, s[20:23], s80 offen offset:0 sc1
    v_mfma_f32_32x32x16_bf16 v[64:79], a[188:191], a[84:87], v[64:79]
    buffer_load_dwordx4 a[140:143], v249, s[20:23], s80 offen offset:0 sc1
    v_mfma_f32_32x32x16_bf16 v[16:31], a[184:187], a[80:83], v[16:31]
    s_waitcnt vmcnt(15)
    v_mfma_f32_32x32x16_bf16 v[32:47], a[192:195], a[92:95], v[32:47]
    s_waitcnt lgkmcnt(4)
    s_add_u32 m0, s61, 4096
    s_add_u32 s46, s67, 25088
    v_mfma_f32_32x32x16_bf16 v[48:63], a[196:199], a[88:91], v[48:63]
    buffer_load_dwordx4 v15, s[28:31], s46 offen  lds
    buffer_load_dwordx4 a[144:147], v254, s[20:23], s80 offen offset:2048 sc1
    v_mfma_f32_32x32x16_bf16 v[64:79], a[196:199], a[92:95], v[64:79]
    buffer_load_dwordx4 a[148:151], v249, s[20:23], s80 offen offset:2048 sc1
    v_mfma_f32_32x32x16_bf16 v[16:31], a[192:195], a[88:91], v[16:31]
    s_waitcnt vmcnt(16)
    v_mfma_f32_32x32x16_bf16 v[32:47], a[200:203], a[100:103], v[32:47]
    buffer_load_dwordx4 v1, s[28:31], s46 offen offset:1024  lds
    v_mfma_f32_32x32x16_bf16 v[48:63], a[204:207], a[96:99], v[48:63]
    buffer_load_dword v11, v253, s[20:23], s51 offen sc1
    s_add_u32 s68, s80, 4096
    v_mfma_f32_32x32x16_bf16 v[64:79], a[204:207], a[100:103], v[64:79]
    buffer_load_dwordx4 a[152:155], v254, s[20:23], s68 offen offset:0 sc1
    buffer_load_dwordx4 a[156:159], v249, s[20:23], s68 offen offset:0 sc1
    v_mfma_f32_32x32x16_bf16 v[16:31], a[200:203], a[96:99], v[16:31]
    s_waitcnt vmcnt(17)
    v_mfma_f32_32x32x16_bf16 v[32:47], a[208:211], a[108:111], v[32:47]
    s_waitcnt lgkmcnt(0)
    s_add_u32 m0, s61, 6144
    s_add_u32 s46, s67, 39424
    v_mfma_f32_32x32x16_bf16 v[48:63], a[212:215], a[104:107], v[48:63]
    buffer_load_dwordx4 v15, s[28:31], s46 offen  lds
    buffer_load_dwordx4 a[56:59], v254, s[20:23], s68 offen offset:2048 sc1
    v_mfma_f32_32x32x16_bf16 v[64:79], a[212:215], a[108:111], v[64:79]
    buffer_load_dwordx4 a[60:63], v249, s[20:23], s68 offen offset:2048 sc1
    v_mfma_f32_32x32x16_bf16 v[16:31], a[208:211], a[104:107], v[16:31]
    s_lshl_b32 s58, s3, 11
    s_add_u32 s58, s58, 147968
    v_and_b32 v12, 31, v0
    v_lshlrev_b32 v12, 6, v12
    v_lshrrev_b32 v8, 5, v0
    v_lshl_add_u32 v12, v8, 3, v12
    v_add_u32 v12, s58, v12
    v_lshlrev_b32 v8, 4, v0
    v_add_u32 v8, s58, v8
    s_waitcnt vmcnt(18)
    v_mfma_f32_32x32x16_bf16 v[32:47], a[216:219], a[116:119], v[32:47]
    buffer_load_dwordx4 v1, s[28:31], s46 offen offset:1024  lds
    v_mfma_f32_32x32x16_bf16 v[48:63], a[220:223], a[112:115], v[48:63]
    s_add_u32 s68, s80, 8192
    v_mfma_f32_32x32x16_bf16 v[64:79], a[220:223], a[116:119], v[64:79]
    buffer_load_dwordx4 a[64:67], v254, s[20:23], s68 offen offset:0 sc1
    v_mfma_f32_32x32x16_bf16 v[16:31], a[216:219], a[112:115], v[16:31]
    buffer_load_dwordx4 a[68:71], v249, s[20:23], s68 offen offset:0 sc1
    ds_write_b128 v8, a[48:51] offset:0
    ds_write_b128 v8, a[52:55] offset:1024
    s_waitcnt vmcnt(18)
    v_mfma_f32_32x32x16_bf16 v[32:47], a[224:227], a[124:127], v[32:47]
    v_mfma_f32_32x32x16_bf16 v[48:63], a[228:231], a[120:123], v[48:63]
    buffer_load_dwordx4 a[72:75], v254, s[20:23], s81 offen offset:0 sc1
    v_mfma_f32_32x32x16_bf16 v[64:79], a[228:231], a[124:127], v[64:79]
    buffer_load_dwordx4 a[76:79], v249, s[20:23], s81 offen offset:0 sc1
    v_mfma_f32_32x32x16_bf16 v[16:31], a[224:227], a[120:123], v[16:31]
    s_waitcnt vmcnt(18)
    v_mfma_f32_32x32x16_bf16 v[32:47], a[232:235], a[132:135], v[32:47]
    v_mfma_f32_32x32x16_bf16 v[48:63], a[236:239], a[128:131], v[48:63]
    buffer_load_dwordx4 a[80:83], v254, s[20:23], s81 offen offset:2048 sc1
    v_mfma_f32_32x32x16_bf16 v[64:79], a[236:239], a[132:135], v[64:79]
    buffer_load_dwordx4 a[84:87], v249, s[20:23], s81 offen offset:2048 sc1
    v_mfma_f32_32x32x16_bf16 v[16:31], a[232:235], a[128:131], v[16:31]
    s_waitcnt lgkmcnt(0)
    ds_read_b64 v[88:89], v12 offset:0
    ds_read_b64 v[90:91], v12 offset:16
    ds_read_b64 v[92:93], v12 offset:32
    ds_read_b64 v[94:95], v12 offset:48
    s_waitcnt vmcnt(17)
    v_mfma_f32_32x32x16_bf16 v[32:47], a[240:243], a[140:143], v[32:47]
    v_mfma_f32_32x32x16_bf16 v[48:63], a[244:247], a[136:139], v[48:63]
    s_add_u32 s68, s81, 4096
    v_mfma_f32_32x32x16_bf16 v[64:79], a[244:247], a[140:143], v[64:79]
    buffer_load_dwordx4 a[88:91], v254, s[20:23], s68 offen offset:0 sc1
    v_mfma_f32_32x32x16_bf16 v[16:31], a[240:243], a[136:139], v[16:31]
    buffer_load_dwordx4 a[92:95], v249, s[20:23], s68 offen offset:0 sc1
    s_waitcnt vmcnt(16)
    v_mfma_f32_32x32x16_bf16 v[32:47], a[248:251], a[148:151], v[32:47]
    v_mfma_f32_32x32x16_bf16 v[48:63], a[252:255], a[144:147], v[48:63]
    buffer_load_dwordx4 a[96:99], v254, s[20:23], s68 offen offset:2048 sc1
    v_mfma_f32_32x32x16_bf16 v[64:79], a[252:255], a[148:151], v[64:79]
    buffer_load_dwordx4 a[100:103], v249, s[20:23], s68 offen offset:2048 sc1
    v_mfma_f32_32x32x16_bf16 v[16:31], a[248:251], a[144:147], v[16:31]
    s_waitcnt lgkmcnt(0)
    v_lshlrev_b32 v128, 16, v88
    v_and_b32 v129, s53, v88
    v_lshlrev_b32 v130, 16, v89
    v_and_b32 v131, s53, v89
    v_lshlrev_b32 v132, 16, v90
    v_and_b32 v133, s53, v90
    v_lshlrev_b32 v134, 16, v91
    v_and_b32 v135, s53, v91
    v_lshlrev_b32 v136, 16, v92
    v_and_b32 v137, s53, v92
    v_lshlrev_b32 v138, 16, v93
    v_and_b32 v139, s53, v93
    v_lshlrev_b32 v140, 16, v94
    v_and_b32 v141, s53, v94
    v_lshlrev_b32 v142, 16, v95
    v_and_b32 v143, s53, v95
    v_and_b32 v8, 32, v0
    v_lshrrev_b32 v8, 2, v8
    v_add_u32 v3, v248, v8
    s_waitcnt vmcnt(14)
    v_mfma_f32_32x32x16_bf16 v[32:47], a[0:3], a[156:159], v[32:47]
    v_mfma_f32_32x32x16_bf16 v[48:63], a[4:7], a[152:155], v[48:63]
    s_add_u32 s68, s81, 8192
    v_mfma_f32_32x32x16_bf16 v[64:79], a[4:7], a[156:159], v[64:79]
    buffer_load_dwordx4 a[104:107], v254, s[20:23], s68 offen offset:0 sc1
    v_mfma_f32_32x32x16_bf16 v[16:31], a[0:3], a[152:155], v[16:31]
    buffer_load_dwordx4 a[108:111], v249, s[20:23], s68 offen offset:0 sc1
    s_waitcnt vmcnt(13)
    v_mfma_f32_32x32x16_bf16 v[32:47], a[8:11], a[60:63], v[32:47]
    v_mfma_f32_32x32x16_bf16 v[48:63], a[12:15], a[56:59], v[48:63]
    s_cmp_eq_u32 s90, 15
    s_cbranch_scc1 L_pollB_ok
    s_mov_b32 s91, 0
    v_cmp_ne_u32 vcc, v11, v14
    s_and_b32 s57, vcc_lo, 15
    s_cmp_eq_u32 s57, 15
    s_cbranch_scc1 L_pollB_ok
L_pollB:
    s_sleep 1
    buffer_load_dword v11, v253, s[20:23], s50 offen sc1
    s_add_u32 s91, s91, 1
    s_waitcnt vmcnt(0)
    v_cmp_ne_u32 vcc, v11, v14
    s_and_b32 s57, vcc_lo, 15
    s_cmp_eq_u32 s57, 15
    s_cbranch_scc1 L_pollB_ok
    s_and_b32 s57, s91, 63
    s_cmp_lg_u32 s57, 0
    s_cbranch_scc1 L_pollB
    v_lshrrev_b32 v11, 7, v253
    v_lshlrev_b32 v11, 2, v11
    buffer_load_dword v11, v11, s[36:39], 0 offen sc1
    s_waitcnt vmcnt(0)
    v_readfirstlane_b32 vcc_lo, v11
    s_and_b32 s57, vcc_lo, 15
    s_cmp_eq_u32 s57, 15
    s_cbranch_scc1 L_pollB_ok
    s_cmp_lt_u32 s91, 0x40000
    s_cbranch_scc1 L_pollB
L_pollB_ok:
    v_mfma_f32_32x32x16_bf16 v[64:79], a[12:15], a[60:63], v[64:79]
    buffer_load_dwordx4 a[112:115], v254, s[20:23], s82 offen offset:0 sc1
    v_mfma_f32_32x32x16_bf16 v[16:31], a[8:11], a[56:59], v[16:31]
    buffer_load_dwordx4 a[116:119], v249, s[20:23], s82 offen offset:0 sc1
    s_waitcnt vmcnt(12)
    v_mfma_f32_32x32x16_bf16 v[32:47], a[16:19], a[68:71], v[32:47]
    v_mfma_f32_32x32x16_bf16 v[48:63], a[20:23], a[64:67], v[48:63]
    buffer_load_dwordx4 a[120:123], v254, s[20:23], s82 offen offset:2048 sc1
    v_mfma_f32_32x32x16_bf16 v[64:79], a[20:23], a[68:71], v[64:79]
    buffer_load_dwordx4 a[124:127], v249, s[20:23], s82 offen offset:2048 sc1
    v_mfma_f32_32x32x16_bf16 v[16:31], a[16:19], a[64:67], v[16:31]
    s_waitcnt vmcnt(12)
    v_mfma_f32_32x32x16_bf16 v[32:47], a[24:27], a[76:79], v[32:47]
    v_mfma_f32_32x32x16_bf16 v[48:63], a[28:31], a[72:75], v[48:63]
    s_add_u32 s68, s82, 4096
    v_mfma_f32_32x32x16_bf16 v[64:79], a[28:31], a[76:79], v[64:79]
    buffer_load_dwordx4 a[128:131], v254, s[20:23], s68 offen offset:0 sc1
    v_mfma_f32_32x32x16_bf16 v[16:31], a[24:27], a[72:75], v[16:31]
    buffer_load_dwordx4 a[132:135], v249, s[20:23], s68 offen offset:0 sc1
    s_waitcnt vmcnt(12)
    v_mfma_f32_32x32x16_bf16 v[32:47], a[32:35], a[84:87], v[32:47]
    ds_read_b64_tr_b16 v[112:113], v246 offset:8192
    ds_read_b64_tr_b16 v[114:115], v246 offset:9216
    v_mfma_f32_32x32x16_bf16 v[48:63], a[36:39], a[80:83], v[48:63]
    ds_read_b64_tr_b16 v[116:117], v247 offset:8192
    ds_read_b64_tr_b16 v[118:119], v247 offset:9216
    buffer_load_dwordx4 a[136:139], v254, s[20:23], s68 offen offset:2048 sc1
    v_mfma_f32_32x32x16_bf16 v[64:79], a[36:39], a[84:87], v[64:79]
    buffer_load_dwordx4 a[140:143], v249, s[20:23], s68 offen offset:2048 sc1
    v_mfma_f32_32x32x16_bf16 v[16:31], a[32:35], a[80:83], v[16:31]
    s_waitcnt vmcnt(12)
    v_mfma_f32_32x32x16_bf16 v[32:47], a[40:43], a[92:95], v[32:47]
    ds_read_b64_tr_b16 v[120:121], v246 offset:10240
    ds_read_b64_tr_b16 v[122:123], v246 offset:11264
    v_mfma_f32_32x32x16_bf16 v[48:63], a[44:47], a[88:91], v[48:63]
    ds_read_b64_tr_b16 v[124:125], v247 offset:10240
    ds_read_b64_tr_b16 v[126:127], v247 offset:11264
    s_add_u32 s68, s82, 8192
    v_mfma_f32_32x32x16_bf16 v[64:79], a[44:47], a[92:95], v[64:79]
    buffer_load_dwordx4 a[144:147], v254, s[20:23], s68 offen offset:0 sc1
    v_mfma_f32_32x32x16_bf16 v[16:31], a[40:43], a[88:91], v[16:31]
    buffer_load_dwordx4 a[148:151], v249, s[20:23], s68 offen offset:0 sc1
    s_waitcnt vmcnt(12) lgkmcnt(4)
    v_mfma_f32_32x32x16_bf16 v[32:47], v[112:115], a[100:103], v[32:47]
    ds_read_b64_tr_b16 v[96:97], v246 offset:12288
    ds_read_b64_tr_b16 v[98:99], v246 offset:13312
    v_mfma_f32_32x32x16_bf16 v[48:63], v[116:119], a[96:99], v[48:63]
    ds_read_b64_tr_b16 v[100:101], v247 offset:12288
    ds_read_b64_tr_b16 v[102:103], v247 offset:13312
    buffer_load_dwordx4 a[152:155], v254, s[20:23], s68 offen offset:2048 sc1
    v_mfma_f32_32x32x16_bf16 v[64:79], v[116:119], a[100:103], v[64:79]
    buffer_load_dwordx4 a[156:159], v249, s[20:23], s68 offen offset:2048 sc1
    v_mfma_f32_32x32x16_bf16 v[16:31], v[112:115], a[96:99], v[16:31]
    s_waitcnt vmcnt(12) lgkmcnt(4)
    v_mfma_f32_32x32x16_bf16 v[32:47], v[120:123], a[108:111], v[32:47]
    ds_read_b64_tr_b16 v[104:105], v246 offset:14336
    ds_read_b64_tr_b16 v[106:107], v246 offset:15360
    v_mfma_f32_32x32x16_bf16 v[48:63], v[124:127], a[104:107], v[48:63]
    ds_read_b64_tr_b16 v[108:109], v247 offset:14336
    ds_read_b64_tr_b16 v[110:111], v247 offset:15360
    s_add_u32 s68, s82, 12288
    v_mfma_f32_32x32x16_bf16 v[64:79], v[124:127], a[108:111], v[64:79]
    buffer_load_dwordx4 a[56:59], v254, s[20:23], s68 offen offset:0 sc1
    v_mfma_f32_32x32x16_bf16 v[16:31], v[120:123], a[104:107], v[16:31]
    buffer_load_dwordx4 a[60:63], v249, s[20:23], s68 offen offset:0 sc1
    s_waitcnt vmcnt(12) lgkmcnt(4)
    v_mfma_f32_32x32x16_bf16 v[32:47], v[96:99], a[116:119], v[32:47]
    ds_read_b64_tr_b16 v[112:113], v246 offset:16384
    ds_read_b64_tr_b16 v[114:115], v246 offset:17408
    v_mfma_f32_32x32x16_bf16 v[48:63], v[100:103], a[112:115], v[48:63]
    ds_read_b64_tr_b16 v[116:117], v247 offset:16384
    ds_read_b64_tr_b16 v[118:119], v247 offset:17408
    buffer_load_dwordx4 a[64:67], v254, s[20:23], s68 offen offset:2048 sc1
    v_mfma_f32_32x32x16_bf16 v[64:79], v[100:103], a[116:119], v[64:79]
    buffer_load_dwordx4 a[68:71], v249, s[20:23], s68 offen offset:2048 sc1
    v_mfma_f32_32x32x16_bf16 v[16:31], v[96:99], a[112:115], v[16:31]
    s_waitcnt vmcnt(12) lgkmcnt(4)
    v_mfma_f32_32x32x16_bf16 v[32:47], v[104:107], a[124:127], v[32:47]
    ds_read_b64_tr_b16 v[120:121], v246 offset:18432
    ds_read_b64_tr_b16 v[122:123], v246 offset:19456
    v_mfma_f32_32x32x16_bf16 v[48:63], v[108:111], a[120:123], v[48:63]
    ds_read_b64_tr_b16 v[124:125], v247 offset:18432
    ds_read_b64_tr_b16 v[126:127], v247 offset:19456
    buffer_load_dwordx4 a[72:75], v254, s[20:23], s83 offen offset:0 sc1
    v_mfma_f32_32x32x16_bf16 v[64:79], v[108:111], a[124:127], v[64:79]
    buffer_load_dwordx4 a[76:79], v249, s[20:23], s83 offen offset:0 sc1
    v_mfma_f32_32x32x16_bf16 v[16:31], v[104:107], a[120:123], v[16:31]
    s_waitcnt vmcnt(12) lgkmcnt(4)
    v_mfma_f32_32x32x16_bf16 v[32:47], v[112:115], a[132:135], v[32:47]
    ds_read_b64_tr_b16 v[96:97], v244 offset:12288
    ds_read_b64_tr_b16 v[98:99], v244 offset:13312
    v_mfma_f32_32x32x16_bf16 v[48:63], v[116:119], a[128:131], v[48:63]
    ds_read_b64_tr_b16 v[100:101], v245 offset:12288
    ds_read_b64_tr_b16 v[102:103], v245 offset:13312
    buffer_load_dwordx4 a[80:83], v254, s[20:23], s83 offen offset:2048 sc1
    v_mfma_f32_32x32x16_bf16 v[64:79], v[116:119], a[132:135], v[64:79]
    buffer_load_dwordx4 a[84:87], v249, s[20:23], s83 offen offset:2048 sc1
    v_mfma_f32_32x32x16_bf16 v[16:31], v[112:115], a[128:131], v[16:31]
    s_waitcnt vmcnt(12) lgkmcnt(4)
    v_mfma_f32_32x32x16_bf16 v[32:47], v[120:123], a[140:143], v[32:47]
    ds_read_b64_tr_b16 v[104:105], v244 offset:14336
    ds_read_b64_tr_b16 v[106:107], v244 offset:15360
    v_mfma_f32_32x32x16_bf16 v[48:63], v[124:127], a[136:139], v[48:63]
    ds_read_b64_tr_b16 v[108:109], v245 offset:14336
    ds_read_b64_tr_b16 v[110:111], v245 offset:15360
    s_add_u32 s68, s83, 4096
    v_mfma_f32_32x32x16_bf16 v[64:79], v[124:127], a[140:143], v[64:79]
    buffer_load_dwordx4 a[88:91], v254, s[20:23], s68 offen offset:0 sc1
    v_mfma_f32_32x32x16_bf16 v[16:31], v[120:123], a[136:139], v[16:31]
    buffer_load_dwordx4 a[92:95], v249, s[20:23], s68 offen offset:0 sc1
    s_waitcnt vmcnt(12) lgkmcnt(4)
    v_mfma_f32_32x32x16_bf16 v[32:47], v[96:99], a[148:151], v[32:47]
    ds_read_b64_tr_b16 v[112:113], v244 offset:0
    ds_read_b64_tr_b16 v[114:115], v244 offset:1024
    v_mfma_f32_32x32x16_bf16 v[48:63], v[100:103], a[144:147], v[48:63]
    ds_read_b64_tr_b16 v[116:117], v245 offset:0
    ds_read_b64_tr_b16 v[118:119], v245 offset:1024
    buffer_load_dwordx4 a[96:99], v254, s[20:23], s68 offen offset:2048 sc1
    v_mfma_f32_32x32x16_bf16 v[64:79], v[100:103], a[148:151], v[64:79]
    buffer_load_dwordx4 a[100:103], v249, s[20:23], s68 offen offset:2048 sc1
    v_mfma_f32_32x32x16_bf16 v[16:31], v[96:99], a[144:147], v[16:31]
    s_waitcnt vmcnt(12) lgkmcnt(4)
    v_mfma_f32_32x32x16_bf16 v[32:47], v[104:107], a[156:159], v[32:47]
    ds_read_b64_tr_b16 v[120:121], v244 offset:2048
    ds_read_b64_tr_b16 v[122:123], v244 offset:3072
    v_mfma_f32_32x32x16_bf16 v[48:63], v[108:111], a[152:155], v[48:63]
    ds_read_b64_tr_b16 v[124:125], v245 offset:2048
    ds_read_b64_tr_b16 v[126:127], v245 offset:3072
    s_add_u32 s68, s83, 8192
    v_mfma_f32_32x32x16_bf16 v[64:79], v[108:111], a[156:159], v[64:79]
    buffer_load_dwordx4 a[104:107], v254, s[20:23], s68 offen offset:0 sc1
    v_mfma_f32_32x32x16_bf16 v[16:31], v[104:107], a[152:155], v[16:31]
    buffer_load_dwordx4 a[108:111], v249, s[20:23], s68 offen offset:0 sc1
    s_waitcnt vmcnt(12) lgkmcnt(4)
    v_mfma_f32_32x32x16_bf16 v[32:47], v[112:115], a[60:63], v[32:47]
    ds_read_b64_tr_b16 v[96:97], v244 offset:4096
    ds_read_b64_tr_b16 v[98:99], v244 offset:5120
    v_mfma_f32_32x32x16_bf16 v[48:63], v[116:119], a[56:59], v[48:63]
    ds_read_b64_tr_b16 v[100:101], v245 offset:4096
    ds_read_b64_tr_b16 v[102:103], v245 offset:5120
    buffer_load_dwordx4 a[112:115], v254, s[20:23], s68 offen offset:2048 sc1
    v_mfma_f32_32x32x16_bf16 v[64:79], v[116:119], a[60:63], v[64:79]
    buffer_load_dwordx4 a[116:119], v249, s[20:23], s68 offen offset:2048 sc1
    v_mfma_f32_32x32x16_bf16 v[16:31], v[112:115], a[56:59], v[16:31]
    s_waitcnt vmcnt(12) lgkmcnt(4)
    v_mfma_f32_32x32x16_bf16 v[32:47], v[120:123], a[68:71], v[32:47]
    ds_read_b64_tr_b16 v[104:105], v244 offset:6144
    ds_read_b64_tr_b16 v[106:107], v244 offset:7168
    v_mfma_f32_32x32x16_bf16 v[48:63], v[124:127], a[64:67], v[48:63]
    ds_read_b64_tr_b16 v[108:109], v245 offset:6144
    ds_read_b64_tr_b16 v[110:111], v245 offset:7168
    s_add_u32 s68, s83, 12288
    v_mfma_f32_32x32x16_bf16 v[64:79], v[124:127], a[68:71], v[64:79]
    buffer_load_dwordx4 a[120:123], v254, s[20:23], s68 offen offset:0 sc1
    v_mfma_f32_32x32x16_bf16 v[16:31], v[120:123], a[64:67], v[16:31]
    buffer_load_dwordx4 a[124:127], v249, s[20:23], s68 offen offset:0 sc1
    s_waitcnt vmcnt(12) lgkmcnt(4)
    v_mfma_f32_32x32x16_bf16 v[32:47], v[96:99], a[76:79], v[32:47]
    ds_read_b64_tr_b16 v[112:113], v244 offset:8192
    ds_read_b64_tr_b16 v[114:115], v244 offset:9216
    v_mfma_f32_32x32x16_bf16 v[48:63], v[100:103], a[72:75], v[48:63]
    ds_read_b64_tr_b16 v[116:117], v245 offset:8192
    ds_read_b64_tr_b16 v[118:119], v245 offset:9216
    buffer_load_dwordx4 a[128:131], v254, s[20:23], s68 offen offset:2048 sc1
    v_mfma_f32_32x32x16_bf16 v[64:79], v[100:103], a[76:79], v[64:79]
    buffer_load_dwordx4 a[132:135], v249, s[20:23], s68 offen offset:2048 sc1
    v_mfma_f32_32x32x16_bf16 v[16:31], v[96:99], a[72:75], v[16:31]
    s_waitcnt vmcnt(12) lgkmcnt(4)
    v_mfma_f32_32x32x16_bf16 v[32:47], v[104:107], a[84:87], v[32:47]
    ds_read_b64_tr_b16 v[120:121], v244 offset:10240
    ds_read_b64_tr_b16 v[122:123], v244 offset:11264
    v_mfma_f32_32x32x16_bf16 v[48:63], v[108:111], a[80:83], v[48:63]
    ds_read_b64_tr_b16 v[124:125], v245 offset:10240
    ds_read_b64_tr_b16 v[126:127], v245 offset:11264
    v_mfma_f32_32x32x16_bf16 v[64:79], v[108:111], a[84:87], v[64:79]
    v_mfma_f32_32x32x16_bf16 v[16:31], v[104:107], a[80:83], v[16:31]
    s_waitcnt vmcnt(10) lgkmcnt(4)
    v_mfma_f32_32x32x16_bf16 v[32:47], v[112:115], a[92:95], v[32:47]
    ds_read_b64_tr_b16 v[96:97], v246 offset:0
    ds_read_b64_tr_b16 v[98:99], v246 offset:1024
    v_mfma_f32_32x32x16_bf16 v[48:63], v[116:119], a[88:91], v[48:63]
    ds_read_b64_tr_b16 v[100:101], v247 offset:0
    ds_read_b64_tr_b16 v[102:103], v247 offset:1024
    v_mfma_f32_32x32x16_bf16 v[64:79], v[116:119], a[92:95], v[64:79]
    v_mfma_f32_32x32x16_bf16 v[16:31], v[112:115], a[88:91], v[16:31]
    s_waitcnt vmcnt(8) lgkmcnt(4)
    v_mfma_f32_32x32x16_bf16 v[32:47], v[120:123], a[100:103], v[32:47]
    ds_read_b64_tr_b16 v[104:105], v246 offset:2048
    ds_read_b64_tr_b16 v[106:107], v246 offset:3072
    v_mfma_f32_32x32x16_bf16 v[48:63], v[124:127], a[96:99], v[48:63]
    ds_read_b64_tr_b16 v[108:109], v247 offset:2048
    ds_read_b64_tr_b16 v[110:111], v247 offset:3072
    v_mfma_f32_32x32x16_bf16 v[64:79], v[124:127], a[100:103], v[64:79]
    v_mfma_f32_32x32x16_bf16 v[16:31], v[120:123], a[96:99], v[16:31]
    v_lshlrev_b32 v9, 4, v0
    v_add_u32 v10, s61, v9
    s_xor_b32 s57, s3, 1
    s_mul_i32 s57, s57, 20608
    v_add_u32 v11, s57, v9
    s_xor_b32 s57, s3, 2
    s_mul_i32 s57, s57, 20608
    v_add_u32 v12, s57, v9
    s_xor_b32 s57, s3, 3
    s_mul_i32 s57, s57, 20608
    v_add_u32 v13, s57, v9
    s_waitcnt vmcnt(6) lgkmcnt(4)
    v_mfma_f32_32x32x16_bf16 v[32:47], v[96:99], a[108:111], v[32:47]
    ds_read_b64_tr_b16 v[112:113], v246 offset:4096
    ds_read_b64_tr_b16 v[114:115], v246 offset:5120
    v_mfma_f32_32x32x16_bf16 v[48:63], v[100:103], a[104:107], v[48:63]
    ds_read_b64_tr_b16 v[116:117], v247 offset:4096
    ds_read_b64_tr_b16 v[118:119], v247 offset:5120
    ds_read_b64_tr_b16 v[120:121], v246 offset:6144
    ds_read_b64_tr_b16 v[122:123], v246 offset:7168
    ds_read_b64_tr_b16 v[124:125], v247 offset:6144
    ds_read_b64_tr_b16 v[126:127], v247 offset:7168
    v_mfma_f32_32x32x16_bf16 v[64:79], v[100:103], a[108:111], v[64:79]
    v_mfma_f32_32x32x16_bf16 v[16:31], v[96:99], a[104:107], v[16:31]
    s_waitcnt vmcnt(0) lgkmcnt(0)
    v_mfma_f32_32x32x16_bf16 v[32:47], v[104:107], a[116:119], v[32:47]
    v_mfma_f32_32x32x16_bf16 v[32:47], v[112:115], a[124:127], v[32:47]
    v_mfma_f32_32x32x16_bf16 v[32:47], v[120:123], a[132:135], v[32:47]
    v_mfma_f32_32x32x16_bf16 v[48:63], v[108:111], a[112:115], v[48:63]
    v_mfma_f32_32x32x16_bf16 v[48:63], v[116:119], a[120:123], v[48:63]
    s_nop 9
    ds_write_b128 v10, v[32:35] offset:4096
    ds_write_b128 v10, v[36:39] offset:5120
    v_mfma_f32_32x32x16_bf16 v[48:63], v[124:127], a[128:131], v[48:63]
    ds_write_b128 v10, v[40:43] offset:6144
    ds_write_b128 v10, v[44:47] offset:7168
    v_mfma_f32_32x32x16_bf16 v[64:79], v[108:111], a[116:119], v[64:79]
    v_mfma_f32_32x32x16_bf16 v[64:79], v[116:119], a[124:127], v[64:79]
    s_nop 7
    ds_write_b128 v10, v[48:51] offset:8192
    ds_write_b128 v10, v[52:55] offset:9216
    v_mfma_f32_32x32x16_bf16 v[64:79], v[124:127], a[132:135], v[64:79]
    ds_write_b128 v10, v[56:59] offset:10240
    ds_write_b128 v10, v[60:63] offset:11264
    v_mfma_f32_32x32x16_bf16 v[16:31], v[104:107], a[112:115], v[16:31]
    v_mfma_f32_32x32x16_bf16 v[16:31], v[112:115], a[120:123], v[16:31]
    s_nop 7
    ds_write_b128 v10, v[64:67] offset:12288
    ds_write_b128 v10, v[68:71] offset:13312
    v_mfma_f32_32x32x16_bf16 v[16:31], v[120:123], a[128:131], v[16:31]
    ds_write_b128 v10, v[72:75] offset:14336
    ds_write_b128 v10, v[76:79] offset:15360
    s_nop 9
    v_pk_add_f32 v[16:17], v[16:17], v[128:129]
    v_pk_add_f32 v[18:19], v[18:19], v[130:131]
    v_pk_add_f32 v[20:21], v[20:21], v[132:133]
    v_pk_add_f32 v[22:23], v[22:23], v[134:135]
    v_pk_add_f32 v[24:25], v[24:25], v[136:137]
    v_pk_add_f32 v[26:27], v[26:27], v[138:139]
    v_pk_add_f32 v[28:29], v[28:29], v[140:141]
    v_pk_add_f32 v[30:31], v[30:31], v[142:143]
    s_waitcnt lgkmcnt(0)
    s_barrier
    ds_read_b128 v[32:35], v11 offset:4096
    ds_read_b128 v[36:39], v11 offset:5120
    ds_read_b128 v[40:43], v11 offset:6144
    ds_read_b128 v[44:47], v11 offset:7168
    ds_read_b128 v[48:51], v12 offset:8192
    ds_read_b128 v[52:55], v12 offset:9216
    ds_read_b128 v[56:59], v12 offset:10240
    ds_read_b128 v[60:63], v12 offset:11264
    ds_read_b128 v[64:67], v13 offset:12288
    ds_read_b128 v[68:71], v13 offset:13312
    ds_read_b128 v[72:75], v13 offset:14336
    ds_read_b128 v[76:79], v13 offset:15360
    s_waitcnt lgkmcnt(8)
    v_pk_add_f32 v[16:17], v[16:17], v[32:33]
    v_pk_add_f32 v[18:19], v[18:19], v[34:35]
    v_pk_add_f32 v[20:21], v[20:21], v[36:37]
    v_pk_add_f32 v[22:23], v[22:23], v[38:39]
    v_pk_add_f32 v[24:25], v[24:25], v[40:41]
    v_pk_add_f32 v[26:27], v[26:27], v[42:43]
    v_pk_add_f32 v[28:29], v[28:29], v[44:45]
    v_pk_add_f32 v[30:31], v[30:31], v[46:47]
    s_waitcnt lgkmcnt(4)
    v_pk_add_f32 v[16:17], v[16:17], v[48:49]
    v_pk_add_f32 v[18:19], v[18:19], v[50:51]
    v_pk_add_f32 v[20:21], v[20:21], v[52:53]
    v_pk_add_f32 v[22:23], v[22:23], v[54:55]
    v_pk_add_f32 v[24:25], v[24:25], v[56:57]
    v_pk_add_f32 v[26:27], v[26:27], v[58:59]
    v_pk_add_f32 v[28:29], v[28:29], v[60:61]
    v_pk_add_f32 v[30:31], v[30:31], v[62:63]
    s_waitcnt lgkmcnt(0)
    v_pk_add_f32 v[16:17], v[16:17], v[64:65]
    v_pk_add_f32 v[18:19], v[18:19], v[66:67]
    v_pk_add_f32 v[20:21], v[20:21], v[68:69]
    v_pk_add_f32 v[22:23], v[22:23], v[70:71]
    v_pk_add_f32 v[24:25], v[24:25], v[72:73]
    v_pk_add_f32 v[26:27], v[26:27], v[74:75]
    v_pk_add_f32 v[28:29], v[28:29], v[76:77]
    v_pk_add_f32 v[30:31], v[30:31], v[78:79]
    v_cvt_pk_bf16_f32 v16, v16, v17
    v_cvt_pk_bf16_f32 v17, v18, v19
    v_cvt_pk_bf16_f32 v18, v20, v21
    v_cvt_pk_bf16_f32 v19, v22, v23
    v_cvt_pk_bf16_f32 v20, v24, v25
    v_cvt_pk_bf16_f32 v21, v26, v27
    v_cvt_pk_bf16_f32 v22, v28, v29
    v_cvt_pk_bf16_f32 v23, v30, v31
    v_permlane32_swap_b32 v16, v18
    v_permlane32_swap_b32 v17, v19
    buffer_store_dwordx4 v[16:19], v3, s[32:35], 0 offen offset:0
    v_permlane32_swap_b32 v20, v22
    v_permlane32_swap_b32 v21, v23
    buffer_store_dwordx4 v[20:23], v3, s[32:35], 0 offen offset:32
    s_branch L_fin
L_nophase2:
    s_waitcnt vmcnt(0)
    s_barrier
    s_cmp_lg_u32 s3, 0
    s_cbranch_scc1 L_noflag_X
    s_lshl_b32 s57, s40, 2
    s_add_u32 s57, s57, s42
    s_lshl_b32 s58, s57, 5
    s_add_u32 s58, s58, s41
    s_lshl_b32 s58, s58, 2
    s_add_u32 s58, s58, 9437184
    s_add_u32 s59, s73, 1
    s_mov_b64 exec, 1
    v_mov_b32 v5, s59
    v_mov_b32 v6, 0
    buffer_store_dword v5, v6, s[20:23], s58 offen sc1
    s_lshl_b32 s57, s57, 2
    s_lshl_b32 s58, 1, s41
    v_mov_b32 v7, s58
    buffer_atomic_or v7, v6, s[36:39], s57 offen sc1
    s_mov_b64 exec, -1
L_noflag_X:
L_fin:
L_end:
    s_endpgm
.section .rodata,"a"
.p2align 6
.amdhsa_kernel parallel_sum__sliding_local_dilated__geglu_ffn__prompt_kernel
  .amdhsa_next_free_vgpr 512
  .amdhsa_next_free_sgpr 102
  .amdhsa_accum_offset 256
  .amdhsa_group_segment_fixed_size 0
  .amdhsa_kernarg_size 80
  .amdhsa_user_sgpr_count 2
  .amdhsa_user_sgpr_kernarg_segment_ptr 1
  .amdhsa_system_sgpr_workgroup_id_x 1
.end_amdhsa_kernel
```
